```python
import torch

def _softmax(x, axis=-1):
    return torch.softmax(x, dim=axis)
def _gelu(x):
    return torch.nn.functional.gelu(x, approximate="tanh")
def _silu(x):
    return torch.nn.functional.silu(x)
def _sigmoid(x):
    return torch.sigmoid(x)
def _layernorm(x, axis=-1, eps=1e-5):
    m = x.mean(dim=axis, keepdim=True)
    v = x.var(dim=axis, keepdim=True, unbiased=False)
    return (x - m) / torch.sqrt(v + eps)
def _scatter_add(tgt, idx, src, axis=0):
    return tgt.clone().index_add_(axis, idx, src)
def _segment_sum(src, seg, n):
    out = torch.zeros((n,) + src.shape[1:], dtype=src.dtype)
    return out.index_add_(0, seg, src)
def _pad(x, pw):
    flat = tuple(v for pair in reversed(pw) for v in pair)
    return torch.nn.functional.pad(x, flat)

kernel_name = 'parallel_sum__linear_attn_block__glu_gated_reglu__prompt'

def setup_inputs():

    _w = (lambda a: (lambda t: t.to(torch.bfloat16) if t.is_floating_point() else t)(torch.as_tensor(a)))
    def _A_setup():
        B, S, D = 1, 2048, 448
        return {
            "x": _w((lambda *s: torch.randn(*s, dtype=torch.bfloat16) * 0.05)(B, S, D)),
            "wqkv": _w((lambda *s: torch.randn(*s, dtype=torch.bfloat16) * 0.1)(D, 3 * D)),
            "wo": _w((lambda *s: torch.randn(*s, dtype=torch.bfloat16) * 0.05)(D, D)),
        }
    _A_in = _A_setup()

    def _B_setup():
        B, S, D, F = 1, 2048, 448, 1792
        return {
            "x": _w((lambda *s: torch.randn(*s, dtype=torch.bfloat16) * 0.05)(B, S, D)),
            "W_gate": _w((lambda *s: torch.randn(*s, dtype=torch.bfloat16) * 0.2)(D, F) * (2.0 / D) ** 0.5),
            "W_up": _w((lambda *s: torch.randn(*s, dtype=torch.bfloat16) * 0.2)(D, F) * (2.0 / D) ** 0.5),
            "W_down": _w((lambda *s: torch.randn(*s, dtype=torch.bfloat16) * 0.2)(F, D) * (1.0 / F) ** 0.5),
        }
    _B_in = _B_setup()

    return {
        "A_x": _A_in["x"],
        "A_wqkv": _A_in["wqkv"],
        "A_wo": _A_in["wo"],
        "B_x": _B_in["x"],
        "B_W_gate": _B_in["W_gate"],
        "B_W_up": _B_in["W_up"],
        "B_W_down": _B_in["W_down"],
    }

def reference(A_x, A_wqkv, A_wo, B_x, B_W_gate, B_W_up, B_W_down):
    def _A_ref(x, wqkv, wo):
        B, S, D = x.shape
        H = 16; Dh = D // H
        qkv = (lambda x, *d: x.permute(*d))((x @ wqkv).reshape(B, S, 3, H, Dh), 2, 0, 3, 1, 4)
        q, k, v = qkv[0], qkv[1], qkv[2]
        phi = lambda t: torch.where(t > 0, t + 1, torch.exp(t)) + 1e-6
        pq, pk = phi(q), phi(k)
        kv = torch.einsum("bhsd,bhse->bhde", pk, v)
        z = torch.einsum("bhsd->bhd", pk)
        num = torch.einsum("bhqd,bhde->bhqe", pq, kv)
        den = torch.einsum("bhqd,bhd->bhq", pq, z)[..., None] + 1e-6
        o = num / den
        return (lambda x, *d: x.permute(*d))(o, 0, 2, 1, 3).reshape(B, S, D) @ wo

    def _B_ref(x, W_gate, W_up, W_down):
        gate = torch.einsum("bsd,df->bsf", x, W_gate)
        up = torch.einsum("bsd,df->bsf", x, W_up)
        gate = gate * (lambda x, dt: x.to(dt))(gate > 0, gate.dtype)
        h = gate * up
        return torch.einsum("bsf,fd->bsd", h, W_down)

    x = A_x
    xn = _layernorm(x, axis=-1)
    return x + _A_ref(xn, A_wqkv, A_wo) + _B_ref(xn, B_W_gate, B_W_up, B_W_down)
```

```asm
; @launch grid=(256,1,1) block=(512,1,1) lds=163840
.amdgcn_target "amdgcn-amd-amdhsa--gfx950"
.text
.globl parallel_sum__linear_attn_block__glu_gated_reglu__prompt_kernel
.p2align 8
.type parallel_sum__linear_attn_block__glu_gated_reglu__prompt_kernel,@function
parallel_sum__linear_attn_block__glu_gated_reglu__prompt_kernel:
    s_cmp_ge_u32 s2, 256
    s_cbranch_scc1 K1_end
    s_load_dwordx2 s[4:5], s[0:1], 0
    s_load_dwordx2 s[8:9], s[0:1], 8
    s_load_dwordx2 s[12:13], s[0:1], 32
    s_load_dwordx2 s[16:17], s[0:1], 40
    s_load_dwordx2 s[20:21], s[0:1], 72
    s_getpc_b64 s[68:69]
K1_pc:
    s_mov_b32 s70, K1_codeend-K1_pc
    s_mov_b32 s71, 0x20000
    s_and_b32 s72, s2, 56
    v_lshlrev_b32 v1, 7, v0
    s_lshl_b64 exec, 0xff, s72
    buffer_load_dword v255, v1, s[68:71], 0 offen
    s_mov_b64 exec, -1
    v_lshrrev_b32 v1, 6, v0
    v_and_b32 v0, 63, v0
    s_setprio 3
    v_readfirstlane_b32 s32, v1
    s_mov_b32 s6, 1835008
    s_mov_b32 s7, 0x20000
    s_and_b32 s49, s2, 1
    s_bfe_u32 s51, s2, 0x20003
    s_lshl2_add_u32 s34, s49, s51
    s_bfe_u32 s36, s2, 0x20001
    s_bfe_u32 s51, s2, 0x30005
    s_lshl3_add_u32 s36, s36, s51
    v_lshlrev_b32 v31, 4, v0
    v_mov_b32 v5, 0x40000000
    v_cmp_gt_u32 vcc, 56, v0
    v_lshrrev_b32 v1, 3, v0
    v_lshrrev_b32 v2, 4, v0
    v_cndmask_b32 v5, v5, v31, vcc
    s_lshl_b32 s49, s34, 8
    s_lshl3_add_u32 s73, s36, s49
    s_add_u32 s73, s73, s32
    s_mul_i32 s72, s73, 896
    s_lshl3_add_u32 s49, s32, s49
    s_mul_i32 s37, s49, 896
    s_lshl_b32 s40, s32, 10
    s_lshl_b32 s50, s32, 2
    s_and_b32 s50, s50, 4
    v_add_u32 v3, s50, v2
    v_and_b32 v4, 7, v0
    v_xor_b32 v4, v4, v3
    v_lshlrev_b32 v4, 4, v4
    v_mul_u32_u24 v28, 896, v1
    v_add_u32 v28, v28, v4
    s_cmp_eq_u32 s34, 7
    s_cselect_b32 s44, 0, s34
    s_lshl_b32 s74, s44, 7
    s_add_u32 s74, s74, s37
    s_add_u32 m0, s40, 0
    s_mul_i32 s75, s44, 172032
    s_waitcnt lgkmcnt(0)
    buffer_load_dwordx4 v[88:91], v5, s[4:7], s72 offen
    buffer_load_dwordx4 v28, s[4:7], s74 offen lds
    s_add_u32 m0, m0, 8192
    s_add_u32 s74, s74, 57344
    buffer_load_dwordx4 v28, s[4:7], s74 offen lds
    s_add_u32 m0, m0, 8192
    s_add_u32 s74, s74, 57344
    buffer_load_dwordx4 v28, s[4:7], s74 offen lds
    s_add_u32 m0, m0, 8192
    s_add_u32 s74, s74, 57344
    buffer_load_dwordx4 v28, s[4:7], s74 offen lds
    s_mov_b32 s10, 1204224
    s_mov_b32 s11, 0x20000
    s_and_b32 s35, s36, 15
    s_and_b32 s33, s32, 3
    s_cmp_ge_u32 s36, 16
    s_cbranch_scc1 K1_typeB
K1_typeA:
    v_lshrrev_b32 v1, 3, v0
    v_lshrrev_b32 v2, 4, v0
    v_and_b32 v2, 1, v2
    v_lshlrev_b32 v2, 2, v2
    v_and_b32 v3, 7, v0
    v_xor_b32 v3, v3, v2
    v_and_b32 v4, 3, v3
    v_lshrrev_b32 v3, 2, v3
    v_lshlrev_b32 v6, 4, v4
    v_cmp_eq_u32 vcc, 3, v4
    v_mul_u32_u24 v3, 896, v3
    v_add_u32 v3, 896, v3
    v_mov_b32 v7, 40
    v_cndmask_b32 v6, v6, v7, vcc
    v_mul_u32_u24 v29, 2688, v1
    v_add3_u32 v29, v29, v3, v6
    s_mul_i32 s38, s32, 21504
    s_mul_i32 s50, s35, 56
    s_add_u32 s38, s38, s50
    s_lshl_b32 s41, s32, 10
    s_add_u32 s41, s41, 32768
    s_add_u32 m0, s41, 0
    s_add_u32 s75, s75, s38
    buffer_load_dwordx4 v29, s[8:11], s75 offen lds
    s_mov_b32 s14, 1605632
    s_mov_b32 s15, 0x20000
    s_mov_b32 s18, 1605632
    s_mov_b32 s19, 0x20000
    v_mul_u32_u24 v1, 43, v0
    v_lshrrev_b32 v1, 8, v1
    v_mul_u32_u24 v2, 6, v1
    v_sub_u32 v2, v0, v2
    v_lshlrev_b32 v2, 4, v2
    v_mul_u32_u24 v30, 3584, v1
    v_add_u32 v30, v30, v2
    s_mov_b32 s56, -1
    s_mov_b32 s57, 0xffff
    s_mov_b32 s52, 0x64532017
    s_mov_b32 s53, 0xedcab98f
    s_lshl_b32 s50, s35, 2
    s_lshr_b64 s[52:53], s[52:53], s50
    s_and_b32 s29, s52, 15
    s_mul_i32 s50, s29, 96
    s_mul_i32 s42, s32, 768
    s_add_u32 s43, s42, 47232
    s_add_u32 s42, s42, 40960
    s_mul_i32 s39, s32, 28672
    s_add_u32 s39, s39, s50
    s_mul_i32 s74, s44, 229376
    s_add_u32 m0, s42, 0
    s_add_u32 s74, s74, s39
    s_mov_b64 exec, s[56:57]
    buffer_load_dwordx4 v30, s[12:15], s74 offen lds
    s_mov_b64 exec, -1
    s_add_u32 m0, s43, 0
    s_nop 0
    s_mov_b64 exec, s[56:57]
    buffer_load_dwordx4 v30, s[16:19], s74 offen lds
    s_mov_b64 exec, -1
    s_add_u32 s44, s44, 1
    s_cmp_eq_u32 s44, 7
    s_cselect_b32 s44, 0, s44
    s_memrealtime s[60:61]
    s_load_dwordx2 s[24:25], s[0:1], 48
    s_load_dwordx2 s[80:81], s[0:1], 16
    s_load_dwordx2 s[64:65], s[0:1], 64
    s_mov_b32 s22, 16777216
    s_mov_b32 s23, 0x20000
    s_mov_b32 s26, 1605632
    s_mov_b32 s27, 0x20000
    s_mov_b32 s82, 401408
    s_mov_b32 s83, 0x20000
    s_mov_b32 s66, 256
    s_mov_b32 s67, 0x20000
    s_cmp_ge_u32 s32, 4
    s_cbranch_scc1 K1_A1
    s_branch K1_A0
K1_typeB:
    v_lshrrev_b32 v1, 2, v0
    v_and_b32 v4, 3, v0
    v_lshlrev_b32 v6, 4, v4
    v_cmp_eq_u32 vcc, 3, v4
    v_mov_b32 v7, 40
    v_mul_u32_u24 v29, 2688, v1
    v_cndmask_b32 v6, v6, v7, vcc
    v_add_u32 v29, v29, v6
    s_mov_b32 s56, -1
    s_mov_b32 s57, 0
    s_mul_i32 s38, s32, 21504
    s_mul_i32 s50, s35, 56
    s_add_u32 s38, s38, s50
    s_mul_i32 s48, s33, 43008
    s_add_u32 s48, s48, s50
    s_lshl_b32 s41, s32, 9
    s_add_u32 s41, s41, 32768
    s_add_u32 m0, s41, 0
    s_add_u32 s75, s75, s38
    s_mov_b64 exec, s[56:57]
    buffer_load_dwordx4 v29, s[8:11], s75 offen lds
    s_mov_b64 exec, -1
    s_mov_b32 s14, 1605632
    s_mov_b32 s15, 0x20000
    s_mov_b32 s18, 1605632
    s_mov_b32 s19, 0x20000
    v_lshrrev_b32 v1, 3, v0
    v_lshrrev_b32 v2, 4, v0
    v_and_b32 v2, 1, v2
    v_lshlrev_b32 v2, 1, v2
    v_and_b32 v3, 7, v0
    v_xor_b32 v3, v3, v2
    v_lshlrev_b32 v3, 4, v3
    v_mul_u32_u24 v30, 3584, v1
    v_add_u32 v30, v30, v3
    s_lshl_b32 s50, s35, 7
    s_add_u32 s50, s50, 1536
    s_lshl_b32 s42, s32, 10
    s_add_u32 s43, s42, 45120
    s_add_u32 s42, s42, 36864
    s_mul_i32 s39, s32, 28672
    s_add_u32 s39, s39, s50
    s_lshl_b32 s28, s33, 10
    s_add_u32 s28, s28, 32768
    s_mul_i32 s74, s44, 229376
    s_add_u32 m0, s42, 0
    s_add_u32 s74, s74, s39
    buffer_load_dwordx4 v30, s[12:15], s74 offen lds
    s_add_u32 m0, s43, 0
    s_nop 0
    buffer_load_dwordx4 v30, s[16:19], s74 offen lds
    s_add_u32 s44, s44, 1
    s_cmp_eq_u32 s44, 7
    s_cselect_b32 s44, 0, s44
    s_memrealtime s[60:61]
    s_load_dwordx2 s[24:25], s[0:1], 48
    s_load_dwordx2 s[80:81], s[0:1], 16
    s_load_dwordx2 s[64:65], s[0:1], 64
    s_mov_b32 s22, 16777216
    s_mov_b32 s23, 0x20000
    s_mov_b32 s26, 1605632
    s_mov_b32 s27, 0x20000
    s_mov_b32 s82, 401408
    s_mov_b32 s83, 0x20000
    s_mov_b32 s66, 256
    s_mov_b32 s67, 0x20000
    s_cmp_ge_u32 s32, 4
    s_cbranch_scc1 K1_B1
    s_branch K1_B0
K1_A0:
    s_setprio 2
    s_mov_b32 s58, 0xffff0000
    s_mov_b32 s62, -1
    s_mov_b32 s63, 0
    s_mov_b32 s30, 0x01000000
    s_mov_b32 s31, 0x01000000
    s_mov_b32 s79, 16777216
    s_lshl_b32 s77, s35, 6
    s_add_u32 s77, s77, 13115392
    v_mov_b32 v1, 0x40000000
    v_cmp_gt_u32 vcc, 4, v0
    s_nop 1
    v_cndmask_b32 v42, v1, v31, vcc
    v_and_b32 v1, 31, v0
    v_lshrrev_b32 v2, 5, v0
    v_lshrrev_b32 v3, 1, v1
    v_and_b32 v3, 7, v3
    s_lshl_b32 s49, s33, 13
    v_lshlrev_b32 v4, 7, v1
    v_add_u32 v4, s49, v4
    s_add_u32 s50, s33, 0
    s_and_b32 s50, s50, 3
    s_lshl_b32 s50, s50, 1
    v_add_u32 v5, s50, v2
    v_xor_b32 v5, v5, v3
    v_lshlrev_b32 v5, 4, v5
    v_add_u32 v16, v4, v5
    v_add_u32 v124, 106752, v16
    s_add_u32 s50, s33, 1
    s_and_b32 s50, s50, 3
    s_lshl_b32 s50, s50, 1
    v_add_u32 v5, s50, v2
    v_xor_b32 v5, v5, v3
    v_lshlrev_b32 v5, 4, v5
    v_add_u32 v17, v4, v5
    v_add_u32 v125, 106752, v17
    s_add_u32 s50, s33, 2
    s_and_b32 s50, s50, 3
    s_lshl_b32 s50, s50, 1
    v_add_u32 v5, s50, v2
    v_xor_b32 v5, v5, v3
    v_lshlrev_b32 v5, 4, v5
    v_add_u32 v18, v4, v5
    v_add_u32 v126, 106752, v18
    s_add_u32 s50, s33, 3
    s_and_b32 s50, s50, 3
    s_lshl_b32 s50, s50, 1
    v_add_u32 v5, s50, v2
    v_xor_b32 v5, v5, v3
    v_lshlrev_b32 v5, 4, v5
    v_add_u32 v19, v4, v5
    v_add_u32 v127, 106752, v19
    v_lshrrev_b32 v1, 2, v0
    v_and_b32 v1, 3, v1
    v_and_b32 v2, 3, v0
    v_lshrrev_b32 v3, 5, v0
    v_lshrrev_b32 v4, 4, v0
    v_and_b32 v4, 1, v4
    v_lshlrev_b32 v5, 3, v3
    v_add_u32 v5, v5, v1
    v_lshrrev_b32 v6, 1, v1
    v_lshlrev_b32 v7, 3, v2
    v_lshrrev_b32 v8, 1, v2
    v_lshl_add_u32 v8, v4, 1, v8
    v_lshlrev_b32 v9, 2, v6
    v_xor_b32 v8, v8, v9
    v_lshlrev_b32 v8, 4, v8
    v_and_b32 v9, 1, v2
    v_lshl_add_u32 v8, v9, 3, v8
    v_lshl_add_u32 v8, v5, 7, v8
    v_add_u32 v8, 32768, v8
    v_xor_b32 v9, 64, v8
    s_add_u32 s50, s33, 0
    s_and_b32 s50, s50, 3
    s_mul_i32 s51, s50, 2048
    v_add_u32 v20, s51, v8
    v_add_u32 v128, 106752, v20
    s_mul_i32 s51, s50, 2048
    v_add_u32 v24, s51, v9
    v_add_u32 v132, 106752, v24
    s_add_u32 s50, s33, 1
    s_and_b32 s50, s50, 3
    s_mul_i32 s51, s50, 2048
    v_add_u32 v21, s51, v8
    v_add_u32 v129, 106752, v21
    s_mul_i32 s51, s50, 2048
    v_add_u32 v25, s51, v9
    v_add_u32 v133, 106752, v25
    s_add_u32 s50, s33, 2
    s_and_b32 s50, s50, 3
    s_mul_i32 s51, s50, 2048
    v_add_u32 v22, s51, v8
    v_add_u32 v130, 106752, v22
    s_mul_i32 s51, s50, 2048
    v_add_u32 v26, s51, v9
    v_add_u32 v134, 106752, v26
    s_add_u32 s50, s33, 3
    s_and_b32 s50, s50, 3
    s_mul_i32 s51, s50, 2048
    v_add_u32 v23, s51, v8
    v_add_u32 v131, 106752, v23
    s_mul_i32 s51, s50, 2048
    v_add_u32 v27, s51, v9
    v_add_u32 v135, 106752, v27
    s_waitcnt lgkmcnt(0)
    s_sub_u32 s55, s60, 800
    s_xor_b32 s59, s61, 0x5bd1e995
    s_waitcnt vmcnt(7)
    v_lshlrev_b32 v92, 16, v88
    v_and_b32 v93, s58, v88
    v_lshlrev_b32 v94, 16, v89
    v_and_b32 v95, s58, v89
    v_lshlrev_b32 v96, 16, v90
    v_and_b32 v97, s58, v90
    v_lshlrev_b32 v98, 16, v91
    v_and_b32 v99, s58, v91
    v_add_f32 v100, v92, v93
    v_mul_f32 v101, v92, v92
    v_fmac_f32 v101, v93, v93
    v_add_f32 v100, v100, v94
    v_fmac_f32 v101, v94, v94
    v_add_f32 v100, v100, v95
    v_fmac_f32 v101, v95, v95
    v_add_f32 v100, v100, v96
    v_fmac_f32 v101, v96, v96
    v_add_f32 v100, v100, v97
    v_fmac_f32 v101, v97, v97
    v_add_f32 v100, v100, v98
    v_fmac_f32 v101, v98, v98
    v_add_f32 v100, v100, v99
    v_fmac_f32 v101, v99, v99
    s_nop 0
    v_add_f32_dpp v100, v100, v100 row_shr:1 row_mask:0xf bank_mask:0xf bound_ctrl:0
    v_add_f32_dpp v101, v101, v101 row_shr:1 row_mask:0xf bank_mask:0xf bound_ctrl:0
    s_nop 0
    v_add_f32_dpp v100, v100, v100 row_shr:2 row_mask:0xf bank_mask:0xf bound_ctrl:0
    v_add_f32_dpp v101, v101, v101 row_shr:2 row_mask:0xf bank_mask:0xf bound_ctrl:0
    s_nop 0
    v_add_f32_dpp v100, v100, v100 row_shr:4 row_mask:0xf bank_mask:0xf bound_ctrl:0
    v_add_f32_dpp v101, v101, v101 row_shr:4 row_mask:0xf bank_mask:0xf bound_ctrl:0
    s_nop 0
    v_add_f32_dpp v100, v100, v100 row_shr:8 row_mask:0xf bank_mask:0xf bound_ctrl:0
    v_add_f32_dpp v101, v101, v101 row_shr:8 row_mask:0xf bank_mask:0xf bound_ctrl:0
    s_nop 0
    v_add_f32_dpp v100, v100, v100 row_bcast:15 row_mask:0xa bank_mask:0xf
    v_add_f32_dpp v101, v101, v101 row_bcast:15 row_mask:0xa bank_mask:0xf
    s_nop 0
    v_add_f32_dpp v100, v100, v100 row_bcast:31 row_mask:0xc bank_mask:0xf
    v_add_f32_dpp v101, v101, v101 row_bcast:31 row_mask:0xc bank_mask:0xf
    v_mul_f32 v104, 0x3b124925, v100
    v_mul_f32 v101, 0x3b124925, v101
    v_fma_f32 v101, -v104, v104, v101
    v_max_f32 v101, 0, v101
    v_add_f32 v101, 0x3727c5ac, v101
    v_rsq_f32 v105, v101
    s_lshl_b32 s49, s73, 4
    s_add_u32 s49, s49, 12648448
    v_mov_b32 v1, 0
    v_mov_b32 v106, s60
    v_xor_b32 v107, v104, v105
    v_xor_b32 v107, s59, v107
    v_xor_b32 v107, s60, v107
    s_mov_b32 s72, s49
    s_lshl_b32 s74, s44, 7
    s_add_u32 s74, s74, s37
    s_add_u32 m0, s40, 53376
    s_mul_i32 s75, s44, 172032
    buffer_load_dwordx4 v28, s[4:7], s74 offen lds
    s_add_u32 m0, m0, 8192
    s_add_u32 s74, s74, 57344
    buffer_load_dwordx4 v28, s[4:7], s74 offen lds
    s_add_u32 m0, m0, 8192
    s_add_u32 s74, s74, 57344
    buffer_load_dwordx4 v28, s[4:7], s74 offen lds
    s_add_u32 m0, m0, 8192
    s_add_u32 s74, s74, 57344
    buffer_load_dwordx4 v28, s[4:7], s74 offen lds
    s_add_u32 m0, s41, 53376
    s_add_u32 s75, s75, s38
    buffer_load_dwordx4 v29, s[8:11], s75 offen lds
    s_mul_i32 s74, s44, 229376
    s_add_u32 m0, s42, 53376
    s_add_u32 s74, s74, s39
    s_mov_b64 exec, s[56:57]
    buffer_load_dwordx4 v30, s[12:15], s74 offen lds
    s_mov_b64 exec, -1
    s_add_u32 m0, s43, 53376
    s_nop 0
    s_mov_b64 exec, s[56:57]
    buffer_load_dwordx4 v30, s[16:19], s74 offen lds
    s_mov_b64 exec, -1
    s_add_u32 s44, s44, 1
    s_cmp_eq_u32 s44, 7
    s_cselect_b32 s44, 0, s44
    s_mov_b32 s68, 0
    s_mov_b32 s69, 0x80000000
    v_mov_b32 v1, 0
    s_mov_b64 exec, s[68:69]
    buffer_store_dwordx4 v[104:107], v1, s[20:23], s72 offen sc1
    s_mov_b64 exec, -1
    s_waitcnt vmcnt(8)
    s_barrier
    ds_read_b128 v[48:51], v16 offset:0
    ds_read_b64_tr_b16 v[56:57], v20 offset:0
    ds_read_b64_tr_b16 v[58:59], v20 offset:512
    ds_read_b128 v[52:55], v16 offset:4096
    ds_read_b64_tr_b16 v[60:61], v24 offset:0
    ds_read_b64_tr_b16 v[62:63], v24 offset:512
    s_waitcnt lgkmcnt(0)
    v_mfma_f32_32x32x16_bf16 v[160:175], v[48:51], v[56:59], 0
    ds_read_b128 v[68:71], v17 offset:0
    ds_read_b64_tr_b16 v[76:77], v21 offset:0
    s_lshl_b32 s45, s44, 7
    s_mul_i32 s46, s44, 172032
    s_mul_i32 s47, s44, 229376
    s_add_u32 s45, s45, s37
    s_add_u32 s46, s46, s38
    s_add_u32 s47, s47, s39
    s_add_u32 s44, s44, 1
    s_cmp_eq_u32 s44, 7
    s_cselect_b32 s44, 0, s44
    s_add_u32 m0, s40, 106752
    s_nop 0
    buffer_load_dwordx4 v28, s[4:7], s45 offen lds
    s_add_u32 m0, s40, 110848
    s_add_u32 s74, s45, 28672
    buffer_load_dwordx4 v28, s[4:7], s74 offen lds
    v_lshlrev_b32 v38, 16, v56
    v_and_b32 v39, s58, v56
    v_add_f32 v32, 0, v38
    v_add_f32 v33, 0, v39
    v_mfma_f32_32x32x16_bf16 v[176:191], v[52:55], v[56:59], 0
    ds_read_b64_tr_b16 v[78:79], v21 offset:512
    ds_read_b128 v[72:75], v17 offset:4096
    s_add_u32 m0, s40, 114944
    s_add_u32 s74, s45, 57344
    buffer_load_dwordx4 v28, s[4:7], s74 offen lds
    v_lshlrev_b32 v40, 16, v57
    v_and_b32 v41, s58, v57
    v_add_f32 v32, v32, v40
    v_add_f32 v33, v33, v41
    v_mfma_f32_32x32x16_bf16 v[192:207], v[48:51], v[60:63], 0
    ds_read_b64_tr_b16 v[80:81], v25 offset:0
    ds_read_b64_tr_b16 v[82:83], v25 offset:512
    s_add_u32 m0, s40, 119040
    s_add_u32 s74, s45, 86016
    buffer_load_dwordx4 v28, s[4:7], s74 offen lds
    v_lshlrev_b32 v38, 16, v58
    v_and_b32 v39, s58, v58
    v_add_f32 v32, v32, v38
    v_add_f32 v33, v33, v39
    v_mfma_f32_32x32x16_bf16 v[208:223], v[52:55], v[60:63], 0
    s_add_u32 m0, s40, 123136
    s_add_u32 s74, s45, 114688
    buffer_load_dwordx4 v28, s[4:7], s74 offen lds
    v_lshlrev_b32 v40, 16, v59
    v_and_b32 v41, s58, v59
    v_add_f32 v32, v32, v40
    v_add_f32 v33, v33, v41
    s_waitcnt lgkmcnt(0)
    v_mfma_f32_32x32x16_bf16 v[160:175], v[68:71], v[76:79], v[160:175]
    ds_read_b128 v[48:51], v18 offset:0
    ds_read_b64_tr_b16 v[56:57], v22 offset:0
    s_add_u32 m0, s40, 127232
    s_add_u32 s74, s45, 143360
    buffer_load_dwordx4 v28, s[4:7], s74 offen lds
    v_lshlrev_b32 v38, 16, v80
    v_and_b32 v39, s58, v80
    v_add_f32 v34, 0, v38
    v_add_f32 v35, 0, v39
    v_mfma_f32_32x32x16_bf16 v[176:191], v[72:75], v[76:79], v[176:191]
    ds_read_b64_tr_b16 v[58:59], v22 offset:512
    ds_read_b128 v[52:55], v18 offset:4096
    s_add_u32 m0, s40, 131328
    s_add_u32 s74, s45, 172032
    buffer_load_dwordx4 v28, s[4:7], s74 offen lds
    v_lshlrev_b32 v40, 16, v81
    v_and_b32 v41, s58, v81
    v_add_f32 v34, v34, v40
    v_add_f32 v35, v35, v41
    v_mfma_f32_32x32x16_bf16 v[192:207], v[68:71], v[80:83], v[192:207]
    ds_read_b64_tr_b16 v[60:61], v26 offset:0
    ds_read_b64_tr_b16 v[62:63], v26 offset:512
    s_add_u32 m0, s40, 135424
    s_add_u32 s74, s45, 200704
    buffer_load_dwordx4 v28, s[4:7], s74 offen lds
    s_add_u32 m0, s41, 106752
    s_nop 0
    buffer_load_dwordx4 v29, s[8:11], s46 offen lds
    v_lshlrev_b32 v38, 16, v82
    v_and_b32 v39, s58, v82
    v_add_f32 v34, v34, v38
    v_add_f32 v35, v35, v39
    v_mfma_f32_32x32x16_bf16 v[208:223], v[72:75], v[80:83], v[208:223]
    s_add_u32 m0, s41, 110848
    s_add_u32 s74, s46, 86016
    buffer_load_dwordx4 v29, s[8:11], s74 offen lds
    v_lshlrev_b32 v40, 16, v83
    v_and_b32 v41, s58, v83
    v_add_f32 v34, v34, v40
    v_add_f32 v35, v35, v41
    s_waitcnt lgkmcnt(0)
    v_mfma_f32_32x32x16_bf16 v[160:175], v[48:51], v[56:59], v[160:175]
    ds_read_b128 v[68:71], v19 offset:0
    ds_read_b64_tr_b16 v[76:77], v23 offset:0
    s_add_u32 m0, s42, 106752
    s_mov_b64 exec, s[56:57]
    buffer_load_dwordx4 v30, s[12:15], s47 offen lds
    s_mov_b64 exec, -1
    v_mfma_f32_32x32x16_bf16 v[176:191], v[52:55], v[56:59], v[176:191]
    ds_read_b64_tr_b16 v[78:79], v23 offset:512
    ds_read_b128 v[72:75], v19 offset:4096
    s_add_u32 m0, s43, 106752
    s_mov_b64 exec, s[56:57]
    buffer_load_dwordx4 v30, s[16:19], s47 offen lds
    s_mov_b64 exec, -1
    v_add_f32 v32, v32, v33
    v_add_f32 v34, v34, v35
    v_mov_b32 v33, v32
    v_mov_b32 v35, v34
    s_nop 1
    v_permlane32_swap_b32 v32, v33
    v_permlane32_swap_b32 v34, v35
    v_mfma_f32_32x32x16_bf16 v[192:207], v[48:51], v[60:63], v[192:207]
    ds_read_b64_tr_b16 v[80:81], v27 offset:0
    ds_read_b64_tr_b16 v[82:83], v27 offset:512
    s_add_u32 m0, s42, 109824
    s_add_u32 s74, s47, 114688
    s_mov_b64 exec, s[56:57]
    buffer_load_dwordx4 v30, s[12:15], s74 offen lds
    s_mov_b64 exec, -1
    v_and_b32 v1, 31, v0
    v_lshlrev_b32 v1, 2, v1
    s_mul_i32 s49, s33, 640
    s_add_u32 s49, s49, 160128
    v_add_u32 v1, s49, v1
    v_add_f32 v32, v32, v33
    v_add_f32 v34, v34, v35
    ds_write_b32 v1, v32 offset:0
    ds_write_b32 v1, v34 offset:128
    v_mfma_f32_32x32x16_bf16 v[208:223], v[52:55], v[60:63], v[208:223]
    s_add_u32 m0, s43, 109824
    s_add_u32 s74, s47, 114688
    s_mov_b64 exec, s[56:57]
    buffer_load_dwordx4 v30, s[16:19], s74 offen lds
    s_mov_b64 exec, -1
    s_waitcnt lgkmcnt(0)
    s_waitcnt vmcnt(15)
    s_barrier
    v_mfma_f32_32x32x16_bf16 v[160:175], v[68:71], v[76:79], v[160:175]
    ds_read_b128 v[48:51], v16 offset:53376
    ds_read_b64_tr_b16 v[56:57], v20 offset:53376
    s_lshl_b32 s45, s44, 7
    s_mul_i32 s46, s44, 172032
    s_mul_i32 s47, s44, 229376
    s_add_u32 s45, s45, s37
    s_add_u32 s46, s46, s38
    s_add_u32 s47, s47, s39
    s_add_u32 s44, s44, 1
    s_cmp_eq_u32 s44, 7
    s_cselect_b32 s44, 0, s44
    s_add_u32 m0, s40, 0
    s_nop 0
    buffer_load_dwordx4 v28, s[4:7], s45 offen lds
    v_mfma_f32_32x32x16_bf16 v[176:191], v[72:75], v[76:79], v[176:191]
    ds_read_b64_tr_b16 v[58:59], v20 offset:53888
    ds_read_b128 v[52:55], v16 offset:57472
    s_add_u32 m0, s40, 4096
    s_add_u32 s74, s45, 28672
    buffer_load_dwordx4 v28, s[4:7], s74 offen lds
    v_mfma_f32_32x32x16_bf16 v[192:207], v[68:71], v[80:83], v[192:207]
    ds_read_b64_tr_b16 v[60:61], v24 offset:53376
    ds_read_b64_tr_b16 v[62:63], v24 offset:53888
    s_add_u32 m0, s40, 8192
    s_add_u32 s74, s45, 57344
    buffer_load_dwordx4 v28, s[4:7], s74 offen lds
    v_mfma_f32_32x32x16_bf16 v[208:223], v[72:75], v[80:83], v[208:223]
    s_add_u32 m0, s40, 12288
    s_add_u32 s74, s45, 86016
    buffer_load_dwordx4 v28, s[4:7], s74 offen lds
    s_waitcnt lgkmcnt(0)
    v_mfma_f32_32x32x16_bf16 v[160:175], v[48:51], v[56:59], v[160:175]
    ds_read_b128 v[68:71], v17 offset:53376
    ds_read_b64_tr_b16 v[76:77], v21 offset:53376
    s_add_u32 m0, s40, 16384
    s_add_u32 s74, s45, 114688
    buffer_load_dwordx4 v28, s[4:7], s74 offen lds
    v_mfma_f32_32x32x16_bf16 v[176:191], v[52:55], v[56:59], v[176:191]
    ds_read_b64_tr_b16 v[78:79], v21 offset:53888
    ds_read_b128 v[72:75], v17 offset:57472
    s_add_u32 m0, s40, 20480
    s_add_u32 s74, s45, 143360
    buffer_load_dwordx4 v28, s[4:7], s74 offen lds
    v_mfma_f32_32x32x16_bf16 v[192:207], v[48:51], v[60:63], v[192:207]
    ds_read_b64_tr_b16 v[80:81], v25 offset:53376
    ds_read_b64_tr_b16 v[82:83], v25 offset:53888
    s_add_u32 m0, s40, 24576
    s_add_u32 s74, s45, 172032
    buffer_load_dwordx4 v28, s[4:7], s74 offen lds
    v_mfma_f32_32x32x16_bf16 v[208:223], v[52:55], v[60:63], v[208:223]
    s_add_u32 m0, s40, 28672
    s_add_u32 s74, s45, 200704
    buffer_load_dwordx4 v28, s[4:7], s74 offen lds
    s_waitcnt lgkmcnt(0)
    v_mfma_f32_32x32x16_bf16 v[160:175], v[68:71], v[76:79], v[160:175]
    ds_read_b128 v[48:51], v18 offset:53376
    ds_read_b64_tr_b16 v[56:57], v22 offset:53376
    s_add_u32 m0, s41, 0
    s_nop 0
    buffer_load_dwordx4 v29, s[8:11], s46 offen lds
    v_mfma_f32_32x32x16_bf16 v[176:191], v[72:75], v[76:79], v[176:191]
    ds_read_b64_tr_b16 v[58:59], v22 offset:53888
    ds_read_b128 v[52:55], v18 offset:57472
    s_add_u32 m0, s41, 4096
    s_add_u32 s74, s46, 86016
    buffer_load_dwordx4 v29, s[8:11], s74 offen lds
    v_mfma_f32_32x32x16_bf16 v[192:207], v[68:71], v[80:83], v[192:207]
    ds_read_b64_tr_b16 v[60:61], v26 offset:53376
    ds_read_b64_tr_b16 v[62:63], v26 offset:53888
    s_add_u32 m0, s42, 0
    s_mov_b64 exec, s[56:57]
    buffer_load_dwordx4 v30, s[12:15], s47 offen lds
    s_mov_b64 exec, -1
    v_mfma_f32_32x32x16_bf16 v[208:223], v[72:75], v[80:83], v[208:223]
    s_add_u32 m0, s43, 0
    s_mov_b64 exec, s[56:57]
    buffer_load_dwordx4 v30, s[16:19], s47 offen lds
    s_mov_b64 exec, -1
    s_waitcnt lgkmcnt(0)
    v_mfma_f32_32x32x16_bf16 v[160:175], v[48:51], v[56:59], v[160:175]
    ds_read_b128 v[68:71], v19 offset:53376
    ds_read_b64_tr_b16 v[76:77], v23 offset:53376
    s_add_u32 m0, s42, 3072
    s_add_u32 s74, s47, 114688
    s_mov_b64 exec, s[56:57]
    buffer_load_dwordx4 v30, s[12:15], s74 offen lds
    s_mov_b64 exec, -1
    v_mfma_f32_32x32x16_bf16 v[176:191], v[52:55], v[56:59], v[176:191]
    ds_read_b64_tr_b16 v[78:79], v23 offset:53888
    ds_read_b128 v[72:75], v19 offset:57472
    s_add_u32 m0, s43, 3072
    s_add_u32 s74, s47, 114688
    s_mov_b64 exec, s[56:57]
    buffer_load_dwordx4 v30, s[16:19], s74 offen lds
    s_mov_b64 exec, -1
    v_mfma_f32_32x32x16_bf16 v[192:207], v[48:51], v[60:63], v[192:207]
    ds_read_b64_tr_b16 v[80:81], v27 offset:53376
    ds_read_b64_tr_b16 v[82:83], v27 offset:53888
    v_mfma_f32_32x32x16_bf16 v[208:223], v[52:55], v[60:63], v[208:223]
    s_waitcnt lgkmcnt(0)
    s_waitcnt vmcnt(14)
    s_barrier
    v_mfma_f32_32x32x16_bf16 v[160:175], v[68:71], v[76:79], v[160:175]
    ds_read_b128 v[48:51], v124 offset:0
    ds_read_b64_tr_b16 v[56:57], v128 offset:0
    s_lshl_b32 s45, s44, 7
    s_mul_i32 s46, s44, 172032
    s_mul_i32 s47, s44, 229376
    s_add_u32 s45, s45, s37
    s_add_u32 s46, s46, s38
    s_add_u32 s47, s47, s39
    s_add_u32 s44, s44, 1
    s_cmp_eq_u32 s44, 7
    s_cselect_b32 s44, 0, s44
    s_add_u32 m0, s40, 53376
    s_nop 0
    buffer_load_dwordx4 v28, s[4:7], s45 offen lds
    v_mfma_f32_32x32x16_bf16 v[176:191], v[72:75], v[76:79], v[176:191]
    ds_read_b64_tr_b16 v[58:59], v128 offset:512
    ds_read_b128 v[52:55], v124 offset:4096
    s_add_u32 m0, s40, 57472
    s_add_u32 s74, s45, 28672
    buffer_load_dwordx4 v28, s[4:7], s74 offen lds
    v_mfma_f32_32x32x16_bf16 v[192:207], v[68:71], v[80:83], v[192:207]
    ds_read_b64_tr_b16 v[60:61], v132 offset:0
    ds_read_b64_tr_b16 v[62:63], v132 offset:512
    s_add_u32 m0, s40, 61568
    s_add_u32 s74, s45, 57344
    buffer_load_dwordx4 v28, s[4:7], s74 offen lds
    v_mfma_f32_32x32x16_bf16 v[208:223], v[72:75], v[80:83], v[208:223]
    s_add_u32 m0, s40, 65664
    s_add_u32 s74, s45, 86016
    buffer_load_dwordx4 v28, s[4:7], s74 offen lds
    s_waitcnt lgkmcnt(0)
    v_mfma_f32_32x32x16_bf16 v[160:175], v[48:51], v[56:59], v[160:175]
    ds_read_b128 v[68:71], v125 offset:0
    ds_read_b64_tr_b16 v[76:77], v129 offset:0
    s_add_u32 m0, s40, 69760
    s_add_u32 s74, s45, 114688
    buffer_load_dwordx4 v28, s[4:7], s74 offen lds
    v_mfma_f32_32x32x16_bf16 v[176:191], v[52:55], v[56:59], v[176:191]
    ds_read_b64_tr_b16 v[78:79], v129 offset:512
    ds_read_b128 v[72:75], v125 offset:4096
    s_add_u32 m0, s40, 73856
    s_add_u32 s74, s45, 143360
    buffer_load_dwordx4 v28, s[4:7], s74 offen lds
    v_mfma_f32_32x32x16_bf16 v[192:207], v[48:51], v[60:63], v[192:207]
    ds_read_b64_tr_b16 v[80:81], v133 offset:0
    ds_read_b64_tr_b16 v[82:83], v133 offset:512
    s_add_u32 m0, s40, 77952
    s_add_u32 s74, s45, 172032
    buffer_load_dwordx4 v28, s[4:7], s74 offen lds
    v_mfma_f32_32x32x16_bf16 v[208:223], v[52:55], v[60:63], v[208:223]
    s_add_u32 m0, s40, 82048
    s_add_u32 s74, s45, 200704
    buffer_load_dwordx4 v28, s[4:7], s74 offen lds
    s_waitcnt lgkmcnt(0)
    v_mfma_f32_32x32x16_bf16 v[160:175], v[68:71], v[76:79], v[160:175]
    ds_read_b128 v[48:51], v126 offset:0
    ds_read_b64_tr_b16 v[56:57], v130 offset:0
    s_add_u32 m0, s41, 53376
    s_nop 0
    buffer_load_dwordx4 v29, s[8:11], s46 offen lds
    v_mfma_f32_32x32x16_bf16 v[176:191], v[72:75], v[76:79], v[176:191]
    ds_read_b64_tr_b16 v[58:59], v130 offset:512
    ds_read_b128 v[52:55], v126 offset:4096
    s_add_u32 m0, s41, 57472
    s_add_u32 s74, s46, 86016
    buffer_load_dwordx4 v29, s[8:11], s74 offen lds
    v_mfma_f32_32x32x16_bf16 v[192:207], v[68:71], v[80:83], v[192:207]
    ds_read_b64_tr_b16 v[60:61], v134 offset:0
    ds_read_b64_tr_b16 v[62:63], v134 offset:512
    s_add_u32 m0, s42, 53376
    s_mov_b64 exec, s[56:57]
    buffer_load_dwordx4 v30, s[12:15], s47 offen lds
    s_mov_b64 exec, -1
    v_mfma_f32_32x32x16_bf16 v[208:223], v[72:75], v[80:83], v[208:223]
    s_add_u32 m0, s43, 53376
    s_mov_b64 exec, s[56:57]
    buffer_load_dwordx4 v30, s[16:19], s47 offen lds
    s_mov_b64 exec, -1
    s_waitcnt lgkmcnt(0)
    v_mfma_f32_32x32x16_bf16 v[160:175], v[48:51], v[56:59], v[160:175]
    ds_read_b128 v[68:71], v127 offset:0
    ds_read_b64_tr_b16 v[76:77], v131 offset:0
    s_add_u32 m0, s42, 56448
    s_add_u32 s74, s47, 114688
    s_mov_b64 exec, s[56:57]
    buffer_load_dwordx4 v30, s[12:15], s74 offen lds
    s_mov_b64 exec, -1
    v_mfma_f32_32x32x16_bf16 v[176:191], v[52:55], v[56:59], v[176:191]
    ds_read_b64_tr_b16 v[78:79], v131 offset:512
    ds_read_b128 v[72:75], v127 offset:4096
    s_add_u32 m0, s43, 56448
    s_add_u32 s74, s47, 114688
    s_mov_b64 exec, s[56:57]
    buffer_load_dwordx4 v30, s[16:19], s74 offen lds
    s_mov_b64 exec, -1
    v_mfma_f32_32x32x16_bf16 v[192:207], v[48:51], v[60:63], v[192:207]
    ds_read_b64_tr_b16 v[80:81], v135 offset:0
    ds_read_b64_tr_b16 v[82:83], v135 offset:512
    v_mfma_f32_32x32x16_bf16 v[208:223], v[52:55], v[60:63], v[208:223]
    s_waitcnt lgkmcnt(0)
    s_waitcnt vmcnt(14)
    s_barrier
    v_mfma_f32_32x32x16_bf16 v[160:175], v[68:71], v[76:79], v[160:175]
    ds_read_b128 v[48:51], v16 offset:0
    ds_read_b64_tr_b16 v[56:57], v20 offset:0
    s_lshl_b32 s45, s44, 7
    s_mul_i32 s46, s44, 172032
    s_mul_i32 s47, s44, 229376
    s_add_u32 s45, s45, s37
    s_add_u32 s46, s46, s38
    s_add_u32 s47, s47, s39
    s_add_u32 s44, s44, 1
    s_cmp_eq_u32 s44, 7
    s_cselect_b32 s44, 0, s44
    s_add_u32 m0, s40, 106752
    s_nop 0
    buffer_load_dwordx4 v28, s[4:7], s45 offen lds
    v_mfma_f32_32x32x16_bf16 v[176:191], v[72:75], v[76:79], v[176:191]
    ds_read_b64_tr_b16 v[58:59], v20 offset:512
    ds_read_b128 v[52:55], v16 offset:4096
    s_add_u32 m0, s40, 110848
    s_add_u32 s74, s45, 28672
    buffer_load_dwordx4 v28, s[4:7], s74 offen lds
    v_mfma_f32_32x32x16_bf16 v[192:207], v[68:71], v[80:83], v[192:207]
    ds_read_b64_tr_b16 v[60:61], v24 offset:0
    ds_read_b64_tr_b16 v[62:63], v24 offset:512
    s_add_u32 m0, s40, 114944
    s_add_u32 s74, s45, 57344
    buffer_load_dwordx4 v28, s[4:7], s74 offen lds
    v_mfma_f32_32x32x16_bf16 v[208:223], v[72:75], v[80:83], v[208:223]
    s_add_u32 m0, s40, 119040
    s_add_u32 s74, s45, 86016
    buffer_load_dwordx4 v28, s[4:7], s74 offen lds
    s_waitcnt lgkmcnt(0)
    v_mfma_f32_32x32x16_bf16 v[160:175], v[48:51], v[56:59], v[160:175]
    ds_read_b128 v[68:71], v17 offset:0
    ds_read_b64_tr_b16 v[76:77], v21 offset:0
    s_add_u32 m0, s40, 123136
    s_add_u32 s74, s45, 114688
    buffer_load_dwordx4 v28, s[4:7], s74 offen lds
    v_mfma_f32_32x32x16_bf16 v[176:191], v[52:55], v[56:59], v[176:191]
    ds_read_b64_tr_b16 v[78:79], v21 offset:512
    ds_read_b128 v[72:75], v17 offset:4096
    s_add_u32 m0, s40, 127232
    s_add_u32 s74, s45, 143360
    buffer_load_dwordx4 v28, s[4:7], s74 offen lds
    v_mfma_f32_32x32x16_bf16 v[192:207], v[48:51], v[60:63], v[192:207]
    ds_read_b64_tr_b16 v[80:81], v25 offset:0
    ds_read_b64_tr_b16 v[82:83], v25 offset:512
    s_add_u32 m0, s40, 131328
    s_add_u32 s74, s45, 172032
    buffer_load_dwordx4 v28, s[4:7], s74 offen lds
    v_mfma_f32_32x32x16_bf16 v[208:223], v[52:55], v[60:63], v[208:223]
    s_add_u32 m0, s40, 135424
    s_add_u32 s74, s45, 200704
    buffer_load_dwordx4 v28, s[4:7], s74 offen lds
    s_waitcnt lgkmcnt(0)
    v_mfma_f32_32x32x16_bf16 v[160:175], v[68:71], v[76:79], v[160:175]
    ds_read_b128 v[48:51], v18 offset:0
    ds_read_b64_tr_b16 v[56:57], v22 offset:0
    s_add_u32 m0, s41, 106752
    s_nop 0
    buffer_load_dwordx4 v29, s[8:11], s46 offen lds
    v_mfma_f32_32x32x16_bf16 v[176:191], v[72:75], v[76:79], v[176:191]
    ds_read_b64_tr_b16 v[58:59], v22 offset:512
    ds_read_b128 v[52:55], v18 offset:4096
    s_add_u32 m0, s41, 110848
    s_add_u32 s74, s46, 86016
    buffer_load_dwordx4 v29, s[8:11], s74 offen lds
    v_mfma_f32_32x32x16_bf16 v[192:207], v[68:71], v[80:83], v[192:207]
    ds_read_b64_tr_b16 v[60:61], v26 offset:0
    ds_read_b64_tr_b16 v[62:63], v26 offset:512
    s_add_u32 m0, s42, 106752
    s_mov_b64 exec, s[56:57]
    buffer_load_dwordx4 v30, s[12:15], s47 offen lds
    s_mov_b64 exec, -1
    v_mfma_f32_32x32x16_bf16 v[208:223], v[72:75], v[80:83], v[208:223]
    s_add_u32 m0, s43, 106752
    s_mov_b64 exec, s[56:57]
    buffer_load_dwordx4 v30, s[16:19], s47 offen lds
    s_mov_b64 exec, -1
    s_waitcnt lgkmcnt(0)
    v_mfma_f32_32x32x16_bf16 v[160:175], v[48:51], v[56:59], v[160:175]
    ds_read_b128 v[68:71], v19 offset:0
    ds_read_b64_tr_b16 v[76:77], v23 offset:0
    s_add_u32 m0, s42, 109824
    s_add_u32 s74, s47, 114688
    s_mov_b64 exec, s[56:57]
    buffer_load_dwordx4 v30, s[12:15], s74 offen lds
    s_mov_b64 exec, -1
    v_mfma_f32_32x32x16_bf16 v[176:191], v[52:55], v[56:59], v[176:191]
    ds_read_b64_tr_b16 v[78:79], v23 offset:512
    ds_read_b128 v[72:75], v19 offset:4096
    s_add_u32 m0, s43, 109824
    s_add_u32 s74, s47, 114688
    s_mov_b64 exec, s[56:57]
    buffer_load_dwordx4 v30, s[16:19], s74 offen lds
    s_mov_b64 exec, -1
    v_mfma_f32_32x32x16_bf16 v[192:207], v[48:51], v[60:63], v[192:207]
    ds_read_b64_tr_b16 v[80:81], v27 offset:0
    ds_read_b64_tr_b16 v[82:83], v27 offset:512
    v_mfma_f32_32x32x16_bf16 v[208:223], v[52:55], v[60:63], v[208:223]
    s_waitcnt lgkmcnt(0)
    s_waitcnt vmcnt(14)
    s_barrier
    v_mfma_f32_32x32x16_bf16 v[160:175], v[68:71], v[76:79], v[160:175]
    ds_read_b128 v[48:51], v16 offset:53376
    ds_read_b64_tr_b16 v[56:57], v20 offset:53376
    s_lshl_b32 s45, s44, 7
    s_mul_i32 s46, s44, 172032
    s_mul_i32 s47, s44, 229376
    s_add_u32 s45, s45, s37
    s_add_u32 s46, s46, s38
    s_add_u32 s47, s47, s39
    s_add_u32 s44, s44, 1
    s_cmp_eq_u32 s44, 7
    s_cselect_b32 s44, 0, s44
    s_add_u32 m0, s40, 0
    s_nop 0
    buffer_load_dwordx4 v28, s[4:7], s45 offen lds
    s_lshl_b32 s49, s34, 12
    s_lshl_b32 s50, s32, 10
    s_add_u32 s49, s49, s50
    s_add_u32 s49, s49, 12648448
    buffer_load_dwordx4 v[96:99], v31, s[20:23], s49 offen sc1
    v_mfma_f32_32x32x16_bf16 v[176:191], v[72:75], v[76:79], v[176:191]
    ds_read_b64_tr_b16 v[58:59], v20 offset:53888
    ds_read_b128 v[52:55], v16 offset:57472
    s_add_u32 m0, s40, 4096
    s_add_u32 s74, s45, 28672
    buffer_load_dwordx4 v28, s[4:7], s74 offen lds
    s_mul_i32 s49, s36, 8960
    s_lshl_b32 s50, s32, 10
    s_add_u32 s49, s49, s50
    s_add_u32 s49, s49, 12718080
    buffer_load_dwordx4 v[100:103], v31, s[20:23], s49 offen sc1
    v_mfma_f32_32x32x16_bf16 v[192:207], v[68:71], v[80:83], v[192:207]
    ds_read_b64_tr_b16 v[60:61], v24 offset:53376
    ds_read_b64_tr_b16 v[62:63], v24 offset:53888
    s_add_u32 m0, s40, 8192
    s_add_u32 s74, s45, 57344
    buffer_load_dwordx4 v28, s[4:7], s74 offen lds
    v_mfma_f32_32x32x16_bf16 v[208:223], v[72:75], v[80:83], v[208:223]
    s_add_u32 m0, s40, 12288
    s_add_u32 s74, s45, 86016
    buffer_load_dwordx4 v28, s[4:7], s74 offen lds
    s_waitcnt lgkmcnt(0)
    v_mfma_f32_32x32x16_bf16 v[160:175], v[48:51], v[56:59], v[160:175]
    ds_read_b128 v[68:71], v17 offset:53376
    ds_read_b64_tr_b16 v[76:77], v21 offset:53376
    s_add_u32 m0, s40, 16384
    s_add_u32 s74, s45, 114688
    buffer_load_dwordx4 v28, s[4:7], s74 offen lds
    v_mfma_f32_32x32x16_bf16 v[176:191], v[52:55], v[56:59], v[176:191]
    ds_read_b64_tr_b16 v[78:79], v21 offset:53888
    ds_read_b128 v[72:75], v17 offset:57472
    s_add_u32 m0, s40, 20480
    s_add_u32 s74, s45, 143360
    buffer_load_dwordx4 v28, s[4:7], s74 offen lds
    v_mfma_f32_32x32x16_bf16 v[192:207], v[48:51], v[60:63], v[192:207]
    ds_read_b64_tr_b16 v[80:81], v25 offset:53376
    ds_read_b64_tr_b16 v[82:83], v25 offset:53888
    s_add_u32 m0, s40, 24576
    s_add_u32 s74, s45, 172032
    buffer_load_dwordx4 v28, s[4:7], s74 offen lds
    v_mfma_f32_32x32x16_bf16 v[208:223], v[52:55], v[60:63], v[208:223]
    s_add_u32 m0, s40, 28672
    s_add_u32 s74, s45, 200704
    buffer_load_dwordx4 v28, s[4:7], s74 offen lds
    s_waitcnt lgkmcnt(0)
    v_mfma_f32_32x32x16_bf16 v[160:175], v[68:71], v[76:79], v[160:175]
    ds_read_b128 v[48:51], v18 offset:53376
    ds_read_b64_tr_b16 v[56:57], v22 offset:53376
    s_add_u32 m0, s41, 0
    s_nop 0
    buffer_load_dwordx4 v29, s[8:11], s46 offen lds
    v_mfma_f32_32x32x16_bf16 v[176:191], v[72:75], v[76:79], v[176:191]
    ds_read_b64_tr_b16 v[58:59], v22 offset:53888
    ds_read_b128 v[52:55], v18 offset:57472
    s_add_u32 m0, s41, 4096
    s_add_u32 s74, s46, 86016
    buffer_load_dwordx4 v29, s[8:11], s74 offen lds
    v_mfma_f32_32x32x16_bf16 v[192:207], v[68:71], v[80:83], v[192:207]
    ds_read_b64_tr_b16 v[60:61], v26 offset:53376
    ds_read_b64_tr_b16 v[62:63], v26 offset:53888
    s_add_u32 m0, s42, 0
    s_mov_b64 exec, s[56:57]
    buffer_load_dwordx4 v30, s[12:15], s47 offen lds
    s_mov_b64 exec, -1
    v_mfma_f32_32x32x16_bf16 v[208:223], v[72:75], v[80:83], v[208:223]
    s_add_u32 m0, s43, 0
    s_mov_b64 exec, s[56:57]
    buffer_load_dwordx4 v30, s[16:19], s47 offen lds
    s_mov_b64 exec, -1
    s_waitcnt lgkmcnt(0)
    v_mfma_f32_32x32x16_bf16 v[160:175], v[48:51], v[56:59], v[160:175]
    ds_read_b128 v[68:71], v19 offset:53376
    ds_read_b64_tr_b16 v[76:77], v23 offset:53376
    s_add_u32 m0, s42, 3072
    s_add_u32 s74, s47, 114688
    s_mov_b64 exec, s[56:57]
    buffer_load_dwordx4 v30, s[12:15], s74 offen lds
    s_mov_b64 exec, -1
    v_mfma_f32_32x32x16_bf16 v[176:191], v[52:55], v[56:59], v[176:191]
    ds_read_b64_tr_b16 v[78:79], v23 offset:53888
    ds_read_b128 v[72:75], v19 offset:57472
    s_add_u32 m0, s43, 3072
    s_add_u32 s74, s47, 114688
    s_mov_b64 exec, s[56:57]
    buffer_load_dwordx4 v30, s[16:19], s74 offen lds
    s_mov_b64 exec, -1
    v_mfma_f32_32x32x16_bf16 v[192:207], v[48:51], v[60:63], v[192:207]
    ds_read_b64_tr_b16 v[80:81], v27 offset:53376
    ds_read_b64_tr_b16 v[82:83], v27 offset:53888
    v_mfma_f32_32x32x16_bf16 v[208:223], v[52:55], v[60:63], v[208:223]
    s_waitcnt lgkmcnt(0)
    s_waitcnt vmcnt(16)
    s_barrier
    v_mfma_f32_32x32x16_bf16 v[160:175], v[68:71], v[76:79], v[160:175]
    ds_read_b128 v[48:51], v124 offset:0
    ds_read_b64_tr_b16 v[56:57], v128 offset:0
    s_lshr_b32 s53, s2, 3
    s_lshl_b32 s53, s53, 3
    s_add_u32 s53, s53, s32
    v_lshlrev_b32 v32, 7, v0
    s_cmp_lt_u32 s53, 196
    s_cselect_b32 s64, s24, s80
    s_cselect_b32 s65, s25, s81
    s_mov_b32 s66, 401408
    s_cselect_b32 s66, 1605632, s66
    s_mov_b32 s67, 0x20000
    s_cselect_b32 s54, 0, 196
    s_sub_u32 s53, s53, s54
    s_lshl_b32 s53, s53, 13
    v_add_u32 v32, s53, v32
    v_mfma_f32_32x32x16_bf16 v[176:191], v[72:75], v[76:79], v[176:191]
    ds_read_b64_tr_b16 v[58:59], v128 offset:512
    ds_read_b128 v[52:55], v124 offset:4096
    s_mov_b32 exec_lo, 0xffffffff
    s_mov_b32 exec_hi, 0xffffffff
    buffer_load_dword v33, v32, s[64:67], 0 offen
    s_mov_b64 exec, -1
    v_mfma_f32_32x32x16_bf16 v[192:207], v[68:71], v[80:83], v[192:207]
    ds_read_b64_tr_b16 v[60:61], v132 offset:0
    ds_read_b64_tr_b16 v[62:63], v132 offset:512
    v_mfma_f32_32x32x16_bf16 v[208:223], v[72:75], v[80:83], v[208:223]
    s_waitcnt lgkmcnt(0)
    v_mfma_f32_32x32x16_bf16 v[160:175], v[48:51], v[56:59], v[160:175]
    ds_read_b128 v[68:71], v125 offset:0
    ds_read_b64_tr_b16 v[76:77], v129 offset:0
    s_mov_b64 s[70:71], -1
    s_mov_b32 s78, 0
    s_waitcnt vmcnt(13)
    v_mfma_f32_32x32x16_bf16 v[176:191], v[52:55], v[56:59], v[176:191]
    ds_read_b64_tr_b16 v[78:79], v129 offset:512
    ds_read_b128 v[72:75], v125 offset:4096
    v_xor_b32 v108, v96, v97
    v_xor_b32 v108, s59, v108
    v_mfma_f32_32x32x16_bf16 v[192:207], v[48:51], v[60:63], v[192:207]
    ds_read_b64_tr_b16 v[80:81], v133 offset:0
    ds_read_b64_tr_b16 v[82:83], v133 offset:512
    v_xor_b32 v108, v98, v108
    v_subrev_u32 v109, s55, v98
    v_mfma_f32_32x32x16_bf16 v[208:223], v[52:55], v[60:63], v[208:223]
    v_cmp_eq_u32 vcc, v108, v99
    v_cmp_gt_u32_e64 s[68:69], s79, v109
    s_waitcnt lgkmcnt(0)
    v_mfma_f32_32x32x16_bf16 v[160:175], v[68:71], v[76:79], v[160:175]
    ds_read_b128 v[48:51], v126 offset:0
    ds_read_b64_tr_b16 v[56:57], v130 offset:0
    s_nop 1
    s_and_b64 s[68:69], s[68:69], vcc
    v_mfma_f32_32x32x16_bf16 v[176:191], v[72:75], v[76:79], v[176:191]
    ds_read_b64_tr_b16 v[58:59], v130 offset:512
    ds_read_b128 v[52:55], v126 offset:4096
    v_xor_b32 v110, v100, v101
    v_xor_b32 v110, s59, v110
    v_mfma_f32_32x32x16_bf16 v[192:207], v[68:71], v[80:83], v[192:207]
    ds_read_b64_tr_b16 v[60:61], v134 offset:0
    ds_read_b64_tr_b16 v[62:63], v134 offset:512
    v_xor_b32 v110, v102, v110
    v_subrev_u32 v111, s55, v102
    v_mfma_f32_32x32x16_bf16 v[208:223], v[72:75], v[80:83], v[208:223]
    v_cmp_eq_u32 vcc, v110, v103
    v_cmp_gt_u32_e64 s[84:85], s79, v111
    s_waitcnt lgkmcnt(0)
    v_mfma_f32_32x32x16_bf16 v[160:175], v[48:51], v[56:59], v[160:175]
    ds_read_b128 v[68:71], v127 offset:0
    ds_read_b64_tr_b16 v[76:77], v131 offset:0
    s_nop 1
    s_and_b64 s[84:85], s[84:85], vcc
    v_mfma_f32_32x32x16_bf16 v[176:191], v[52:55], v[56:59], v[176:191]
    ds_read_b64_tr_b16 v[78:79], v131 offset:512
    ds_read_b128 v[72:75], v127 offset:4096
    s_orn2_b64 s[84:85], s[84:85], s[70:71]
    s_and_b64 s[68:69], s[68:69], s[84:85]
    s_cmp_eq_u64 s[68:69], -1
    s_cbranch_scc0 K1_A0_slow
K1_A0_ok:
    s_lshl_b32 s49, s32, 8
    s_add_u32 s49, s49, 53376
    v_lshlrev_b32 v1, 2, v0
    v_add_u32 v1, s49, v1
    ds_write_b32 v1, v96
    ds_write_b32 v1, v97 offset:1024
    v_mfma_f32_32x32x16_bf16 v[192:207], v[48:51], v[60:63], v[192:207]
    ds_read_b64_tr_b16 v[80:81], v135 offset:0
    ds_read_b64_tr_b16 v[82:83], v135 offset:512
    s_lshl_b32 s49, s32, 9
    s_add_u32 s49, s49, 57472
    v_lshlrev_b32 v1, 3, v0
    v_add_u32 v2, s49, v1
    v_add_u32 v1, 160128, v1
    v_cndmask_b32_e64 v1, v1, v2, s[70:71]
    ds_write_b64 v1, v[100:101]
    v_mfma_f32_32x32x16_bf16 v[208:223], v[52:55], v[60:63], v[208:223]
    s_waitcnt lgkmcnt(0)
    s_waitcnt vmcnt(1)
    s_setprio 0
    s_barrier
    v_mfma_f32_32x32x16_bf16 v[160:175], v[68:71], v[76:79], v[160:175]
    ds_read_b128 v[48:51], v16 offset:0
    ds_read_b64_tr_b16 v[56:57], v20 offset:0
    v_and_b32 v1, 31, v0
    v_lshlrev_b32 v1, 2, v1
    s_lshl_b32 s49, s33, 8
    s_add_u32 s49, s49, 53376
    v_add_u32 v2, s49, v1
    ds_read_b32 v150, v2
    ds_read_b32 v151, v2 offset:128
    v_add_u32 v3, 55424, v1
    ds_read_b32 v136, v3 offset:0
    ds_read_b32 v137, v3 offset:640
    ds_read_b32 v138, v3 offset:1280
    v_mfma_f32_32x32x16_bf16 v[176:191], v[72:75], v[76:79], v[176:191]
    ds_read_b64_tr_b16 v[58:59], v20 offset:512
    ds_read_b128 v[52:55], v16 offset:4096
    ds_read_b32 v139, v3 offset:1920
    ds_read_b32 v140, v3 offset:2560
    ds_read_b32 v141, v3 offset:3200
    v_mfma_f32_32x32x16_bf16 v[192:207], v[68:71], v[80:83], v[192:207]
    ds_read_b64_tr_b16 v[60:61], v24 offset:0
    ds_read_b64_tr_b16 v[62:63], v24 offset:512
    ds_read_b32 v142, v3 offset:3840
    ds_read_b32 v143, v3 offset:128
    ds_read_b32 v144, v3 offset:768
    v_mfma_f32_32x32x16_bf16 v[208:223], v[72:75], v[80:83], v[208:223]
    ds_read_b32 v145, v3 offset:1408
    ds_read_b32 v146, v3 offset:2048
    ds_read_b32 v147, v3 offset:2688
    s_waitcnt lgkmcnt(0)
    v_mfma_f32_32x32x16_bf16 v[160:175], v[48:51], v[56:59], v[160:175]
    ds_read_b128 v[68:71], v17 offset:0
    ds_read_b64_tr_b16 v[76:77], v21 offset:0
    ds_read_b32 v148, v3 offset:3328
    ds_read_b32 v149, v3 offset:3968
    v_lshrrev_b32 v4, 5, v0
    v_lshlrev_b32 v4, 4, v4
    v_add_u32 v4, s49, v4
    v_mfma_f32_32x32x16_bf16 v[176:191], v[52:55], v[56:59], v[176:191]
    ds_read_b64_tr_b16 v[78:79], v21 offset:512
    ds_read_b128 v[72:75], v17 offset:4096
    ds_read_b128 v[104:107], v4 offset:1024
    ds_read_b128 v[108:111], v4 offset:1056
    ds_read_b128 v[112:115], v4 offset:1088
    v_mfma_f32_32x32x16_bf16 v[192:207], v[48:51], v[60:63], v[192:207]
    ds_read_b64_tr_b16 v[80:81], v25 offset:0
    ds_read_b64_tr_b16 v[82:83], v25 offset:512
    ds_read_b128 v[116:119], v4 offset:1120
    ds_read_b128 v[120:123], v4 offset:1152
    ds_read_b128 v[124:127], v4 offset:1184
    v_mfma_f32_32x32x16_bf16 v[208:223], v[52:55], v[60:63], v[208:223]
    ds_read_b128 v[128:131], v4 offset:1216
    ds_read_b128 v[132:135], v4 offset:1248
    buffer_load_dwordx4 v[44:47], v42, s[20:23], s77 offen sc1
    s_waitcnt lgkmcnt(0)
    v_mfma_f32_32x32x16_bf16 v[160:175], v[68:71], v[76:79], v[160:175]
    ds_read_b128 v[48:51], v18 offset:0
    ds_read_b64_tr_b16 v[56:57], v22 offset:0
    v_sub_f32 v150, 0, v150
    v_cndmask_b32_e64 v150, 0, v150, s[62:63]
    v_sub_f32 v151, 0, v151
    v_cndmask_b32_e64 v151, 0, v151, s[62:63]
    v_mfma_f32_32x32x16_bf16 v[176:191], v[72:75], v[76:79], v[176:191]
    ds_read_b64_tr_b16 v[58:59], v22 offset:512
    ds_read_b128 v[52:55], v18 offset:4096
    v_cvt_pk_bf16_f32 v89, v150, 0
    v_cvt_pk_bf16_f32 v93, v151, 0
    v_lshlrev_b32 v1, 16, v89
    v_lshlrev_b32 v2, 16, v93
    v_mfma_f32_32x32x16_bf16 v[192:207], v[68:71], v[80:83], v[192:207]
    ds_read_b64_tr_b16 v[60:61], v26 offset:0
    ds_read_b64_tr_b16 v[62:63], v26 offset:512
    v_sub_f32 v1, v150, v1
    v_sub_f32 v2, v151, v2
    v_cvt_pk_bf16_f32 v88, v150, v1
    v_mfma_f32_32x32x16_bf16 v[208:223], v[72:75], v[80:83], v[208:223]
    v_mov_b32 v90, 0
    v_mov_b32 v91, 0
    v_cvt_pk_bf16_f32 v92, v151, v2
    v_mov_b32 v94, 0
    s_waitcnt lgkmcnt(0)
    v_mfma_f32_32x32x16_bf16 v[160:175], v[48:51], v[56:59], v[160:175]
    ds_read_b128 v[68:71], v19 offset:0
    ds_read_b64_tr_b16 v[76:77], v23 offset:0
    v_mov_b32 v95, 0
    v_add_f32 v136, v136, v137
    v_add_f32 v138, v138, v139
    v_mfma_f32_32x32x16_bf16 v[176:191], v[52:55], v[56:59], v[176:191]
    ds_read_b64_tr_b16 v[78:79], v23 offset:512
    ds_read_b128 v[72:75], v19 offset:4096
    v_add_f32 v140, v140, v141
    v_add_f32 v136, v136, v142
    v_add_f32 v138, v138, v140
    v_add_f32 v136, v136, v138
    v_mfma_f32_32x32x16_bf16 v[192:207], v[48:51], v[60:63], v[192:207]
    ds_read_b64_tr_b16 v[80:81], v27 offset:0
    ds_read_b64_tr_b16 v[82:83], v27 offset:512
    v_cvt_pk_bf16_f32 v96, v136, v136
    v_lshlrev_b32 v137, 16, v96
    v_sub_f32 v137, v136, v137
    v_cvt_pk_bf16_f32 v97, v137, 0
    v_mfma_f32_32x32x16_bf16 v[208:223], v[52:55], v[60:63], v[208:223]
    v_mov_b32 v98, 0
    v_mov_b32 v99, 0
    v_add_f32 v143, v143, v144
    s_waitcnt lgkmcnt(0)
    v_mfma_f32_32x32x16_bf16 v[160:175], v[68:71], v[76:79], v[160:175]
    v_add_f32 v145, v145, v146
    v_add_f32 v147, v147, v148
    v_add_f32 v143, v143, v149
    v_add_f32 v145, v145, v147
    v_mfma_f32_32x32x16_bf16 v[176:191], v[72:75], v[76:79], v[176:191]
    v_add_f32 v143, v143, v145
    v_cvt_pk_bf16_f32 v100, v143, v143
    v_lshlrev_b32 v144, 16, v100
    v_mfma_f32_32x32x16_bf16 v[192:207], v[68:71], v[80:83], v[192:207]
    v_sub_f32 v144, v143, v144
    v_cvt_pk_bf16_f32 v101, v144, 0
    v_mov_b32 v102, 0
    v_mov_b32 v103, 0
    v_mfma_f32_32x32x16_bf16 v[208:223], v[72:75], v[80:83], v[208:223]
    v_mov_b32 v12, 0x358637bd
    v_mov_b32 v13, 0x3fb8aa3b
    v_mov_b32 v14, 0xb5c1a2a0
    s_setprio 3
    v_mfma_f32_32x32x16_bf16 v[160:175], v[88:91], v[96:99], v[160:175]
    v_mfma_f32_32x32x16_bf16 v[176:191], v[92:95], v[96:99], v[176:191]
    v_mfma_f32_32x32x16_bf16 v[192:207], v[88:91], v[100:103], v[192:207]
    v_mfma_f32_32x32x16_bf16 v[208:223], v[92:95], v[100:103], v[208:223]
    s_lshl_b32 s49, s34, 3
    s_lshl_b32 s50, s33, 1
    s_add_u32 s49, s49, s50
    s_nop 7
    s_nop 7
    v_mov_b32 v152, 0x3f803f80
    v_fma_f32 v64, v160, v104, v12
    v_fma_f32 v65, v161, v105, v12
    v_fma_f32 v66, v162, v106, v12
    v_fma_f32 v67, v163, v107, v12
    v_fma_f32 v68, v164, v108, v12
    v_fma_f32 v69, v165, v109, v12
    v_fma_f32 v70, v166, v110, v12
    v_fma_f32 v71, v167, v111, v12
    v_fma_f32 v72, v64, v13, v14
    v_fma_f32 v73, v65, v13, v14
    v_fma_f32 v74, v66, v13, v14
    v_fma_f32 v75, v67, v13, v14
    v_fma_f32 v76, v68, v13, v14
    v_fma_f32 v77, v69, v13, v14
    v_fma_f32 v78, v70, v13, v14
    v_fma_f32 v79, v71, v13, v14
    v_exp_f32_e64 v72, v72 clamp
    v_exp_f32_e64 v73, v73 clamp
    v_exp_f32_e64 v74, v74 clamp
    v_exp_f32_e64 v75, v75 clamp
    v_exp_f32_e64 v76, v76 clamp
    v_exp_f32_e64 v77, v77 clamp
    v_exp_f32_e64 v78, v78 clamp
    v_exp_f32_e64 v79, v79 clamp
    v_max_f32 v64, v12, v64
    v_max_f32 v65, v12, v65
    v_max_f32 v66, v12, v66
    v_max_f32 v67, v12, v67
    v_max_f32 v68, v12, v68
    v_max_f32 v69, v12, v69
    v_max_f32 v70, v12, v70
    v_max_f32 v71, v12, v71
    v_add_f32 v64, v64, v72
    v_add_f32 v65, v65, v73
    v_add_f32 v66, v66, v74
    v_add_f32 v67, v67, v75
    v_add_f32 v68, v68, v76
    v_add_f32 v69, v69, v77
    v_add_f32 v70, v70, v78
    v_add_f32 v71, v71, v79
    v_cvt_pk_bf16_f32 v48, v64, v65
    v_cvt_pk_bf16_f32 v49, v66, v67
    v_cvt_pk_bf16_f32 v50, v68, v69
    v_cvt_pk_bf16_f32 v51, v70, v71
    v_fma_f32 v64, v168, v112, v12
    v_fma_f32 v65, v169, v113, v12
    v_fma_f32 v66, v170, v114, v12
    v_fma_f32 v67, v171, v115, v12
    v_fma_f32 v68, v172, v116, v12
    v_fma_f32 v69, v173, v117, v12
    v_fma_f32 v70, v174, v118, v12
    v_fma_f32 v71, v175, v119, v12
    v_fma_f32 v72, v64, v13, v14
    v_fma_f32 v73, v65, v13, v14
    v_fma_f32 v74, v66, v13, v14
    v_fma_f32 v75, v67, v13, v14
    v_fma_f32 v76, v68, v13, v14
    v_fma_f32 v77, v69, v13, v14
    v_fma_f32 v78, v70, v13, v14
    v_fma_f32 v79, v71, v13, v14
    v_exp_f32_e64 v72, v72 clamp
    v_exp_f32_e64 v73, v73 clamp
    v_exp_f32_e64 v74, v74 clamp
    v_exp_f32_e64 v75, v75 clamp
    v_exp_f32_e64 v76, v76 clamp
    v_exp_f32_e64 v77, v77 clamp
    v_exp_f32_e64 v78, v78 clamp
    v_exp_f32_e64 v79, v79 clamp
    v_max_f32 v64, v12, v64
    v_max_f32 v65, v12, v65
    v_max_f32 v66, v12, v66
    v_max_f32 v67, v12, v67
    v_max_f32 v68, v12, v68
    v_max_f32 v69, v12, v69
    v_max_f32 v70, v12, v70
    v_max_f32 v71, v12, v71
    v_add_f32 v64, v64, v72
    v_add_f32 v65, v65, v73
    v_add_f32 v66, v66, v74
    v_add_f32 v67, v67, v75
    v_add_f32 v68, v68, v76
    v_add_f32 v69, v69, v77
    v_add_f32 v70, v70, v78
    v_add_f32 v71, v71, v79
    v_cvt_pk_bf16_f32 v52, v64, v65
    v_cvt_pk_bf16_f32 v53, v66, v67
    v_cvt_pk_bf16_f32 v54, v68, v69
    v_cvt_pk_bf16_f32 v55, v70, v71
    v_pk_mul_f32 v[192:193], v[192:193], v[104:105]
    v_pk_mul_f32 v[194:195], v[194:195], v[106:107]
    v_pk_mul_f32 v[196:197], v[196:197], v[108:109]
    v_pk_mul_f32 v[198:199], v[198:199], v[110:111]
    v_pk_mul_f32 v[200:201], v[200:201], v[112:113]
    v_pk_mul_f32 v[202:203], v[202:203], v[114:115]
    v_pk_mul_f32 v[204:205], v[204:205], v[116:117]
    v_pk_mul_f32 v[206:207], v[206:207], v[118:119]
    v_cvt_pk_bf16_f32 v136, v192, v193
    v_cvt_pk_bf16_f32 v137, v194, v195
    v_cvt_pk_bf16_f32 v138, v196, v197
    v_cvt_pk_bf16_f32 v139, v198, v199
    v_cvt_pk_bf16_f32 v140, v200, v201
    v_cvt_pk_bf16_f32 v141, v202, v203
    v_cvt_pk_bf16_f32 v142, v204, v205
    v_cvt_pk_bf16_f32 v143, v206, v207
    v_cndmask_b32_e64 v136, v136, v152, s[30:31]
    v_cndmask_b32_e64 v137, v137, v152, s[30:31]
    v_cndmask_b32_e64 v138, v138, v152, s[30:31]
    v_cndmask_b32_e64 v139, v139, v152, s[30:31]
    v_cndmask_b32_e64 v140, v140, v152, s[30:31]
    v_cndmask_b32_e64 v141, v141, v152, s[30:31]
    v_cndmask_b32_e64 v142, v142, v152, s[30:31]
    v_cndmask_b32_e64 v143, v143, v152, s[30:31]
    v_fma_f32 v64, v176, v120, v12
    v_fma_f32 v65, v177, v121, v12
    v_fma_f32 v66, v178, v122, v12
    v_fma_f32 v67, v179, v123, v12
    v_fma_f32 v68, v180, v124, v12
    v_fma_f32 v69, v181, v125, v12
    v_fma_f32 v70, v182, v126, v12
    v_fma_f32 v71, v183, v127, v12
    v_fma_f32 v72, v64, v13, v14
    v_fma_f32 v73, v65, v13, v14
    v_fma_f32 v74, v66, v13, v14
    v_fma_f32 v75, v67, v13, v14
    v_fma_f32 v76, v68, v13, v14
    v_fma_f32 v77, v69, v13, v14
    v_fma_f32 v78, v70, v13, v14
    v_fma_f32 v79, v71, v13, v14
    v_exp_f32_e64 v72, v72 clamp
    v_exp_f32_e64 v73, v73 clamp
    v_exp_f32_e64 v74, v74 clamp
    v_exp_f32_e64 v75, v75 clamp
    v_exp_f32_e64 v76, v76 clamp
    v_exp_f32_e64 v77, v77 clamp
    v_exp_f32_e64 v78, v78 clamp
    v_exp_f32_e64 v79, v79 clamp
    v_max_f32 v64, v12, v64
    v_max_f32 v65, v12, v65
    v_max_f32 v66, v12, v66
    v_max_f32 v67, v12, v67
    v_max_f32 v68, v12, v68
    v_max_f32 v69, v12, v69
    v_max_f32 v70, v12, v70
    v_max_f32 v71, v12, v71
    v_add_f32 v64, v64, v72
    v_add_f32 v65, v65, v73
    v_add_f32 v66, v66, v74
    v_add_f32 v67, v67, v75
    v_add_f32 v68, v68, v76
    v_add_f32 v69, v69, v77
    v_add_f32 v70, v70, v78
    v_add_f32 v71, v71, v79
    v_cvt_pk_bf16_f32 v56, v64, v65
    v_cvt_pk_bf16_f32 v57, v66, v67
    v_cvt_pk_bf16_f32 v58, v68, v69
    v_cvt_pk_bf16_f32 v59, v70, v71
    v_fma_f32 v64, v184, v128, v12
    v_fma_f32 v65, v185, v129, v12
    v_fma_f32 v66, v186, v130, v12
    v_fma_f32 v67, v187, v131, v12
    v_fma_f32 v68, v188, v132, v12
    v_fma_f32 v69, v189, v133, v12
    v_fma_f32 v70, v190, v134, v12
    v_fma_f32 v71, v191, v135, v12
    v_fma_f32 v72, v64, v13, v14
    v_fma_f32 v73, v65, v13, v14
    v_fma_f32 v74, v66, v13, v14
    v_fma_f32 v75, v67, v13, v14
    v_fma_f32 v76, v68, v13, v14
    v_fma_f32 v77, v69, v13, v14
    v_fma_f32 v78, v70, v13, v14
    v_fma_f32 v79, v71, v13, v14
    v_exp_f32_e64 v72, v72 clamp
    v_exp_f32_e64 v73, v73 clamp
    v_exp_f32_e64 v74, v74 clamp
    v_exp_f32_e64 v75, v75 clamp
    v_exp_f32_e64 v76, v76 clamp
    v_exp_f32_e64 v77, v77 clamp
    v_exp_f32_e64 v78, v78 clamp
    v_exp_f32_e64 v79, v79 clamp
    v_max_f32 v64, v12, v64
    v_max_f32 v65, v12, v65
    v_max_f32 v66, v12, v66
    v_max_f32 v67, v12, v67
    v_max_f32 v68, v12, v68
    v_max_f32 v69, v12, v69
    v_max_f32 v70, v12, v70
    v_max_f32 v71, v12, v71
    v_add_f32 v64, v64, v72
    v_add_f32 v65, v65, v73
    v_add_f32 v66, v66, v74
    v_add_f32 v67, v67, v75
    v_add_f32 v68, v68, v76
    v_add_f32 v69, v69, v77
    v_add_f32 v70, v70, v78
    v_add_f32 v71, v71, v79
    v_cvt_pk_bf16_f32 v60, v64, v65
    v_cvt_pk_bf16_f32 v61, v66, v67
    v_cvt_pk_bf16_f32 v62, v68, v69
    v_cvt_pk_bf16_f32 v63, v70, v71
    v_pk_mul_f32 v[208:209], v[208:209], v[120:121]
    v_pk_mul_f32 v[210:211], v[210:211], v[122:123]
    v_pk_mul_f32 v[212:213], v[212:213], v[124:125]
    v_pk_mul_f32 v[214:215], v[214:215], v[126:127]
    v_pk_mul_f32 v[216:217], v[216:217], v[128:129]
    v_pk_mul_f32 v[218:219], v[218:219], v[130:131]
    v_pk_mul_f32 v[220:221], v[220:221], v[132:133]
    v_pk_mul_f32 v[222:223], v[222:223], v[134:135]
    v_cvt_pk_bf16_f32 v144, v208, v209
    v_cvt_pk_bf16_f32 v145, v210, v211
    v_cvt_pk_bf16_f32 v146, v212, v213
    v_cvt_pk_bf16_f32 v147, v214, v215
    v_cvt_pk_bf16_f32 v148, v216, v217
    v_cvt_pk_bf16_f32 v149, v218, v219
    v_cvt_pk_bf16_f32 v150, v220, v221
    v_cvt_pk_bf16_f32 v151, v222, v223
    v_cndmask_b32_e64 v144, v144, v152, s[30:31]
    v_cndmask_b32_e64 v145, v145, v152, s[30:31]
    v_cndmask_b32_e64 v146, v146, v152, s[30:31]
    v_cndmask_b32_e64 v147, v147, v152, s[30:31]
    v_cndmask_b32_e64 v148, v148, v152, s[30:31]
    v_cndmask_b32_e64 v149, v149, v152, s[30:31]
    v_cndmask_b32_e64 v150, v150, v152, s[30:31]
    v_cndmask_b32_e64 v151, v151, v152, s[30:31]
    s_nop 1
    v_mfma_f32_32x32x16_bf16 v[160:175], v[48:51], v[136:139], 0
    v_mfma_f32_32x32x16_bf16 v[160:175], v[52:55], v[140:143], v[160:175]
    v_mfma_f32_32x32x16_bf16 v[160:175], v[56:59], v[144:147], v[160:175]
    v_mfma_f32_32x32x16_bf16 v[160:175], v[60:63], v[148:151], v[160:175]
    s_lshl_b32 s51, s35, 12
    s_add_u32 s51, s51, 12582912
    v_lshlrev_b32 v1, 2, v0
    s_lshl_b32 s52, s33, 12
    s_add_u32 s52, s52, 61568
    v_add_u32 v2, s52, v31
    s_lshl_b32 s52, s33, 10
    s_add_u32 s51, s51, s52
    s_add_u32 s52, s52, 61568
    v_add_u32 v3, s52, v1
    s_nop 7
    s_nop 1
    ds_write_b128 v2, v[160:163] offset:0
    ds_write_b128 v2, v[164:167] offset:1024
    ds_write_b128 v2, v[168:171] offset:2048
    ds_write_b128 v2, v[172:175] offset:3072
    s_waitcnt lgkmcnt(0)
    s_barrier
    ds_read2st64_b32 v[64:65], v3 offset0:0 offset1:1
    ds_read2st64_b32 v[66:67], v3 offset0:2 offset1:3
    ds_read2st64_b32 v[68:69], v3 offset0:16 offset1:17
    ds_read2st64_b32 v[70:71], v3 offset0:18 offset1:19
    ds_read2st64_b32 v[72:73], v3 offset0:32 offset1:33
    ds_read2st64_b32 v[74:75], v3 offset0:34 offset1:35
    ds_read2st64_b32 v[76:77], v3 offset0:48 offset1:49
    ds_read2st64_b32 v[78:79], v3 offset0:50 offset1:51
    s_waitcnt vmcnt(0)
    v_xor_b32 v2, v44, v45
    v_xor_b32 v2, s59, v2
    v_xor_b32 v2, v46, v2
    v_subrev_u32 v3, s55, v46
    v_cmp_eq_u32 vcc, v2, v47
    v_cmp_gt_u32_e64 s[68:69], s79, v3
    s_nop 1
    s_and_b64 s[68:69], s[68:69], vcc
    s_and_b32 s68, s68, 15
    s_cmp_eq_u32 s68, 15
    s_cbranch_scc0 K1_A0_zslow
K1_A0_zok:
    s_waitcnt lgkmcnt(4)
    v_add_f32 v64, v64, v68
    v_add_f32 v65, v65, v69
    v_add_f32 v66, v66, v70
    v_add_f32 v67, v67, v71
    s_waitcnt lgkmcnt(0)
    v_add_f32 v72, v72, v76
    v_add_f32 v73, v73, v77
    v_add_f32 v74, v74, v78
    v_add_f32 v75, v75, v79
    v_add_f32 v64, v64, v72
    v_add_f32 v65, v65, v73
    v_add_f32 v66, v66, v74
    v_add_f32 v67, v67, v75
    buffer_atomic_add_f32 v64, v1, s[20:23], s51 offen offset:0 sc1
    buffer_atomic_add_f32 v65, v1, s[20:23], s51 offen offset:256 sc1
    buffer_atomic_add_f32 v66, v1, s[20:23], s51 offen offset:512 sc1
    buffer_atomic_add_f32 v67, v1, s[20:23], s51 offen offset:768 sc1
    s_branch F_bridge
K1_A0_zslow:
    s_mov_b32 s78, 0
K1_A0_zspin:
    s_sleep 2
    buffer_load_dwordx4 v[44:47], v42, s[20:23], s77 offen sc1
    s_waitcnt vmcnt(0)
    v_xor_b32 v2, v44, v45
    v_xor_b32 v2, s59, v2
    v_xor_b32 v2, v46, v2
    v_subrev_u32 v3, s55, v46
    v_cmp_eq_u32 vcc, v2, v47
    v_cmp_gt_u32_e64 s[68:69], s79, v3
    s_nop 1
    s_and_b64 s[68:69], s[68:69], vcc
    s_and_b32 s68, s68, 15
    s_cmp_eq_u32 s68, 15
    s_cbranch_scc1 K1_A0_zok
    s_add_u32 s78, s78, 1
    s_cmp_ge_u32 s78, 96
    s_cbranch_scc1 W_ref_1
W_ref_1_back:
    s_cmp_lt_u32 s78, 200000
    s_cbranch_scc1 K1_A0_zspin
    s_branch K1_A0_zok
K1_A0_slow:
    s_add_u32 s78, s78, 1
    s_cmp_ge_u32 s78, 40
    s_cbranch_scc1 K1_fb_2
    s_sleep 2
    s_lshl_b32 s49, s34, 12
    s_lshl_b32 s50, s32, 10
    s_add_u32 s49, s49, s50
    s_add_u32 s49, s49, 12648448
    buffer_load_dwordx4 v[96:99], v31, s[20:23], s49 offen sc1
    s_mul_i32 s49, s36, 8960
    s_lshl_b32 s50, s32, 10
    s_add_u32 s49, s49, s50
    s_add_u32 s49, s49, 12718080
    buffer_load_dwordx4 v[100:103], v31, s[20:23], s49 offen sc1
    s_waitcnt vmcnt(0)
    v_xor_b32 v108, v96, v97
    v_xor_b32 v108, s59, v108
    v_xor_b32 v108, v98, v108
    v_subrev_u32 v109, s55, v98
    v_cmp_eq_u32 vcc, v108, v99
    v_cmp_gt_u32_e64 s[68:69], s79, v109
    s_nop 1
    s_and_b64 s[68:69], s[68:69], vcc
    v_xor_b32 v110, v100, v101
    v_xor_b32 v110, s59, v110
    v_xor_b32 v110, v102, v110
    v_subrev_u32 v111, s55, v102
    v_cmp_eq_u32 vcc, v110, v103
    v_cmp_gt_u32_e64 s[84:85], s79, v111
    s_nop 1
    s_and_b64 s[84:85], s[84:85], vcc
    s_orn2_b64 s[84:85], s[84:85], s[70:71]
    s_and_b64 s[68:69], s[68:69], s[84:85]
    s_cmp_eq_u64 s[68:69], -1
    s_cbranch_scc0 K1_A0_slow
    s_branch K1_A0_ok
K1_fb_2:
    s_lshl_b32 s49, s34, 8
    s_lshl_b32 s50, s32, 6
    s_add_u32 s49, s49, s50
    v_add_u32 v108, s49, v0
    v_mul_u32_u24 v108, 896, v108
    v_mov_b32 v96, 0
    v_mov_b32 v97, 0
    s_mov_b32 s51, 0
K1_fbr_3:
    buffer_load_dwordx4 v[112:115], v108, s[4:7], s51 offen
    s_waitcnt vmcnt(0)
    v_lshlrev_b32 v109, 16, v112
    v_and_b32 v110, s58, v112
    v_add_f32 v96, v96, v109
    v_fmac_f32 v97, v109, v109
    v_add_f32 v96, v96, v110
    v_fmac_f32 v97, v110, v110
    v_lshlrev_b32 v109, 16, v113
    v_and_b32 v110, s58, v113
    v_add_f32 v96, v96, v109
    v_fmac_f32 v97, v109, v109
    v_add_f32 v96, v96, v110
    v_fmac_f32 v97, v110, v110
    v_lshlrev_b32 v109, 16, v114
    v_and_b32 v110, s58, v114
    v_add_f32 v96, v96, v109
    v_fmac_f32 v97, v109, v109
    v_add_f32 v96, v96, v110
    v_fmac_f32 v97, v110, v110
    v_lshlrev_b32 v109, 16, v115
    v_and_b32 v110, s58, v115
    v_add_f32 v96, v96, v109
    v_fmac_f32 v97, v109, v109
    v_add_f32 v96, v96, v110
    v_fmac_f32 v97, v110, v110
    s_add_u32 s51, s51, 16
    s_cmp_lt_u32 s51, 896
    s_cbranch_scc1 K1_fbr_3
    v_mul_f32 v96, 0x3b124925, v96
    v_mul_f32 v97, 0x3b124925, v97
    v_fma_f32 v97, -v96, v96, v97
    v_max_f32 v97, 0, v97
    v_add_f32 v97, 0x3727c5ac, v97
    v_rsq_f32 v97, v97
    s_nop 0
    s_lshl_b32 s54, s32, 6
    s_add_u32 s54, s54, 256
    v_add_u32 v108, s54, v0
    v_mul_u32_u24 v109, 205, v108
    v_lshrrev_b32 v109, 14, v109
    v_mul_u32_u24 v110, 80, v109
    v_sub_u32 v110, v108, v110
    v_lshrrev_b32 v111, 4, v110
    v_and_b32 v112, 15, v110
    v_lshlrev_b32 v116, 1, v112
    v_subrev_u32 v117, 4, v116
    v_cmp_gt_u32 vcc, 24, v116
    s_nop 1
    v_cndmask_b32 v116, v117, v116, vcc
    s_mul_i32 s49, s35, 28
    v_add_u32 v116, s49, v116
    v_mul_u32_u24 v117, 448, v111
    v_add_u32 v116, v116, v117
    v_add_u32 v116, 448, v116
    v_lshlrev_b32 v113, 1, v116
    v_mul_u32_u24 v117, 2688, v109
    v_lshlrev_b32 v117, 6, v117
    v_add_u32 v113, v113, v117
    v_mov_b32 v118, 1073741824
    v_cmp_gt_u32 vcc, 2, v111
    s_nop 1
    v_cndmask_b32 v113, v118, v113, vcc
    v_subrev_u32 v116, 2, v111
    v_lshlrev_b32 v116, 4, v116
    v_and_b32 v117, 7, v112
    v_lshl_add_u32 v116, v117, 1, v116
    s_mul_i32 s49, s29, 48
    v_add_u32 v116, s49, v116
    v_lshlrev_b32 v114, 1, v116
    v_mul_u32_u24 v117, 3584, v109
    v_lshlrev_b32 v117, 6, v117
    v_add_u32 v114, v114, v117
    v_cndmask_b32 v114, v114, v118, vcc
    v_cmp_gt_u32 vcc, 8, v112
    s_nop 1
    v_cndmask_b32 v115, v114, v118, vcc
    v_cndmask_b32 v114, v118, v114, vcc
    v_mov_b32 v100, 0
    v_mov_b32 v101, 0
    s_mov_b32 s51, 0
    s_mov_b32 s52, 0
    s_mov_b32 s53, 0
K1_fbc_4:
    buffer_load_dword v117, v113, s[8:11], s51 offen
    buffer_load_dword v118, v114, s[12:15], s52 offen
    buffer_load_dword v119, v115, s[16:19], s52 offen
    s_waitcnt vmcnt(0)
    v_or_b32 v117, v117, v118
    v_or_b32 v117, v117, v119
    v_lshlrev_b32 v118, 16, v117
    v_and_b32 v119, s58, v117
    v_add_f32 v100, v100, v118
    v_add_f32 v101, v101, v119
    s_add_u32 s51, s51, 2688
    s_add_u32 s52, s52, 3584
    s_add_u32 s53, s53, 1
    s_cmp_lt_u32 s53, 64
    s_cbranch_scc1 K1_fbc_4
    s_branch K1_A0_ok
K1_A1:
    s_setprio 1
    s_mov_b32 s58, 0xffff0000
    s_mov_b32 s62, -1
    s_mov_b32 s63, 0
    s_mov_b32 s30, 0x01000000
    s_mov_b32 s31, 0x01000000
    s_mov_b32 s79, 16777216
    s_mul_i32 s49, s36, 8960
    s_mul_i32 s50, s34, 1280
    s_add_u32 s49, s49, s50
    s_lshl_b32 s50, s33, 10
    s_add_u32 s49, s49, s50
    s_add_u32 s76, s49, 12713984
    v_mov_b32 v1, 0x40000000
    s_cmp_eq_u32 s33, 1
    s_cselect_b32 s68, 0xffff, 0
    s_mov_b32 s69, 0
    s_cmp_eq_u32 s33, 0
    s_cselect_b32 s68, -1, s68
    s_cselect_b32 s69, -1, 0
    s_cmp_lt_u32 s34, 7
    s_cselect_b32 s68, s68, 0
    s_cselect_b32 s69, s69, 0
    s_cselect_b32 s76, s76, 0
    v_cndmask_b32_e64 v43, v1, v31, s[68:69]
    s_lshl_b32 s77, s35, 6
    s_lshl_b32 s49, s33, 4
    s_add_u32 s77, s77, s49
    s_add_u32 s77, s77, 13115392
    v_mov_b32 v44, 0
    v_mov_b32 v45, 0
    v_mov_b32 v1, 0x40000000
    v_lshlrev_b32 v2, 3, v0
    s_cmp_eq_u32 s34, 0
    s_cselect_b64 vcc, -1, 0
    s_cselect_b64 s[68:69], 1, 0
    v_cndmask_b32 v42, v1, v2, vcc
    v_cndmask_b32_e64 v46, v1, v44, s[68:69]
    v_and_b32 v1, 31, v0
    v_lshrrev_b32 v2, 5, v0
    v_lshrrev_b32 v3, 1, v1
    v_and_b32 v3, 7, v3
    s_lshl_b32 s49, s33, 13
    v_lshlrev_b32 v4, 7, v1
    v_add_u32 v4, s49, v4
    s_add_u32 s50, s33, 0
    s_and_b32 s50, s50, 3
    s_lshl_b32 s50, s50, 1
    v_add_u32 v5, s50, v2
    v_xor_b32 v5, v5, v3
    v_lshlrev_b32 v5, 4, v5
    v_add_u32 v16, v4, v5
    v_add_u32 v124, 106752, v16
    s_add_u32 s50, s33, 1
    s_and_b32 s50, s50, 3
    s_lshl_b32 s50, s50, 1
    v_add_u32 v5, s50, v2
    v_xor_b32 v5, v5, v3
    v_lshlrev_b32 v5, 4, v5
    v_add_u32 v17, v4, v5
    v_add_u32 v125, 106752, v17
    s_add_u32 s50, s33, 2
    s_and_b32 s50, s50, 3
    s_lshl_b32 s50, s50, 1
    v_add_u32 v5, s50, v2
    v_xor_b32 v5, v5, v3
    v_lshlrev_b32 v5, 4, v5
    v_add_u32 v18, v4, v5
    v_add_u32 v126, 106752, v18
    s_add_u32 s50, s33, 3
    s_and_b32 s50, s50, 3
    s_lshl_b32 s50, s50, 1
    v_add_u32 v5, s50, v2
    v_xor_b32 v5, v5, v3
    v_lshlrev_b32 v5, 4, v5
    v_add_u32 v19, v4, v5
    v_add_u32 v127, 106752, v19
    v_lshrrev_b32 v1, 2, v0
    v_and_b32 v1, 3, v1
    v_and_b32 v2, 3, v0
    v_lshrrev_b32 v3, 5, v0
    v_lshrrev_b32 v4, 4, v0
    v_and_b32 v4, 1, v4
    v_lshlrev_b32 v5, 3, v3
    v_add_u32 v5, v5, v1
    v_lshrrev_b32 v6, 1, v1
    v_lshlrev_b32 v7, 3, v2
    v_mul_u32_u24 v8, 96, v5
    v_add_u32 v8, v8, v7
    v_mul_u32_u24 v9, 6272, v4
    v_add3_u32 v8, v8, v9, 0
    v_add_u32 v8, 40960, v8
    s_add_u32 s50, s33, 0
    s_and_b32 s50, s50, 3
    s_mul_i32 s51, s50, 1536
    v_add_u32 v20, s51, v8
    v_add_u32 v128, 106752, v20
    s_add_u32 s50, s33, 1
    s_and_b32 s50, s50, 3
    s_mul_i32 s51, s50, 1536
    v_add_u32 v21, s51, v8
    v_add_u32 v129, 106752, v21
    s_add_u32 s50, s33, 2
    s_and_b32 s50, s50, 3
    s_mul_i32 s51, s50, 1536
    v_add_u32 v22, s51, v8
    v_add_u32 v130, 106752, v22
    s_add_u32 s50, s33, 3
    s_and_b32 s50, s50, 3
    s_mul_i32 s51, s50, 1536
    v_add_u32 v23, s51, v8
    v_add_u32 v131, 106752, v23
    s_waitcnt lgkmcnt(0)
    s_sub_u32 s55, s60, 800
    s_xor_b32 s59, s61, 0x5bd1e995
    s_waitcnt vmcnt(7)
    v_lshlrev_b32 v92, 16, v88
    v_and_b32 v93, s58, v88
    v_lshlrev_b32 v94, 16, v89
    v_and_b32 v95, s58, v89
    v_lshlrev_b32 v96, 16, v90
    v_and_b32 v97, s58, v90
    v_lshlrev_b32 v98, 16, v91
    v_and_b32 v99, s58, v91
    v_add_f32 v100, v92, v93
    v_mul_f32 v101, v92, v92
    v_fmac_f32 v101, v93, v93
    v_add_f32 v100, v100, v94
    v_fmac_f32 v101, v94, v94
    v_add_f32 v100, v100, v95
    v_fmac_f32 v101, v95, v95
    v_add_f32 v100, v100, v96
    v_fmac_f32 v101, v96, v96
    v_add_f32 v100, v100, v97
    v_fmac_f32 v101, v97, v97
    v_add_f32 v100, v100, v98
    v_fmac_f32 v101, v98, v98
    v_add_f32 v100, v100, v99
    v_fmac_f32 v101, v99, v99
    s_nop 0
    v_add_f32_dpp v100, v100, v100 row_shr:1 row_mask:0xf bank_mask:0xf bound_ctrl:0
    v_add_f32_dpp v101, v101, v101 row_shr:1 row_mask:0xf bank_mask:0xf bound_ctrl:0
    s_nop 0
    v_add_f32_dpp v100, v100, v100 row_shr:2 row_mask:0xf bank_mask:0xf bound_ctrl:0
    v_add_f32_dpp v101, v101, v101 row_shr:2 row_mask:0xf bank_mask:0xf bound_ctrl:0
    s_nop 0
    v_add_f32_dpp v100, v100, v100 row_shr:4 row_mask:0xf bank_mask:0xf bound_ctrl:0
    v_add_f32_dpp v101, v101, v101 row_shr:4 row_mask:0xf bank_mask:0xf bound_ctrl:0
    s_nop 0
    v_add_f32_dpp v100, v100, v100 row_shr:8 row_mask:0xf bank_mask:0xf bound_ctrl:0
    v_add_f32_dpp v101, v101, v101 row_shr:8 row_mask:0xf bank_mask:0xf bound_ctrl:0
    s_nop 0
    v_add_f32_dpp v100, v100, v100 row_bcast:15 row_mask:0xa bank_mask:0xf
    v_add_f32_dpp v101, v101, v101 row_bcast:15 row_mask:0xa bank_mask:0xf
    s_nop 0
    v_add_f32_dpp v100, v100, v100 row_bcast:31 row_mask:0xc bank_mask:0xf
    v_add_f32_dpp v101, v101, v101 row_bcast:31 row_mask:0xc bank_mask:0xf
    v_mul_f32 v104, 0x3b124925, v100
    v_mul_f32 v101, 0x3b124925, v101
    v_fma_f32 v101, -v104, v104, v101
    v_max_f32 v101, 0, v101
    v_add_f32 v101, 0x3727c5ac, v101
    v_rsq_f32 v105, v101
    s_lshl_b32 s49, s73, 4
    s_add_u32 s49, s49, 12648448
    v_mov_b32 v1, 0
    v_mov_b32 v106, s60
    v_xor_b32 v107, v104, v105
    v_xor_b32 v107, s59, v107
    v_xor_b32 v107, s60, v107
    s_mov_b32 s72, s49
    s_lshl_b32 s74, s44, 7
    s_add_u32 s74, s74, s37
    s_add_u32 m0, s40, 53376
    s_mul_i32 s75, s44, 172032
    buffer_load_dwordx4 v28, s[4:7], s74 offen lds
    s_add_u32 m0, m0, 8192
    s_add_u32 s74, s74, 57344
    buffer_load_dwordx4 v28, s[4:7], s74 offen lds
    s_add_u32 m0, m0, 8192
    s_add_u32 s74, s74, 57344
    buffer_load_dwordx4 v28, s[4:7], s74 offen lds
    s_add_u32 m0, m0, 8192
    s_add_u32 s74, s74, 57344
    buffer_load_dwordx4 v28, s[4:7], s74 offen lds
    s_add_u32 m0, s41, 53376
    s_add_u32 s75, s75, s38
    buffer_load_dwordx4 v29, s[8:11], s75 offen lds
    s_mul_i32 s74, s44, 229376
    s_add_u32 m0, s42, 53376
    s_add_u32 s74, s74, s39
    s_mov_b64 exec, s[56:57]
    buffer_load_dwordx4 v30, s[12:15], s74 offen lds
    s_mov_b64 exec, -1
    s_add_u32 m0, s43, 53376
    s_nop 0
    s_mov_b64 exec, s[56:57]
    buffer_load_dwordx4 v30, s[16:19], s74 offen lds
    s_mov_b64 exec, -1
    s_add_u32 s44, s44, 1
    s_cmp_eq_u32 s44, 7
    s_cselect_b32 s44, 0, s44
    s_mov_b32 s68, 0
    s_mov_b32 s69, 0x80000000
    v_mov_b32 v1, 0
    s_mov_b64 exec, s[68:69]
    buffer_store_dwordx4 v[104:107], v1, s[20:23], s72 offen sc1
    s_mov_b64 exec, -1
    s_lshl_b32 s49, s35, 12
    s_lshl_b32 s50, s33, 10
    s_add_u32 s49, s49, s50
    s_add_u32 s49, s49, 12582912
    buffer_atomic_swap_x2 v[44:45], v42, s[20:23], s49 offen sc1
    buffer_atomic_swap_x2 v[44:45], v42, s[20:23], s49 offen offset:512 sc1
    v_mov_b32 v2, 0x40000000
    s_and_b32 s50, s2, 63
    s_lshl_b32 s50, s50, 2
    v_mov_b32 v4, s50
    s_cmp_eq_u32 s33, 0
    s_cselect_b64 s[68:69], 1, 0
    s_not_b32 s49, s60
    v_mov_b32 v3, s49
    v_cndmask_b32_e64 v2, v2, v4, s[68:69]
    buffer_atomic_umax v3, v2, s[64:67], 0 offen sc1
    s_waitcnt vmcnt(11)
    s_barrier
    ds_read_b128 v[48:51], v16 offset:0
    ds_read_b64_tr_b16 v[56:57], v20 offset:0
    ds_read_b64_tr_b16 v[58:59], v20 offset:384
    ds_read_b128 v[52:55], v16 offset:4096
    ds_read_b64_tr_b16 v[60:61], v20 offset:32
    ds_read_b64_tr_b16 v[62:63], v20 offset:416
    ds_read_b64_tr_b16 v[64:65], v20 offset:64
    ds_read_b64_tr_b16 v[66:67], v20 offset:448
    s_waitcnt lgkmcnt(0)
    v_mfma_f32_32x32x16_bf16 v[160:175], v[56:59], v[48:51], 0
    ds_read_b128 v[68:71], v17 offset:0
    ds_read_b64_tr_b16 v[76:77], v21 offset:0
    v_lshlrev_b32 v38, 16, v56
    v_and_b32 v39, s58, v56
    v_add_f32 v32, 0, v38
    v_mfma_f32_32x32x16_bf16 v[176:191], v[56:59], v[52:55], 0
    ds_read_b64_tr_b16 v[78:79], v21 offset:384
    ds_read_b128 v[72:75], v17 offset:4096
    v_add_f32 v33, 0, v39
    v_lshlrev_b32 v40, 16, v57
    v_and_b32 v41, s58, v57
    v_mfma_f32_32x32x16_bf16 v[192:207], v[60:63], v[48:51], 0
    ds_read_b64_tr_b16 v[80:81], v21 offset:32
    ds_read_b64_tr_b16 v[82:83], v21 offset:416
    v_add_f32 v32, v32, v40
    v_add_f32 v33, v33, v41
    v_mfma_f32_32x32x16_bf16 v[208:223], v[60:63], v[52:55], 0
    ds_read_b64_tr_b16 v[84:85], v21 offset:64
    ds_read_b64_tr_b16 v[86:87], v21 offset:448
    v_lshlrev_b32 v38, 16, v58
    v_and_b32 v39, s58, v58
    v_add_f32 v32, v32, v38
    v_mfma_f32_32x32x16_bf16 v[224:239], v[64:67], v[48:51], 0
    v_add_f32 v33, v33, v39
    v_lshlrev_b32 v40, 16, v59
    v_and_b32 v41, s58, v59
    v_mfma_f32_32x32x16_bf16 v[240:255], v[64:67], v[52:55], 0
    v_add_f32 v32, v32, v40
    v_add_f32 v33, v33, v41
    s_waitcnt lgkmcnt(0)
    v_mfma_f32_32x32x16_bf16 v[160:175], v[76:79], v[68:71], v[160:175]
    ds_read_b128 v[48:51], v18 offset:0
    ds_read_b64_tr_b16 v[56:57], v22 offset:0
    v_lshlrev_b32 v38, 16, v80
    v_and_b32 v39, s58, v80
    v_add_f32 v34, 0, v38
    v_mfma_f32_32x32x16_bf16 v[176:191], v[76:79], v[72:75], v[176:191]
    ds_read_b64_tr_b16 v[58:59], v22 offset:384
    ds_read_b128 v[52:55], v18 offset:4096
    v_add_f32 v35, 0, v39
    v_lshlrev_b32 v40, 16, v81
    v_and_b32 v41, s58, v81
    v_mfma_f32_32x32x16_bf16 v[192:207], v[80:83], v[68:71], v[192:207]
    ds_read_b64_tr_b16 v[60:61], v22 offset:32
    ds_read_b64_tr_b16 v[62:63], v22 offset:416
    v_add_f32 v34, v34, v40
    v_add_f32 v35, v35, v41
    v_mfma_f32_32x32x16_bf16 v[208:223], v[80:83], v[72:75], v[208:223]
    ds_read_b64_tr_b16 v[64:65], v22 offset:64
    ds_read_b64_tr_b16 v[66:67], v22 offset:448
    v_lshlrev_b32 v38, 16, v82
    v_and_b32 v39, s58, v82
    v_add_f32 v34, v34, v38
    v_mfma_f32_32x32x16_bf16 v[224:239], v[84:87], v[68:71], v[224:239]
    v_add_f32 v35, v35, v39
    v_lshlrev_b32 v40, 16, v83
    v_and_b32 v41, s58, v83
    v_mfma_f32_32x32x16_bf16 v[240:255], v[84:87], v[72:75], v[240:255]
    v_add_f32 v34, v34, v40
    v_add_f32 v35, v35, v41
    s_waitcnt lgkmcnt(0)
    v_mfma_f32_32x32x16_bf16 v[160:175], v[56:59], v[48:51], v[160:175]
    ds_read_b128 v[68:71], v19 offset:0
    ds_read_b64_tr_b16 v[76:77], v23 offset:0
    ds_read_b64_tr_b16 v[78:79], v23 offset:384
    v_lshlrev_b32 v38, 16, v64
    v_and_b32 v39, s58, v64
    v_add_f32 v36, 0, v38
    v_add_f32 v37, 0, v39
    v_lshlrev_b32 v40, 16, v65
    v_and_b32 v41, s58, v65
    v_mfma_f32_32x32x16_bf16 v[176:191], v[56:59], v[52:55], v[176:191]
    ds_read_b128 v[72:75], v19 offset:4096
    ds_read_b64_tr_b16 v[80:81], v23 offset:32
    ds_read_b64_tr_b16 v[82:83], v23 offset:416
    v_add_f32 v36, v36, v40
    v_add_f32 v37, v37, v41
    v_lshlrev_b32 v38, 16, v66
    v_and_b32 v39, s58, v66
    v_add_f32 v36, v36, v38
    v_mfma_f32_32x32x16_bf16 v[192:207], v[60:63], v[48:51], v[192:207]
    ds_read_b64_tr_b16 v[84:85], v23 offset:64
    ds_read_b64_tr_b16 v[86:87], v23 offset:448
    v_add_f32 v37, v37, v39
    v_lshlrev_b32 v40, 16, v67
    v_and_b32 v41, s58, v67
    v_add_f32 v36, v36, v40
    v_add_f32 v37, v37, v41
    v_mfma_f32_32x32x16_bf16 v[208:223], v[60:63], v[52:55], v[208:223]
    v_add_f32 v32, v32, v33
    v_add_f32 v34, v34, v35
    v_add_f32 v36, v36, v37
    v_mov_b32 v33, v32
    v_mov_b32 v35, v34
    v_mov_b32 v37, v36
    s_nop 1
    v_permlane32_swap_b32 v32, v33
    v_permlane32_swap_b32 v34, v35
    v_permlane32_swap_b32 v36, v37
    v_mfma_f32_32x32x16_bf16 v[224:239], v[64:67], v[48:51], v[224:239]
    v_and_b32 v1, 31, v0
    v_lshlrev_b32 v1, 2, v1
    s_mul_i32 s49, s33, 640
    s_add_u32 s49, s49, 160384
    v_add_u32 v1, s49, v1
    v_add_f32 v32, v32, v33
    v_add_f32 v34, v34, v35
    v_add_f32 v36, v36, v37
    ds_write_b32 v1, v32 offset:0
    ds_write_b32 v1, v34 offset:128
    ds_write_b32 v1, v36 offset:256
    s_waitcnt lgkmcnt(0)
    s_waitcnt vmcnt(4)
    s_barrier
    v_mfma_f32_32x32x16_bf16 v[240:255], v[64:67], v[52:55], v[240:255]
    v_mfma_f32_32x32x16_bf16 v[160:175], v[76:79], v[68:71], v[160:175]
    ds_read_b128 v[48:51], v16 offset:53376
    ds_read_b64_tr_b16 v[56:57], v20 offset:53376
    v_mfma_f32_32x32x16_bf16 v[176:191], v[76:79], v[72:75], v[176:191]
    ds_read_b64_tr_b16 v[58:59], v20 offset:53760
    ds_read_b128 v[52:55], v16 offset:57472
    v_mfma_f32_32x32x16_bf16 v[192:207], v[80:83], v[68:71], v[192:207]
    ds_read_b64_tr_b16 v[60:61], v20 offset:53408
    ds_read_b64_tr_b16 v[62:63], v20 offset:53792
    v_mfma_f32_32x32x16_bf16 v[208:223], v[80:83], v[72:75], v[208:223]
    ds_read_b64_tr_b16 v[64:65], v20 offset:53440
    ds_read_b64_tr_b16 v[66:67], v20 offset:53824
    v_mfma_f32_32x32x16_bf16 v[224:239], v[84:87], v[68:71], v[224:239]
    v_mfma_f32_32x32x16_bf16 v[240:255], v[84:87], v[72:75], v[240:255]
    v_lshlrev_b32 v1, 3, v0
    s_and_b32 s49, s33, 1
    s_lshl_b32 s49, s49, 9
    s_add_u32 s49, s49, 160128
    v_add_u32 v1, s49, v1
    ds_read_b64 v[104:105], v1 offset:0
    ds_read_b64 v[106:107], v1 offset:640
    ds_read_b64 v[108:109], v1 offset:1280
    ds_read_b64 v[110:111], v1 offset:1920
    s_waitcnt lgkmcnt(0)
    v_mfma_f32_32x32x16_bf16 v[160:175], v[56:59], v[48:51], v[160:175]
    ds_read_b128 v[68:71], v17 offset:53376
    ds_read_b64_tr_b16 v[76:77], v21 offset:53376
    v_add_f32 v104, v104, v106
    v_add_f32 v108, v108, v110
    v_mfma_f32_32x32x16_bf16 v[176:191], v[56:59], v[52:55], v[176:191]
    ds_read_b64_tr_b16 v[78:79], v21 offset:53760
    ds_read_b128 v[72:75], v17 offset:57472
    v_add_f32 v105, v105, v107
    v_add_f32 v109, v109, v111
    v_mfma_f32_32x32x16_bf16 v[192:207], v[60:63], v[48:51], v[192:207]
    ds_read_b64_tr_b16 v[80:81], v21 offset:53408
    ds_read_b64_tr_b16 v[82:83], v21 offset:53792
    v_add_f32 v112, v104, v108
    v_add_f32 v113, v105, v109
    v_mfma_f32_32x32x16_bf16 v[208:223], v[60:63], v[52:55], v[208:223]
    ds_read_b64_tr_b16 v[84:85], v21 offset:53440
    ds_read_b64_tr_b16 v[86:87], v21 offset:53824
    v_mov_b32 v114, s60
    v_xor_b32 v115, v112, v113
    v_mfma_f32_32x32x16_bf16 v[224:239], v[64:67], v[48:51], v[224:239]
    v_xor_b32 v115, s59, v115
    v_xor_b32 v115, s60, v115
    v_mfma_f32_32x32x16_bf16 v[240:255], v[64:67], v[52:55], v[240:255]
    buffer_store_dwordx4 v[112:115], v43, s[20:23], s76 offen sc1
    s_waitcnt lgkmcnt(0)
    v_mfma_f32_32x32x16_bf16 v[160:175], v[76:79], v[68:71], v[160:175]
    ds_read_b128 v[48:51], v18 offset:53376
    ds_read_b64_tr_b16 v[56:57], v22 offset:53376
    v_mfma_f32_32x32x16_bf16 v[176:191], v[76:79], v[72:75], v[176:191]
    ds_read_b64_tr_b16 v[58:59], v22 offset:53760
    ds_read_b128 v[52:55], v18 offset:57472
    v_mfma_f32_32x32x16_bf16 v[192:207], v[80:83], v[68:71], v[192:207]
    ds_read_b64_tr_b16 v[60:61], v22 offset:53408
    ds_read_b64_tr_b16 v[62:63], v22 offset:53792
    v_mfma_f32_32x32x16_bf16 v[208:223], v[80:83], v[72:75], v[208:223]
    ds_read_b64_tr_b16 v[64:65], v22 offset:53440
    ds_read_b64_tr_b16 v[66:67], v22 offset:53824
    v_mfma_f32_32x32x16_bf16 v[224:239], v[84:87], v[68:71], v[224:239]
    v_mfma_f32_32x32x16_bf16 v[240:255], v[84:87], v[72:75], v[240:255]
    s_waitcnt lgkmcnt(0)
    v_mfma_f32_32x32x16_bf16 v[160:175], v[56:59], v[48:51], v[160:175]
    ds_read_b128 v[68:71], v19 offset:53376
    ds_read_b64_tr_b16 v[76:77], v23 offset:53376
    ds_read_b64_tr_b16 v[78:79], v23 offset:53760
    v_mfma_f32_32x32x16_bf16 v[176:191], v[56:59], v[52:55], v[176:191]
    ds_read_b128 v[72:75], v19 offset:57472
    ds_read_b64_tr_b16 v[80:81], v23 offset:53408
    ds_read_b64_tr_b16 v[82:83], v23 offset:53792
    v_mfma_f32_32x32x16_bf16 v[192:207], v[60:63], v[48:51], v[192:207]
    ds_read_b64_tr_b16 v[84:85], v23 offset:53440
    ds_read_b64_tr_b16 v[86:87], v23 offset:53824
    v_mfma_f32_32x32x16_bf16 v[208:223], v[60:63], v[52:55], v[208:223]
    v_mfma_f32_32x32x16_bf16 v[224:239], v[64:67], v[48:51], v[224:239]
    s_waitcnt lgkmcnt(0)
    s_barrier
    v_mfma_f32_32x32x16_bf16 v[240:255], v[64:67], v[52:55], v[240:255]
    v_mfma_f32_32x32x16_bf16 v[160:175], v[76:79], v[68:71], v[160:175]
    ds_read_b128 v[48:51], v124 offset:0
    ds_read_b64_tr_b16 v[56:57], v128 offset:0
    v_mfma_f32_32x32x16_bf16 v[176:191], v[76:79], v[72:75], v[176:191]
    ds_read_b64_tr_b16 v[58:59], v128 offset:384
    ds_read_b128 v[52:55], v124 offset:4096
    v_mfma_f32_32x32x16_bf16 v[192:207], v[80:83], v[68:71], v[192:207]
    ds_read_b64_tr_b16 v[60:61], v128 offset:32
    ds_read_b64_tr_b16 v[62:63], v128 offset:416
    v_mfma_f32_32x32x16_bf16 v[208:223], v[80:83], v[72:75], v[208:223]
    ds_read_b64_tr_b16 v[64:65], v128 offset:64
    ds_read_b64_tr_b16 v[66:67], v128 offset:448
    v_mfma_f32_32x32x16_bf16 v[224:239], v[84:87], v[68:71], v[224:239]
    v_mfma_f32_32x32x16_bf16 v[240:255], v[84:87], v[72:75], v[240:255]
    s_waitcnt lgkmcnt(0)
    v_mfma_f32_32x32x16_bf16 v[160:175], v[56:59], v[48:51], v[160:175]
    ds_read_b128 v[68:71], v125 offset:0
    ds_read_b64_tr_b16 v[76:77], v129 offset:0
    v_mov_b32 v38, 1
    v_mov_b32 v39, 2
    v_mov_b32 v40, s60
    v_xor_b32 v41, v38, v39
    v_xor_b32 v41, s59, v41
    v_xor_b32 v41, s60, v41
    v_mfma_f32_32x32x16_bf16 v[176:191], v[56:59], v[52:55], v[176:191]
    ds_read_b64_tr_b16 v[78:79], v129 offset:384
    ds_read_b128 v[72:75], v125 offset:4096
    s_waitcnt vmcnt(2)
    buffer_store_dwordx4 v[38:41], v46, s[20:23], s77 offen sc1
    v_mfma_f32_32x32x16_bf16 v[192:207], v[60:63], v[48:51], v[192:207]
    ds_read_b64_tr_b16 v[80:81], v129 offset:32
    ds_read_b64_tr_b16 v[82:83], v129 offset:416
    v_mfma_f32_32x32x16_bf16 v[208:223], v[60:63], v[52:55], v[208:223]
    ds_read_b64_tr_b16 v[84:85], v129 offset:64
    ds_read_b64_tr_b16 v[86:87], v129 offset:448
    v_mfma_f32_32x32x16_bf16 v[224:239], v[64:67], v[48:51], v[224:239]
    v_mfma_f32_32x32x16_bf16 v[240:255], v[64:67], v[52:55], v[240:255]
    s_waitcnt lgkmcnt(0)
    v_mfma_f32_32x32x16_bf16 v[160:175], v[76:79], v[68:71], v[160:175]
    ds_read_b128 v[48:51], v126 offset:0
    ds_read_b64_tr_b16 v[56:57], v130 offset:0
    v_mfma_f32_32x32x16_bf16 v[176:191], v[76:79], v[72:75], v[176:191]
    ds_read_b64_tr_b16 v[58:59], v130 offset:384
    ds_read_b128 v[52:55], v126 offset:4096
    v_mfma_f32_32x32x16_bf16 v[192:207], v[80:83], v[68:71], v[192:207]
    ds_read_b64_tr_b16 v[60:61], v130 offset:32
    ds_read_b64_tr_b16 v[62:63], v130 offset:416
    v_mfma_f32_32x32x16_bf16 v[208:223], v[80:83], v[72:75], v[208:223]
    ds_read_b64_tr_b16 v[64:65], v130 offset:64
    ds_read_b64_tr_b16 v[66:67], v130 offset:448
    v_mfma_f32_32x32x16_bf16 v[224:239], v[84:87], v[68:71], v[224:239]
    v_mfma_f32_32x32x16_bf16 v[240:255], v[84:87], v[72:75], v[240:255]
    s_waitcnt lgkmcnt(0)
    v_mfma_f32_32x32x16_bf16 v[160:175], v[56:59], v[48:51], v[160:175]
    ds_read_b128 v[68:71], v127 offset:0
    ds_read_b64_tr_b16 v[76:77], v131 offset:0
    ds_read_b64_tr_b16 v[78:79], v131 offset:384
    v_mfma_f32_32x32x16_bf16 v[176:191], v[56:59], v[52:55], v[176:191]
    ds_read_b128 v[72:75], v127 offset:4096
    ds_read_b64_tr_b16 v[80:81], v131 offset:32
    ds_read_b64_tr_b16 v[82:83], v131 offset:416
    v_mfma_f32_32x32x16_bf16 v[192:207], v[60:63], v[48:51], v[192:207]
    ds_read_b64_tr_b16 v[84:85], v131 offset:64
    ds_read_b64_tr_b16 v[86:87], v131 offset:448
    v_mfma_f32_32x32x16_bf16 v[208:223], v[60:63], v[52:55], v[208:223]
    v_mfma_f32_32x32x16_bf16 v[224:239], v[64:67], v[48:51], v[224:239]
    s_waitcnt lgkmcnt(0)
    s_barrier
    v_mfma_f32_32x32x16_bf16 v[240:255], v[64:67], v[52:55], v[240:255]
    v_mfma_f32_32x32x16_bf16 v[160:175], v[76:79], v[68:71], v[160:175]
    ds_read_b128 v[48:51], v16 offset:0
    ds_read_b64_tr_b16 v[56:57], v20 offset:0
    v_mfma_f32_32x32x16_bf16 v[176:191], v[76:79], v[72:75], v[176:191]
    ds_read_b64_tr_b16 v[58:59], v20 offset:384
    ds_read_b128 v[52:55], v16 offset:4096
    v_mfma_f32_32x32x16_bf16 v[192:207], v[80:83], v[68:71], v[192:207]
    ds_read_b64_tr_b16 v[60:61], v20 offset:32
    ds_read_b64_tr_b16 v[62:63], v20 offset:416
    v_mfma_f32_32x32x16_bf16 v[208:223], v[80:83], v[72:75], v[208:223]
    ds_read_b64_tr_b16 v[64:65], v20 offset:64
    ds_read_b64_tr_b16 v[66:67], v20 offset:448
    v_mfma_f32_32x32x16_bf16 v[224:239], v[84:87], v[68:71], v[224:239]
    v_mfma_f32_32x32x16_bf16 v[240:255], v[84:87], v[72:75], v[240:255]
    s_waitcnt lgkmcnt(0)
    v_mfma_f32_32x32x16_bf16 v[160:175], v[56:59], v[48:51], v[160:175]
    ds_read_b128 v[68:71], v17 offset:0
    ds_read_b64_tr_b16 v[76:77], v21 offset:0
    v_mov_b32 v38, 0
    v_mov_b32 v39, 0
    v_mov_b32 v40, 0
    v_mov_b32 v41, 0
    v_mfma_f32_32x32x16_bf16 v[176:191], v[56:59], v[52:55], v[176:191]
    ds_read_b64_tr_b16 v[78:79], v21 offset:384
    ds_read_b128 v[72:75], v17 offset:4096
    s_lshl_b32 s53, s34, 5
    s_add_u32 s53, s53, s36
    s_lshl_b32 s53, s53, 2
    s_add_u32 s53, s53, s33
    s_lshl_b32 s53, s53, 11
    s_add_u32 s53, s53, 7340032
    buffer_store_dwordx4 v[38:41], v31, s[20:23], s53 offen sc1
    v_mfma_f32_32x32x16_bf16 v[192:207], v[60:63], v[48:51], v[192:207]
    ds_read_b64_tr_b16 v[80:81], v21 offset:32
    ds_read_b64_tr_b16 v[82:83], v21 offset:416
    buffer_store_dwordx4 v[38:41], v31, s[20:23], s53 offen offset:1024 sc1
    v_mfma_f32_32x32x16_bf16 v[208:223], v[60:63], v[52:55], v[208:223]
    ds_read_b64_tr_b16 v[84:85], v21 offset:64
    ds_read_b64_tr_b16 v[86:87], v21 offset:448
    v_mfma_f32_32x32x16_bf16 v[224:239], v[64:67], v[48:51], v[224:239]
    v_mfma_f32_32x32x16_bf16 v[240:255], v[64:67], v[52:55], v[240:255]
    s_waitcnt lgkmcnt(0)
    v_mfma_f32_32x32x16_bf16 v[160:175], v[76:79], v[68:71], v[160:175]
    ds_read_b128 v[48:51], v18 offset:0
    ds_read_b64_tr_b16 v[56:57], v22 offset:0
    v_mfma_f32_32x32x16_bf16 v[176:191], v[76:79], v[72:75], v[176:191]
    ds_read_b64_tr_b16 v[58:59], v22 offset:384
    ds_read_b128 v[52:55], v18 offset:4096
    v_mfma_f32_32x32x16_bf16 v[192:207], v[80:83], v[68:71], v[192:207]
    ds_read_b64_tr_b16 v[60:61], v22 offset:32
    ds_read_b64_tr_b16 v[62:63], v22 offset:416
    v_mfma_f32_32x32x16_bf16 v[208:223], v[80:83], v[72:75], v[208:223]
    ds_read_b64_tr_b16 v[64:65], v22 offset:64
    ds_read_b64_tr_b16 v[66:67], v22 offset:448
    v_mfma_f32_32x32x16_bf16 v[224:239], v[84:87], v[68:71], v[224:239]
    v_mfma_f32_32x32x16_bf16 v[240:255], v[84:87], v[72:75], v[240:255]
    s_waitcnt lgkmcnt(0)
    v_mfma_f32_32x32x16_bf16 v[160:175], v[56:59], v[48:51], v[160:175]
    ds_read_b128 v[68:71], v19 offset:0
    ds_read_b64_tr_b16 v[76:77], v23 offset:0
    ds_read_b64_tr_b16 v[78:79], v23 offset:384
    v_mfma_f32_32x32x16_bf16 v[176:191], v[56:59], v[52:55], v[176:191]
    ds_read_b128 v[72:75], v19 offset:4096
    ds_read_b64_tr_b16 v[80:81], v23 offset:32
    ds_read_b64_tr_b16 v[82:83], v23 offset:416
    v_mfma_f32_32x32x16_bf16 v[192:207], v[60:63], v[48:51], v[192:207]
    ds_read_b64_tr_b16 v[84:85], v23 offset:64
    ds_read_b64_tr_b16 v[86:87], v23 offset:448
    v_mfma_f32_32x32x16_bf16 v[208:223], v[60:63], v[52:55], v[208:223]
    v_mfma_f32_32x32x16_bf16 v[224:239], v[64:67], v[48:51], v[224:239]
    s_waitcnt lgkmcnt(0)
    s_barrier
    v_mfma_f32_32x32x16_bf16 v[240:255], v[64:67], v[52:55], v[240:255]
    v_mfma_f32_32x32x16_bf16 v[160:175], v[76:79], v[68:71], v[160:175]
    ds_read_b128 v[48:51], v16 offset:53376
    ds_read_b64_tr_b16 v[56:57], v20 offset:53376
    s_mul_i32 s49, s36, 8960
    s_lshl_b32 s50, s33, 10
    s_add_u32 s49, s49, s50
    s_add_u32 s49, s49, 12713984
    buffer_load_dwordx4 v[96:99], v31, s[20:23], s49 offen sc1
    v_mfma_f32_32x32x16_bf16 v[176:191], v[76:79], v[72:75], v[176:191]
    ds_read_b64_tr_b16 v[58:59], v20 offset:53760
    ds_read_b128 v[52:55], v16 offset:57472
    s_mul_i32 s49, s36, 8960
    s_lshl_b32 s50, s32, 10
    s_add_u32 s49, s49, s50
    s_add_u32 s49, s49, 12718080
    buffer_load_dwordx4 v[100:103], v31, s[20:23], s49 offen sc1
    v_mfma_f32_32x32x16_bf16 v[192:207], v[80:83], v[68:71], v[192:207]
    ds_read_b64_tr_b16 v[60:61], v20 offset:53408
    ds_read_b64_tr_b16 v[62:63], v20 offset:53792
    v_mfma_f32_32x32x16_bf16 v[208:223], v[80:83], v[72:75], v[208:223]
    ds_read_b64_tr_b16 v[64:65], v20 offset:53440
    ds_read_b64_tr_b16 v[66:67], v20 offset:53824
    v_mfma_f32_32x32x16_bf16 v[224:239], v[84:87], v[68:71], v[224:239]
    v_mfma_f32_32x32x16_bf16 v[240:255], v[84:87], v[72:75], v[240:255]
    s_waitcnt lgkmcnt(0)
    v_mfma_f32_32x32x16_bf16 v[160:175], v[56:59], v[48:51], v[160:175]
    ds_read_b128 v[68:71], v17 offset:53376
    ds_read_b64_tr_b16 v[76:77], v21 offset:53376
    v_mfma_f32_32x32x16_bf16 v[176:191], v[56:59], v[52:55], v[176:191]
    ds_read_b64_tr_b16 v[78:79], v21 offset:53760
    ds_read_b128 v[72:75], v17 offset:57472
    v_mfma_f32_32x32x16_bf16 v[192:207], v[60:63], v[48:51], v[192:207]
    ds_read_b64_tr_b16 v[80:81], v21 offset:53408
    ds_read_b64_tr_b16 v[82:83], v21 offset:53792
    v_mfma_f32_32x32x16_bf16 v[208:223], v[60:63], v[52:55], v[208:223]
    ds_read_b64_tr_b16 v[84:85], v21 offset:53440
    ds_read_b64_tr_b16 v[86:87], v21 offset:53824
    v_mfma_f32_32x32x16_bf16 v[224:239], v[64:67], v[48:51], v[224:239]
    v_mfma_f32_32x32x16_bf16 v[240:255], v[64:67], v[52:55], v[240:255]
    s_waitcnt lgkmcnt(0)
    v_mfma_f32_32x32x16_bf16 v[160:175], v[76:79], v[68:71], v[160:175]
    ds_read_b128 v[48:51], v18 offset:53376
    ds_read_b64_tr_b16 v[56:57], v22 offset:53376
    v_mfma_f32_32x32x16_bf16 v[176:191], v[76:79], v[72:75], v[176:191]
    ds_read_b64_tr_b16 v[58:59], v22 offset:53760
    ds_read_b128 v[52:55], v18 offset:57472
    v_mfma_f32_32x32x16_bf16 v[192:207], v[80:83], v[68:71], v[192:207]
    ds_read_b64_tr_b16 v[60:61], v22 offset:53408
    ds_read_b64_tr_b16 v[62:63], v22 offset:53792
    v_mfma_f32_32x32x16_bf16 v[208:223], v[80:83], v[72:75], v[208:223]
    ds_read_b64_tr_b16 v[64:65], v22 offset:53440
    ds_read_b64_tr_b16 v[66:67], v22 offset:53824
    v_mfma_f32_32x32x16_bf16 v[224:239], v[84:87], v[68:71], v[224:239]
    v_mfma_f32_32x32x16_bf16 v[240:255], v[84:87], v[72:75], v[240:255]
    s_waitcnt lgkmcnt(0)
    v_mfma_f32_32x32x16_bf16 v[160:175], v[56:59], v[48:51], v[160:175]
    ds_read_b128 v[68:71], v19 offset:53376
    ds_read_b64_tr_b16 v[76:77], v23 offset:53376
    ds_read_b64_tr_b16 v[78:79], v23 offset:53760
    v_mfma_f32_32x32x16_bf16 v[176:191], v[56:59], v[52:55], v[176:191]
    ds_read_b128 v[72:75], v19 offset:57472
    ds_read_b64_tr_b16 v[80:81], v23 offset:53408
    ds_read_b64_tr_b16 v[82:83], v23 offset:53792
    v_mfma_f32_32x32x16_bf16 v[192:207], v[60:63], v[48:51], v[192:207]
    ds_read_b64_tr_b16 v[84:85], v23 offset:53440
    ds_read_b64_tr_b16 v[86:87], v23 offset:53824
    v_mfma_f32_32x32x16_bf16 v[208:223], v[60:63], v[52:55], v[208:223]
    v_mfma_f32_32x32x16_bf16 v[224:239], v[64:67], v[48:51], v[224:239]
    s_waitcnt lgkmcnt(0)
    s_barrier
    v_mfma_f32_32x32x16_bf16 v[240:255], v[64:67], v[52:55], v[240:255]
    v_mfma_f32_32x32x16_bf16 v[160:175], v[76:79], v[68:71], v[160:175]
    ds_read_b128 v[48:51], v124 offset:0
    ds_read_b64_tr_b16 v[56:57], v128 offset:0
    s_lshr_b32 s53, s2, 3
    s_lshl_b32 s53, s53, 3
    s_add_u32 s53, s53, s32
    v_lshlrev_b32 v32, 7, v0
    s_cmp_lt_u32 s53, 196
    s_cselect_b32 s64, s24, s80
    s_cselect_b32 s65, s25, s81
    s_mov_b32 s66, 401408
    s_cselect_b32 s66, 1605632, s66
    s_mov_b32 s67, 0x20000
    s_cselect_b32 s54, 0, 196
    s_sub_u32 s53, s53, s54
    s_lshl_b32 s53, s53, 13
    v_add_u32 v32, s53, v32
    v_mfma_f32_32x32x16_bf16 v[176:191], v[76:79], v[72:75], v[176:191]
    ds_read_b64_tr_b16 v[58:59], v128 offset:384
    ds_read_b128 v[52:55], v124 offset:4096
    s_mov_b32 exec_lo, 0xffffffff
    s_mov_b32 exec_hi, 0xffffffff
    buffer_load_dword v33, v32, s[64:67], 0 offen
    s_mov_b64 exec, -1
    v_mfma_f32_32x32x16_bf16 v[192:207], v[80:83], v[68:71], v[192:207]
    ds_read_b64_tr_b16 v[60:61], v128 offset:32
    ds_read_b64_tr_b16 v[62:63], v128 offset:416
    v_mfma_f32_32x32x16_bf16 v[208:223], v[80:83], v[72:75], v[208:223]
    ds_read_b64_tr_b16 v[64:65], v128 offset:64
    ds_read_b64_tr_b16 v[66:67], v128 offset:448
    v_mfma_f32_32x32x16_bf16 v[224:239], v[84:87], v[68:71], v[224:239]
    v_mfma_f32_32x32x16_bf16 v[240:255], v[84:87], v[72:75], v[240:255]
    s_waitcnt lgkmcnt(0)
    v_mfma_f32_32x32x16_bf16 v[160:175], v[56:59], v[48:51], v[160:175]
    ds_read_b128 v[68:71], v125 offset:0
    ds_read_b64_tr_b16 v[76:77], v129 offset:0
    s_cmp_eq_u32 s32, 4
    s_cselect_b32 s70, -1, 0
    s_cselect_b32 s71, 0xffff, 0
    s_mov_b32 s78, 0
    s_waitcnt vmcnt(1)
    v_mfma_f32_32x32x16_bf16 v[176:191], v[56:59], v[52:55], v[176:191]
    ds_read_b64_tr_b16 v[78:79], v129 offset:384
    ds_read_b128 v[72:75], v125 offset:4096
    v_xor_b32 v108, v96, v97
    v_mfma_f32_32x32x16_bf16 v[192:207], v[60:63], v[48:51], v[192:207]
    ds_read_b64_tr_b16 v[80:81], v129 offset:32
    ds_read_b64_tr_b16 v[82:83], v129 offset:416
    v_xor_b32 v108, s59, v108
    v_mfma_f32_32x32x16_bf16 v[208:223], v[60:63], v[52:55], v[208:223]
    ds_read_b64_tr_b16 v[84:85], v129 offset:64
    ds_read_b64_tr_b16 v[86:87], v129 offset:448
    v_xor_b32 v108, v98, v108
    v_subrev_u32 v109, s55, v98
    v_mfma_f32_32x32x16_bf16 v[224:239], v[64:67], v[48:51], v[224:239]
    v_cmp_eq_u32 vcc, v108, v99
    v_mfma_f32_32x32x16_bf16 v[240:255], v[64:67], v[52:55], v[240:255]
    v_cmp_gt_u32_e64 s[68:69], s79, v109
    s_waitcnt lgkmcnt(0)
    v_mfma_f32_32x32x16_bf16 v[160:175], v[76:79], v[68:71], v[160:175]
    ds_read_b128 v[48:51], v126 offset:0
    ds_read_b64_tr_b16 v[56:57], v130 offset:0
    s_nop 1
    s_and_b64 s[68:69], s[68:69], vcc
    v_mfma_f32_32x32x16_bf16 v[176:191], v[76:79], v[72:75], v[176:191]
    ds_read_b64_tr_b16 v[58:59], v130 offset:384
    ds_read_b128 v[52:55], v126 offset:4096
    v_xor_b32 v110, v100, v101
    v_mfma_f32_32x32x16_bf16 v[192:207], v[80:83], v[68:71], v[192:207]
    ds_read_b64_tr_b16 v[60:61], v130 offset:32
    ds_read_b64_tr_b16 v[62:63], v130 offset:416
    v_xor_b32 v110, s59, v110
    v_mfma_f32_32x32x16_bf16 v[208:223], v[80:83], v[72:75], v[208:223]
    ds_read_b64_tr_b16 v[64:65], v130 offset:64
    ds_read_b64_tr_b16 v[66:67], v130 offset:448
    v_xor_b32 v110, v102, v110
    v_subrev_u32 v111, s55, v102
    v_mfma_f32_32x32x16_bf16 v[224:239], v[84:87], v[68:71], v[224:239]
    v_cmp_eq_u32 vcc, v110, v103
    v_mfma_f32_32x32x16_bf16 v[240:255], v[84:87], v[72:75], v[240:255]
    v_cmp_gt_u32_e64 s[84:85], s79, v111
    s_waitcnt lgkmcnt(0)
    v_mfma_f32_32x32x16_bf16 v[160:175], v[56:59], v[48:51], v[160:175]
    ds_read_b128 v[68:71], v127 offset:0
    ds_read_b64_tr_b16 v[76:77], v131 offset:0
    ds_read_b64_tr_b16 v[78:79], v131 offset:384
    s_nop 1
    s_and_b64 s[84:85], s[84:85], vcc
    v_mfma_f32_32x32x16_bf16 v[176:191], v[56:59], v[52:55], v[176:191]
    ds_read_b128 v[72:75], v127 offset:4096
    ds_read_b64_tr_b16 v[80:81], v131 offset:32
    ds_read_b64_tr_b16 v[82:83], v131 offset:416
    s_orn2_b64 s[84:85], s[84:85], s[70:71]
    s_and_b64 s[68:69], s[68:69], s[84:85]
    s_cmp_eq_u64 s[68:69], -1
    s_cbranch_scc0 K1_A1_slow
K1_A1_ok:
    v_mfma_f32_32x32x16_bf16 v[192:207], v[60:63], v[48:51], v[192:207]
    ds_read_b64_tr_b16 v[84:85], v131 offset:64
    ds_read_b64_tr_b16 v[86:87], v131 offset:448
    s_lshl_b32 s49, s33, 9
    s_add_u32 s49, s49, 55424
    v_lshlrev_b32 v1, 3, v0
    v_add_u32 v1, s49, v1
    ds_write_b64 v1, v[96:97]
    v_mfma_f32_32x32x16_bf16 v[208:223], v[60:63], v[52:55], v[208:223]
    s_lshl_b32 s49, s32, 9
    s_add_u32 s49, s49, 57472
    v_lshlrev_b32 v1, 3, v0
    v_add_u32 v2, s49, v1
    v_add_u32 v1, 160128, v1
    v_cndmask_b32_e64 v1, v1, v2, s[70:71]
    ds_write_b64 v1, v[100:101]
    v_mfma_f32_32x32x16_bf16 v[224:239], v[64:67], v[48:51], v[224:239]
    s_waitcnt lgkmcnt(0)
    s_setprio 3
    s_barrier
    v_mfma_f32_32x32x16_bf16 v[240:255], v[64:67], v[52:55], v[240:255]
    v_mfma_f32_32x32x16_bf16 v[160:175], v[76:79], v[68:71], v[160:175]
    ds_read_b128 v[48:51], v16 offset:0
    ds_read_b64_tr_b16 v[56:57], v20 offset:0
    s_lshr_b32 s53, s2, 3
    s_sub_u32 s53, s53, 4
    s_max_i32 s53, s53, 0
    s_mul_i32 s54, s53, 37
    s_lshr_b32 s54, s54, 8
    s_mul_i32 s54, s54, 7
    s_sub_u32 s53, s53, s54
    s_lshl_b32 s53, s53, 7
    s_mul_i32 s37, s32, 200704
    s_add_u32 s37, s37, s53
    s_add_u32 s37, s37, 0
    s_mul_i32 s39, s32, 50176
    s_add_u32 s39, s39, s53
    s_add_u32 s39, s39, 0
    s_mul_i32 s41, s32, 20480
    s_add_u32 s41, s41, 0
    v_lshrrev_b32 v5, 3, v0
    v_lshrrev_b32 v6, 4, v0
    v_and_b32 v6, 1, v6
    v_lshlrev_b32 v6, 2, v6
    v_and_b32 v7, 7, v0
    v_xor_b32 v7, v7, v6
    v_lshlrev_b32 v7, 4, v7
    v_mul_u32_u24 v28, 896, v5
    v_add_u32 v28, v28, v7
    v_and_b32 v6, 3, v5
    v_subrev_u32 v29, 896, v28
    v_cmp_gt_u32 vcc, 32, v0
    s_nop 1
    v_cndmask_b32 v29, v29, v28, vcc
    v_mov_b32 v7, 0x40000000
    v_cmp_eq_u32 vcc, 3, v6
    s_nop 1
    v_cndmask_b32 v29, v29, v7, vcc
    v_and_b32 v1, 31, v0
    v_lshlrev_b32 v1, 2, v1
    s_lshl_b32 s49, s33, 8
    s_add_u32 s49, s49, 53376
    v_add_u32 v2, s49, v1
    ds_read_b32 v157, v2
    ds_read_b32 v158, v2 offset:128
    v_add_u32 v3, 55680, v1
    ds_read_b32 v136, v3 offset:0
    v_mfma_f32_32x32x16_bf16 v[176:191], v[76:79], v[72:75], v[176:191]
    ds_read_b64_tr_b16 v[58:59], v20 offset:384
    ds_read_b128 v[52:55], v16 offset:4096
    s_add_u32 m0, s41, 0
    s_add_u32 s40, s37, 0
    buffer_load_dwordx4 v28, s[24:27], s40 offen lds
    ds_read_b32 v137, v3 offset:640
    ds_read_b32 v138, v3 offset:1280
    v_mfma_f32_32x32x16_bf16 v[192:207], v[80:83], v[68:71], v[192:207]
    ds_read_b64_tr_b16 v[60:61], v20 offset:32
    ds_read_b64_tr_b16 v[62:63], v20 offset:416
    s_add_u32 m0, s41, 1024
    s_add_u32 s40, s37, 7168
    buffer_load_dwordx4 v28, s[24:27], s40 offen lds
    ds_read_b32 v139, v3 offset:1920
    ds_read_b32 v140, v3 offset:2560
    v_mfma_f32_32x32x16_bf16 v[208:223], v[80:83], v[72:75], v[208:223]
    ds_read_b64_tr_b16 v[64:65], v20 offset:64
    ds_read_b64_tr_b16 v[66:67], v20 offset:448
    s_add_u32 m0, s41, 2048
    s_add_u32 s40, s37, 14336
    buffer_load_dwordx4 v28, s[24:27], s40 offen lds
    ds_read_b32 v141, v3 offset:3200
    ds_read_b32 v142, v3 offset:3840
    v_mfma_f32_32x32x16_bf16 v[224:239], v[84:87], v[68:71], v[224:239]
    s_add_u32 m0, s41, 3072
    s_add_u32 s40, s37, 21504
    buffer_load_dwordx4 v28, s[24:27], s40 offen lds
    ds_read_b32 v143, v3 offset:128
    ds_read_b32 v144, v3 offset:768
    v_mfma_f32_32x32x16_bf16 v[240:255], v[84:87], v[72:75], v[240:255]
    s_add_u32 m0, s41, 4096
    s_add_u32 s40, s37, 28672
    buffer_load_dwordx4 v28, s[24:27], s40 offen lds
    ds_read_b32 v145, v3 offset:1408
    s_waitcnt lgkmcnt(0)
    v_mfma_f32_32x32x16_bf16 v[160:175], v[56:59], v[48:51], v[160:175]
    ds_read_b128 v[68:71], v17 offset:0
    ds_read_b64_tr_b16 v[76:77], v21 offset:0
    s_add_u32 m0, s41, 5120
    s_add_u32 s40, s37, 35840
    buffer_load_dwordx4 v28, s[24:27], s40 offen lds
    ds_read_b32 v146, v3 offset:2048
    ds_read_b32 v147, v3 offset:2688
    v_mfma_f32_32x32x16_bf16 v[176:191], v[56:59], v[52:55], v[176:191]
    ds_read_b64_tr_b16 v[78:79], v21 offset:384
    ds_read_b128 v[72:75], v17 offset:4096
    s_add_u32 m0, s41, 6144
    s_add_u32 s40, s37, 43008
    buffer_load_dwordx4 v28, s[24:27], s40 offen lds
    ds_read_b32 v148, v3 offset:3328
    ds_read_b32 v149, v3 offset:3968
    v_mfma_f32_32x32x16_bf16 v[192:207], v[60:63], v[48:51], v[192:207]
    ds_read_b64_tr_b16 v[80:81], v21 offset:32
    ds_read_b64_tr_b16 v[82:83], v21 offset:416
    ds_read_b32 v150, v3 offset:256
    ds_read_b32 v151, v3 offset:896
    v_mfma_f32_32x32x16_bf16 v[208:223], v[60:63], v[52:55], v[208:223]
    ds_read_b64_tr_b16 v[84:85], v21 offset:64
    ds_read_b64_tr_b16 v[86:87], v21 offset:448
    s_add_u32 m0, s41, 7168
    s_add_u32 s40, s37, 50176
    buffer_load_dwordx4 v28, s[24:27], s40 offen lds
    ds_read_b32 v152, v3 offset:1536
    ds_read_b32 v153, v3 offset:2176
    v_mfma_f32_32x32x16_bf16 v[224:239], v[64:67], v[48:51], v[224:239]
    s_add_u32 m0, s41, 8192
    s_add_u32 s40, s37, 57344
    buffer_load_dwordx4 v28, s[24:27], s40 offen lds
    ds_read_b32 v154, v3 offset:2816
    ds_read_b32 v155, v3 offset:3456
    v_mfma_f32_32x32x16_bf16 v[240:255], v[64:67], v[52:55], v[240:255]
    s_add_u32 m0, s41, 9216
    s_add_u32 s40, s37, 64512
    buffer_load_dwordx4 v28, s[24:27], s40 offen lds
    ds_read_b32 v156, v3 offset:4096
    s_waitcnt lgkmcnt(0)
    v_mfma_f32_32x32x16_bf16 v[160:175], v[76:79], v[68:71], v[160:175]
    ds_read_b128 v[48:51], v18 offset:0
    ds_read_b64_tr_b16 v[56:57], v22 offset:0
    s_add_u32 m0, s41, 10240
    s_add_u32 s40, s37, 71680
    buffer_load_dwordx4 v28, s[24:27], s40 offen lds
    v_sub_f32 v157, 0, v157
    v_cndmask_b32_e64 v157, 0, v157, s[62:63]
    v_sub_f32 v158, 0, v158
    v_mfma_f32_32x32x16_bf16 v[176:191], v[76:79], v[72:75], v[176:191]
    ds_read_b64_tr_b16 v[58:59], v22 offset:384
    ds_read_b128 v[52:55], v18 offset:4096
    s_add_u32 m0, s41, 11264
    s_add_u32 s40, s37, 78848
    buffer_load_dwordx4 v28, s[24:27], s40 offen lds
    v_cndmask_b32_e64 v158, 0, v158, s[62:63]
    v_cvt_pk_bf16_f32 v89, v157, 0
    v_cvt_pk_bf16_f32 v93, v158, 0
    v_mfma_f32_32x32x16_bf16 v[192:207], v[80:83], v[68:71], v[192:207]
    ds_read_b64_tr_b16 v[60:61], v22 offset:32
    ds_read_b64_tr_b16 v[62:63], v22 offset:416
    s_add_u32 m0, s41, 12288
    s_add_u32 s40, s39, 0
    buffer_load_dwordx4 v28, s[80:83], s40 offen lds
    v_lshlrev_b32 v1, 16, v89
    v_lshlrev_b32 v2, 16, v93
    v_sub_f32 v1, v157, v1
    v_mfma_f32_32x32x16_bf16 v[208:223], v[80:83], v[72:75], v[208:223]
    ds_read_b64_tr_b16 v[64:65], v22 offset:64
    ds_read_b64_tr_b16 v[66:67], v22 offset:448
    s_add_u32 m0, s41, 13312
    s_add_u32 s40, s39, 7168
    buffer_load_dwordx4 v29, s[80:83], s40 offen lds
    v_sub_f32 v2, v158, v2
    v_cvt_pk_bf16_f32 v88, v157, v1
    v_mov_b32 v90, 0
    v_mfma_f32_32x32x16_bf16 v[224:239], v[84:87], v[68:71], v[224:239]
    v_mov_b32 v91, 0
    v_cvt_pk_bf16_f32 v92, v158, v2
    v_mov_b32 v94, 0
    v_mfma_f32_32x32x16_bf16 v[240:255], v[84:87], v[72:75], v[240:255]
    s_add_u32 m0, s41, 14336
    s_add_u32 s40, s39, 12544
    buffer_load_dwordx4 v28, s[80:83], s40 offen lds
    v_mov_b32 v95, 0
    v_add_f32 v136, v136, v137
    v_add_f32 v138, v138, v139
    s_waitcnt lgkmcnt(0)
    v_mfma_f32_32x32x16_bf16 v[160:175], v[56:59], v[48:51], v[160:175]
    ds_read_b128 v[68:71], v19 offset:0
    ds_read_b64_tr_b16 v[76:77], v23 offset:0
    s_add_u32 m0, s41, 15360
    s_add_u32 s40, s39, 19712
    buffer_load_dwordx4 v29, s[80:83], s40 offen lds
    v_add_f32 v140, v140, v141
    v_add_f32 v136, v136, v142
    v_add_f32 v138, v138, v140
    v_mfma_f32_32x32x16_bf16 v[176:191], v[56:59], v[52:55], v[176:191]
    ds_read_b64_tr_b16 v[78:79], v23 offset:384
    ds_read_b128 v[72:75], v19 offset:4096
    s_add_u32 m0, s41, 16384
    s_add_u32 s40, s39, 25088
    buffer_load_dwordx4 v28, s[80:83], s40 offen lds
    v_add_f32 v136, v136, v138
    v_cvt_pk_bf16_f32 v96, v136, v136
    v_lshlrev_b32 v137, 16, v96
    v_mfma_f32_32x32x16_bf16 v[192:207], v[60:63], v[48:51], v[192:207]
    ds_read_b64_tr_b16 v[80:81], v23 offset:32
    ds_read_b64_tr_b16 v[82:83], v23 offset:416
    s_add_u32 m0, s41, 17408
    s_add_u32 s40, s39, 32256
    buffer_load_dwordx4 v29, s[80:83], s40 offen lds
    v_sub_f32 v137, v136, v137
    v_cvt_pk_bf16_f32 v97, v137, 0
    v_mfma_f32_32x32x16_bf16 v[208:223], v[60:63], v[52:55], v[208:223]
    ds_read_b64_tr_b16 v[84:85], v23 offset:64
    ds_read_b64_tr_b16 v[86:87], v23 offset:448
    s_add_u32 m0, s41, 18432
    s_add_u32 s40, s39, 37632
    buffer_load_dwordx4 v28, s[80:83], s40 offen lds
    v_mov_b32 v98, 0
    v_mov_b32 v99, 0
    v_add_f32 v143, v143, v144
    v_mfma_f32_32x32x16_bf16 v[224:239], v[64:67], v[48:51], v[224:239]
    s_add_u32 m0, s41, 19456
    s_add_u32 s40, s39, 44800
    buffer_load_dwordx4 v29, s[80:83], s40 offen lds
    v_add_f32 v145, v145, v146
    v_add_f32 v147, v147, v148
    v_add_f32 v143, v143, v149
    v_mfma_f32_32x32x16_bf16 v[240:255], v[64:67], v[52:55], v[240:255]
    v_add_f32 v145, v145, v147
    v_add_f32 v143, v143, v145
    v_cvt_pk_bf16_f32 v100, v143, v143
    s_waitcnt lgkmcnt(0)
    v_mfma_f32_32x32x16_bf16 v[160:175], v[76:79], v[68:71], v[160:175]
    v_lshlrev_b32 v144, 16, v100
    v_sub_f32 v144, v143, v144
    v_cvt_pk_bf16_f32 v101, v144, 0
    v_mfma_f32_32x32x16_bf16 v[176:191], v[76:79], v[72:75], v[176:191]
    v_mov_b32 v102, 0
    v_mov_b32 v103, 0
    v_add_f32 v150, v150, v151
    v_mfma_f32_32x32x16_bf16 v[192:207], v[80:83], v[68:71], v[192:207]
    v_add_f32 v152, v152, v153
    v_add_f32 v154, v154, v155
    v_add_f32 v150, v150, v156
    v_mfma_f32_32x32x16_bf16 v[208:223], v[80:83], v[72:75], v[208:223]
    v_add_f32 v152, v152, v154
    v_add_f32 v150, v150, v152
    v_cvt_pk_bf16_f32 v104, v150, v150
    v_mfma_f32_32x32x16_bf16 v[224:239], v[84:87], v[68:71], v[224:239]
    v_lshlrev_b32 v151, 16, v104
    v_sub_f32 v151, v150, v151
    v_cvt_pk_bf16_f32 v105, v151, 0
    v_mfma_f32_32x32x16_bf16 v[240:255], v[84:87], v[72:75], v[240:255]
    v_mov_b32 v106, 0
    v_mov_b32 v107, 0
    v_mfma_f32_32x32x16_bf16 v[160:175], v[96:99], v[88:91], v[160:175]
    v_mfma_f32_32x32x16_bf16 v[176:191], v[96:99], v[92:95], v[176:191]
    v_mfma_f32_32x32x16_bf16 v[192:207], v[100:103], v[88:91], v[192:207]
    v_mfma_f32_32x32x16_bf16 v[208:223], v[100:103], v[92:95], v[208:223]
    v_mfma_f32_32x32x16_bf16 v[224:239], v[104:107], v[88:91], v[224:239]
    v_mfma_f32_32x32x16_bf16 v[240:255], v[104:107], v[92:95], v[240:255]
    s_lshl_b32 s49, s34, 3
    s_lshl_b32 s50, s33, 1
    s_add_u32 s49, s49, s50
    s_nop 7
    s_nop 3
    s_mul_i32 s52, s29, 3
    s_add_u32 s52, s52, 0
    v_max_f32 v160, 0, v160
    v_max_f32 v161, 0, v161
    v_max_f32 v162, 0, v162
    v_max_f32 v163, 0, v163
    v_max_f32 v164, 0, v164
    v_max_f32 v165, 0, v165
    v_max_f32 v166, 0, v166
    v_max_f32 v167, 0, v167
    v_pk_mul_f32 v[160:161], v[160:161], v[168:169]
    v_pk_mul_f32 v[162:163], v[162:163], v[170:171]
    v_pk_mul_f32 v[164:165], v[164:165], v[172:173]
    v_pk_mul_f32 v[166:167], v[166:167], v[174:175]
    v_cvt_pk_bf16_f32 v48, v160, v161
    v_cvt_pk_bf16_f32 v49, v162, v163
    v_cvt_pk_bf16_f32 v50, v164, v165
    v_cvt_pk_bf16_f32 v51, v166, v167
    s_add_u32 s51, s49, 0
    s_mul_i32 s51, s51, 112
    s_add_u32 s51, s51, s52
    s_lshl_b32 s51, s51, 10
    buffer_store_dwordx4 v[48:51], v31, s[20:23], s51 offen sc1
    v_max_f32 v176, 0, v176
    v_max_f32 v177, 0, v177
    v_max_f32 v178, 0, v178
    v_max_f32 v179, 0, v179
    v_max_f32 v180, 0, v180
    v_max_f32 v181, 0, v181
    v_max_f32 v182, 0, v182
    v_max_f32 v183, 0, v183
    v_pk_mul_f32 v[176:177], v[176:177], v[184:185]
    v_pk_mul_f32 v[178:179], v[178:179], v[186:187]
    v_pk_mul_f32 v[180:181], v[180:181], v[188:189]
    v_pk_mul_f32 v[182:183], v[182:183], v[190:191]
    v_cvt_pk_bf16_f32 v52, v176, v177
    v_cvt_pk_bf16_f32 v53, v178, v179
    v_cvt_pk_bf16_f32 v54, v180, v181
    v_cvt_pk_bf16_f32 v55, v182, v183
    s_add_u32 s51, s49, 1
    s_mul_i32 s51, s51, 112
    s_add_u32 s51, s51, s52
    s_lshl_b32 s51, s51, 10
    buffer_store_dwordx4 v[52:55], v31, s[20:23], s51 offen sc1
    s_mul_i32 s52, s29, 3
    s_add_u32 s52, s52, 1
    v_max_f32 v192, 0, v192
    v_max_f32 v193, 0, v193
    v_max_f32 v194, 0, v194
    v_max_f32 v195, 0, v195
    v_max_f32 v196, 0, v196
    v_max_f32 v197, 0, v197
    v_max_f32 v198, 0, v198
    v_max_f32 v199, 0, v199
    v_pk_mul_f32 v[192:193], v[192:193], v[200:201]
    v_pk_mul_f32 v[194:195], v[194:195], v[202:203]
    v_pk_mul_f32 v[196:197], v[196:197], v[204:205]
    v_pk_mul_f32 v[198:199], v[198:199], v[206:207]
    v_cvt_pk_bf16_f32 v56, v192, v193
    v_cvt_pk_bf16_f32 v57, v194, v195
    v_cvt_pk_bf16_f32 v58, v196, v197
    v_cvt_pk_bf16_f32 v59, v198, v199
    s_add_u32 s51, s49, 0
    s_mul_i32 s51, s51, 112
    s_add_u32 s51, s51, s52
    s_lshl_b32 s51, s51, 10
    buffer_store_dwordx4 v[56:59], v31, s[20:23], s51 offen sc1
    v_max_f32 v208, 0, v208
    v_max_f32 v209, 0, v209
    v_max_f32 v210, 0, v210
    v_max_f32 v211, 0, v211
    v_max_f32 v212, 0, v212
    v_max_f32 v213, 0, v213
    v_max_f32 v214, 0, v214
    v_max_f32 v215, 0, v215
    v_pk_mul_f32 v[208:209], v[208:209], v[216:217]
    v_pk_mul_f32 v[210:211], v[210:211], v[218:219]
    v_pk_mul_f32 v[212:213], v[212:213], v[220:221]
    v_pk_mul_f32 v[214:215], v[214:215], v[222:223]
    v_cvt_pk_bf16_f32 v60, v208, v209
    v_cvt_pk_bf16_f32 v61, v210, v211
    v_cvt_pk_bf16_f32 v62, v212, v213
    v_cvt_pk_bf16_f32 v63, v214, v215
    s_add_u32 s51, s49, 1
    s_mul_i32 s51, s51, 112
    s_add_u32 s51, s51, s52
    s_lshl_b32 s51, s51, 10
    buffer_store_dwordx4 v[60:63], v31, s[20:23], s51 offen sc1
    s_mul_i32 s52, s29, 3
    s_add_u32 s52, s52, 2
    v_max_f32 v224, 0, v224
    v_max_f32 v225, 0, v225
    v_max_f32 v226, 0, v226
    v_max_f32 v227, 0, v227
    v_max_f32 v228, 0, v228
    v_max_f32 v229, 0, v229
    v_max_f32 v230, 0, v230
    v_max_f32 v231, 0, v231
    v_pk_mul_f32 v[224:225], v[224:225], v[232:233]
    v_pk_mul_f32 v[226:227], v[226:227], v[234:235]
    v_pk_mul_f32 v[228:229], v[228:229], v[236:237]
    v_pk_mul_f32 v[230:231], v[230:231], v[238:239]
    v_cvt_pk_bf16_f32 v64, v224, v225
    v_cvt_pk_bf16_f32 v65, v226, v227
    v_cvt_pk_bf16_f32 v66, v228, v229
    v_cvt_pk_bf16_f32 v67, v230, v231
    s_add_u32 s51, s49, 0
    s_mul_i32 s51, s51, 112
    s_add_u32 s51, s51, s52
    s_lshl_b32 s51, s51, 10
    buffer_store_dwordx4 v[64:67], v31, s[20:23], s51 offen sc1
    v_max_f32 v240, 0, v240
    v_max_f32 v241, 0, v241
    v_max_f32 v242, 0, v242
    v_max_f32 v243, 0, v243
    v_max_f32 v244, 0, v244
    v_max_f32 v245, 0, v245
    v_max_f32 v246, 0, v246
    v_max_f32 v247, 0, v247
    v_pk_mul_f32 v[240:241], v[240:241], v[248:249]
    v_pk_mul_f32 v[242:243], v[242:243], v[250:251]
    v_pk_mul_f32 v[244:245], v[244:245], v[252:253]
    v_pk_mul_f32 v[246:247], v[246:247], v[254:255]
    v_cvt_pk_bf16_f32 v68, v240, v241
    v_cvt_pk_bf16_f32 v69, v242, v243
    v_cvt_pk_bf16_f32 v70, v244, v245
    v_cvt_pk_bf16_f32 v71, v246, v247
    s_add_u32 s51, s49, 1
    s_mul_i32 s51, s51, 112
    s_add_u32 s51, s51, s52
    s_lshl_b32 s51, s51, 10
    buffer_store_dwordx4 v[68:71], v31, s[20:23], s51 offen sc1
    s_barrier
    s_setprio 0
    s_branch F_bridge
K1_A1_slow:
    s_add_u32 s78, s78, 1
    s_cmp_ge_u32 s78, 40
    s_cbranch_scc1 K1_fb_5
    s_sleep 2
    s_mul_i32 s49, s36, 8960
    s_lshl_b32 s50, s33, 10
    s_add_u32 s49, s49, s50
    s_add_u32 s49, s49, 12713984
    buffer_load_dwordx4 v[96:99], v31, s[20:23], s49 offen sc1
    s_mul_i32 s49, s36, 8960
    s_lshl_b32 s50, s32, 10
    s_add_u32 s49, s49, s50
    s_add_u32 s49, s49, 12718080
    buffer_load_dwordx4 v[100:103], v31, s[20:23], s49 offen sc1
    s_waitcnt vmcnt(0)
    v_xor_b32 v108, v96, v97
    v_xor_b32 v108, s59, v108
    v_xor_b32 v108, v98, v108
    v_subrev_u32 v109, s55, v98
    v_cmp_eq_u32 vcc, v108, v99
    v_cmp_gt_u32_e64 s[68:69], s79, v109
    s_nop 1
    s_and_b64 s[68:69], s[68:69], vcc
    v_xor_b32 v110, v100, v101
    v_xor_b32 v110, s59, v110
    v_xor_b32 v110, v102, v110
    v_subrev_u32 v111, s55, v102
    v_cmp_eq_u32 vcc, v110, v103
    v_cmp_gt_u32_e64 s[84:85], s79, v111
    s_nop 1
    s_and_b64 s[84:85], s[84:85], vcc
    s_orn2_b64 s[84:85], s[84:85], s[70:71]
    s_and_b64 s[68:69], s[68:69], s[84:85]
    s_cmp_eq_u64 s[68:69], -1
    s_cbranch_scc0 K1_A1_slow
    s_branch K1_A1_ok
K1_fb_5:
    s_lshl_b32 s54, s33, 6
    v_add_u32 v108, s54, v0
    v_mul_u32_u24 v109, 205, v108
    v_lshrrev_b32 v109, 14, v109
    v_mul_u32_u24 v110, 80, v109
    v_sub_u32 v110, v108, v110
    v_lshrrev_b32 v111, 4, v110
    v_and_b32 v112, 15, v110
    v_lshlrev_b32 v116, 1, v112
    v_subrev_u32 v117, 4, v116
    v_cmp_gt_u32 vcc, 24, v116
    s_nop 1
    v_cndmask_b32 v116, v117, v116, vcc
    s_mul_i32 s49, s35, 28
    v_add_u32 v116, s49, v116
    v_mul_u32_u24 v117, 448, v111
    v_add_u32 v116, v116, v117
    v_add_u32 v116, 448, v116
    v_lshlrev_b32 v113, 1, v116
    v_mul_u32_u24 v117, 2688, v109
    v_lshlrev_b32 v117, 6, v117
    v_add_u32 v113, v113, v117
    v_mov_b32 v118, 1073741824
    v_cmp_gt_u32 vcc, 2, v111
    s_nop 1
    v_cndmask_b32 v113, v118, v113, vcc
    v_subrev_u32 v116, 2, v111
    v_lshlrev_b32 v116, 4, v116
    v_and_b32 v117, 7, v112
    v_lshl_add_u32 v116, v117, 1, v116
    s_mul_i32 s49, s29, 48
    v_add_u32 v116, s49, v116
    v_lshlrev_b32 v114, 1, v116
    v_mul_u32_u24 v117, 3584, v109
    v_lshlrev_b32 v117, 6, v117
    v_add_u32 v114, v114, v117
    v_cndmask_b32 v114, v114, v118, vcc
    v_cmp_gt_u32 vcc, 8, v112
    s_nop 1
    v_cndmask_b32 v115, v114, v118, vcc
    v_cndmask_b32 v114, v118, v114, vcc
    v_mov_b32 v96, 0
    v_mov_b32 v97, 0
    s_mov_b32 s51, 0
    s_mov_b32 s52, 0
    s_mov_b32 s53, 0
K1_fbc_6:
    buffer_load_dword v117, v113, s[8:11], s51 offen
    buffer_load_dword v118, v114, s[12:15], s52 offen
    buffer_load_dword v119, v115, s[16:19], s52 offen
    s_waitcnt vmcnt(0)
    v_or_b32 v117, v117, v118
    v_or_b32 v117, v117, v119
    v_lshlrev_b32 v118, 16, v117
    v_and_b32 v119, s58, v117
    v_add_f32 v96, v96, v118
    v_add_f32 v97, v97, v119
    s_add_u32 s51, s51, 2688
    s_add_u32 s52, s52, 3584
    s_add_u32 s53, s53, 1
    s_cmp_lt_u32 s53, 64
    s_cbranch_scc1 K1_fbc_6
    s_lshl_b32 s54, s32, 6
    s_add_u32 s54, s54, 256
    v_add_u32 v108, s54, v0
    v_mul_u32_u24 v109, 205, v108
    v_lshrrev_b32 v109, 14, v109
    v_mul_u32_u24 v110, 80, v109
    v_sub_u32 v110, v108, v110
    v_lshrrev_b32 v111, 4, v110
    v_and_b32 v112, 15, v110
    v_lshlrev_b32 v116, 1, v112
    v_subrev_u32 v117, 4, v116
    v_cmp_gt_u32 vcc, 24, v116
    s_nop 1
    v_cndmask_b32 v116, v117, v116, vcc
    s_mul_i32 s49, s35, 28
    v_add_u32 v116, s49, v116
    v_mul_u32_u24 v117, 448, v111
    v_add_u32 v116, v116, v117
    v_add_u32 v116, 448, v116
    v_lshlrev_b32 v113, 1, v116
    v_mul_u32_u24 v117, 2688, v109
    v_lshlrev_b32 v117, 6, v117
    v_add_u32 v113, v113, v117
    v_mov_b32 v118, 1073741824
    v_cmp_gt_u32 vcc, 2, v111
    s_nop 1
    v_cndmask_b32 v113, v118, v113, vcc
    v_subrev_u32 v116, 2, v111
    v_lshlrev_b32 v116, 4, v116
    v_and_b32 v117, 7, v112
    v_lshl_add_u32 v116, v117, 1, v116
    s_mul_i32 s49, s29, 48
    v_add_u32 v116, s49, v116
    v_lshlrev_b32 v114, 1, v116
    v_mul_u32_u24 v117, 3584, v109
    v_lshlrev_b32 v117, 6, v117
    v_add_u32 v114, v114, v117
    v_cndmask_b32 v114, v114, v118, vcc
    v_cmp_gt_u32 vcc, 8, v112
    s_nop 1
    v_cndmask_b32 v115, v114, v118, vcc
    v_cndmask_b32 v114, v118, v114, vcc
    v_mov_b32 v100, 0
    v_mov_b32 v101, 0
    s_mov_b32 s51, 0
    s_mov_b32 s52, 0
    s_mov_b32 s53, 0
K1_fbc_7:
    buffer_load_dword v117, v113, s[8:11], s51 offen
    buffer_load_dword v118, v114, s[12:15], s52 offen
    buffer_load_dword v119, v115, s[16:19], s52 offen
    s_waitcnt vmcnt(0)
    v_or_b32 v117, v117, v118
    v_or_b32 v117, v117, v119
    v_lshlrev_b32 v118, 16, v117
    v_and_b32 v119, s58, v117
    v_add_f32 v100, v100, v118
    v_add_f32 v101, v101, v119
    s_add_u32 s51, s51, 2688
    s_add_u32 s52, s52, 3584
    s_add_u32 s53, s53, 1
    s_cmp_lt_u32 s53, 64
    s_cbranch_scc1 K1_fbc_7
    s_branch K1_A1_ok
K1_B0:
    s_setprio 2
    s_mov_b32 s58, 0xffff0000
    s_mov_b32 s62, -1
    s_mov_b32 s63, 0
    s_mov_b32 s30, 0x01000000
    s_mov_b32 s31, 0x01000000
    s_mov_b32 s79, 16777216
    v_and_b32 v1, 31, v0
    v_lshrrev_b32 v2, 5, v0
    v_lshrrev_b32 v3, 1, v1
    v_and_b32 v3, 7, v3
    s_lshl_b32 s49, s33, 13
    v_lshlrev_b32 v4, 7, v1
    v_add_u32 v4, s49, v4
    s_add_u32 s50, s33, 0
    s_and_b32 s50, s50, 3
    s_lshl_b32 s50, s50, 1
    v_add_u32 v5, s50, v2
    v_xor_b32 v5, v5, v3
    v_lshlrev_b32 v5, 4, v5
    v_add_u32 v16, v4, v5
    v_add_u32 v124, 106752, v16
    s_add_u32 s50, s33, 1
    s_and_b32 s50, s50, 3
    s_lshl_b32 s50, s50, 1
    v_add_u32 v5, s50, v2
    v_xor_b32 v5, v5, v3
    v_lshlrev_b32 v5, 4, v5
    v_add_u32 v17, v4, v5
    v_add_u32 v125, 106752, v17
    s_add_u32 s50, s33, 2
    s_and_b32 s50, s50, 3
    s_lshl_b32 s50, s50, 1
    v_add_u32 v5, s50, v2
    v_xor_b32 v5, v5, v3
    v_lshlrev_b32 v5, 4, v5
    v_add_u32 v18, v4, v5
    v_add_u32 v126, 106752, v18
    s_add_u32 s50, s33, 3
    s_and_b32 s50, s50, 3
    s_lshl_b32 s50, s50, 1
    v_add_u32 v5, s50, v2
    v_xor_b32 v5, v5, v3
    v_lshlrev_b32 v5, 4, v5
    v_add_u32 v19, v4, v5
    v_add_u32 v127, 106752, v19
    v_lshrrev_b32 v1, 2, v0
    v_and_b32 v1, 3, v1
    v_and_b32 v2, 3, v0
    v_lshrrev_b32 v3, 5, v0
    v_lshrrev_b32 v4, 4, v0
    v_and_b32 v4, 1, v4
    v_lshlrev_b32 v5, 3, v3
    v_add_u32 v5, v5, v1
    v_lshrrev_b32 v6, 1, v1
    v_lshlrev_b32 v7, 3, v2
    v_lshl_add_u32 v10, v5, 7, v7
    v_mul_u32_u24 v9, 8256, v4
    v_add_u32 v10, v10, v9
    v_add_u32 v10, 36864, v10
    v_lshlrev_b32 v11, 5, v6
    v_lshl_add_u32 v8, v5, 6, v7
    v_lshl_add_u32 v8, v4, 5, v8
    v_add_u32 v8, 32768, v8
    v_add_u32 v9, v10, v11
    s_add_u32 s50, s33, 0
    s_and_b32 s50, s50, 3
    s_mul_i32 s51, s50, 1024
    v_add_u32 v20, s51, v8
    v_add_u32 v128, 106752, v20
    s_mul_i32 s51, s50, 2048
    v_add_u32 v24, s51, v9
    v_add_u32 v132, 106752, v24
    s_add_u32 s50, s33, 1
    s_and_b32 s50, s50, 3
    s_mul_i32 s51, s50, 1024
    v_add_u32 v21, s51, v8
    v_add_u32 v129, 106752, v21
    s_mul_i32 s51, s50, 2048
    v_add_u32 v25, s51, v9
    v_add_u32 v133, 106752, v25
    s_add_u32 s50, s33, 2
    s_and_b32 s50, s50, 3
    s_mul_i32 s51, s50, 1024
    v_add_u32 v22, s51, v8
    v_add_u32 v130, 106752, v22
    s_mul_i32 s51, s50, 2048
    v_add_u32 v26, s51, v9
    v_add_u32 v134, 106752, v26
    s_add_u32 s50, s33, 3
    s_and_b32 s50, s50, 3
    s_mul_i32 s51, s50, 1024
    v_add_u32 v23, s51, v8
    v_add_u32 v131, 106752, v23
    s_mul_i32 s51, s50, 2048
    v_add_u32 v27, s51, v9
    v_add_u32 v135, 106752, v27
    s_waitcnt lgkmcnt(0)
    s_sub_u32 s55, s60, 800
    s_xor_b32 s59, s61, 0x5bd1e995
    s_waitcnt vmcnt(7)
    v_lshlrev_b32 v92, 16, v88
    v_and_b32 v93, s58, v88
    v_lshlrev_b32 v94, 16, v89
    v_and_b32 v95, s58, v89
    v_lshlrev_b32 v96, 16, v90
    v_and_b32 v97, s58, v90
    v_lshlrev_b32 v98, 16, v91
    v_and_b32 v99, s58, v91
    v_add_f32 v100, v92, v93
    v_mul_f32 v101, v92, v92
    v_fmac_f32 v101, v93, v93
    v_add_f32 v100, v100, v94
    v_fmac_f32 v101, v94, v94
    v_add_f32 v100, v100, v95
    v_fmac_f32 v101, v95, v95
    v_add_f32 v100, v100, v96
    v_fmac_f32 v101, v96, v96
    v_add_f32 v100, v100, v97
    v_fmac_f32 v101, v97, v97
    v_add_f32 v100, v100, v98
    v_fmac_f32 v101, v98, v98
    v_add_f32 v100, v100, v99
    v_fmac_f32 v101, v99, v99
    s_nop 0
    v_add_f32_dpp v100, v100, v100 row_shr:1 row_mask:0xf bank_mask:0xf bound_ctrl:0
    v_add_f32_dpp v101, v101, v101 row_shr:1 row_mask:0xf bank_mask:0xf bound_ctrl:0
    s_nop 0
    v_add_f32_dpp v100, v100, v100 row_shr:2 row_mask:0xf bank_mask:0xf bound_ctrl:0
    v_add_f32_dpp v101, v101, v101 row_shr:2 row_mask:0xf bank_mask:0xf bound_ctrl:0
    s_nop 0
    v_add_f32_dpp v100, v100, v100 row_shr:4 row_mask:0xf bank_mask:0xf bound_ctrl:0
    v_add_f32_dpp v101, v101, v101 row_shr:4 row_mask:0xf bank_mask:0xf bound_ctrl:0
    s_nop 0
    v_add_f32_dpp v100, v100, v100 row_shr:8 row_mask:0xf bank_mask:0xf bound_ctrl:0
    v_add_f32_dpp v101, v101, v101 row_shr:8 row_mask:0xf bank_mask:0xf bound_ctrl:0
    s_nop 0
    v_add_f32_dpp v100, v100, v100 row_bcast:15 row_mask:0xa bank_mask:0xf
    v_add_f32_dpp v101, v101, v101 row_bcast:15 row_mask:0xa bank_mask:0xf
    s_nop 0
    v_add_f32_dpp v100, v100, v100 row_bcast:31 row_mask:0xc bank_mask:0xf
    v_add_f32_dpp v101, v101, v101 row_bcast:31 row_mask:0xc bank_mask:0xf
    v_mul_f32 v104, 0x3b124925, v100
    v_mul_f32 v101, 0x3b124925, v101
    v_fma_f32 v101, -v104, v104, v101
    v_max_f32 v101, 0, v101
    v_add_f32 v101, 0x3727c5ac, v101
    v_rsq_f32 v105, v101
    s_lshl_b32 s49, s73, 4
    s_add_u32 s49, s49, 12648448
    v_mov_b32 v1, 0
    v_mov_b32 v106, s60
    v_xor_b32 v107, v104, v105
    v_xor_b32 v107, s59, v107
    v_xor_b32 v107, s60, v107
    s_mov_b32 s72, s49
    s_lshl_b32 s74, s44, 7
    s_add_u32 s74, s74, s37
    s_add_u32 m0, s40, 53376
    s_mul_i32 s75, s44, 172032
    buffer_load_dwordx4 v28, s[4:7], s74 offen lds
    s_add_u32 m0, m0, 8192
    s_add_u32 s74, s74, 57344
    buffer_load_dwordx4 v28, s[4:7], s74 offen lds
    s_add_u32 m0, m0, 8192
    s_add_u32 s74, s74, 57344
    buffer_load_dwordx4 v28, s[4:7], s74 offen lds
    s_add_u32 m0, m0, 8192
    s_add_u32 s74, s74, 57344
    buffer_load_dwordx4 v28, s[4:7], s74 offen lds
    s_add_u32 m0, s41, 53376
    s_add_u32 s75, s75, s38
    s_mov_b64 exec, s[56:57]
    buffer_load_dwordx4 v29, s[8:11], s75 offen lds
    s_mov_b64 exec, -1
    s_mul_i32 s74, s44, 229376
    s_add_u32 m0, s42, 53376
    s_add_u32 s74, s74, s39
    buffer_load_dwordx4 v30, s[12:15], s74 offen lds
    s_add_u32 m0, s43, 53376
    s_nop 0
    buffer_load_dwordx4 v30, s[16:19], s74 offen lds
    s_add_u32 s44, s44, 1
    s_cmp_eq_u32 s44, 7
    s_cselect_b32 s44, 0, s44
    s_mov_b32 s68, 0
    s_mov_b32 s69, 0x80000000
    v_mov_b32 v1, 0
    s_mov_b64 exec, s[68:69]
    buffer_store_dwordx4 v[104:107], v1, s[20:23], s72 offen sc1
    s_mov_b64 exec, -1
    s_waitcnt vmcnt(8)
    s_barrier
    ds_read_b128 v[48:51], v16 offset:0
    ds_read_b64_tr_b16 v[56:57], v20 offset:0
    ds_read_b64_tr_b16 v[58:59], v20 offset:256
    ds_read_b128 v[52:55], v16 offset:4096
    ds_read_b64_tr_b16 v[60:61], v24 offset:0
    ds_read_b64_tr_b16 v[62:63], v24 offset:512
    s_waitcnt lgkmcnt(0)
    v_mfma_f32_32x32x16_bf16 v[160:175], v[56:59], v[48:51], 0
    ds_read_b128 v[68:71], v17 offset:0
    ds_read_b64_tr_b16 v[76:77], v21 offset:0
    s_lshl_b32 s45, s44, 7
    s_mul_i32 s46, s44, 172032
    s_mul_i32 s47, s44, 229376
    s_add_u32 s45, s45, s37
    s_add_u32 s46, s46, s48
    s_add_u32 s47, s47, s39
    s_add_u32 s44, s44, 1
    s_cmp_eq_u32 s44, 7
    s_cselect_b32 s44, 0, s44
    s_add_u32 m0, s40, 106752
    s_nop 0
    buffer_load_dwordx4 v28, s[4:7], s45 offen lds
    s_add_u32 m0, s40, 110848
    s_add_u32 s74, s45, 28672
    buffer_load_dwordx4 v28, s[4:7], s74 offen lds
    v_lshlrev_b32 v38, 16, v56
    v_and_b32 v39, s58, v56
    v_add_f32 v32, 0, v38
    v_add_f32 v33, 0, v39
    v_mfma_f32_32x32x16_bf16 v[176:191], v[56:59], v[52:55], 0
    ds_read_b64_tr_b16 v[78:79], v21 offset:256
    ds_read_b128 v[72:75], v17 offset:4096
    s_add_u32 m0, s40, 114944
    s_add_u32 s74, s45, 57344
    buffer_load_dwordx4 v28, s[4:7], s74 offen lds
    v_lshlrev_b32 v40, 16, v57
    v_and_b32 v41, s58, v57
    v_add_f32 v32, v32, v40
    v_add_f32 v33, v33, v41
    v_mfma_f32_32x32x16_bf16 v[192:207], v[60:63], v[48:51], 0
    ds_read_b64_tr_b16 v[80:81], v25 offset:0
    ds_read_b64_tr_b16 v[82:83], v25 offset:512
    s_add_u32 m0, s40, 119040
    s_add_u32 s74, s45, 86016
    buffer_load_dwordx4 v28, s[4:7], s74 offen lds
    v_lshlrev_b32 v38, 16, v58
    v_and_b32 v39, s58, v58
    v_add_f32 v32, v32, v38
    v_add_f32 v33, v33, v39
    v_mfma_f32_32x32x16_bf16 v[208:223], v[60:63], v[52:55], 0
    s_add_u32 m0, s40, 123136
    s_add_u32 s74, s45, 114688
    buffer_load_dwordx4 v28, s[4:7], s74 offen lds
    v_lshlrev_b32 v40, 16, v59
    v_and_b32 v41, s58, v59
    v_add_f32 v32, v32, v40
    v_add_f32 v33, v33, v41
    s_waitcnt lgkmcnt(0)
    v_mfma_f32_32x32x16_bf16 v[160:175], v[76:79], v[68:71], v[160:175]
    ds_read_b128 v[48:51], v18 offset:0
    ds_read_b64_tr_b16 v[56:57], v22 offset:0
    s_add_u32 m0, s40, 127232
    s_add_u32 s74, s45, 143360
    buffer_load_dwordx4 v28, s[4:7], s74 offen lds
    v_lshlrev_b32 v38, 16, v80
    v_and_b32 v39, s58, v80
    v_add_f32 v34, 0, v38
    v_add_f32 v35, 0, v39
    v_mfma_f32_32x32x16_bf16 v[176:191], v[76:79], v[72:75], v[176:191]
    ds_read_b64_tr_b16 v[58:59], v22 offset:256
    ds_read_b128 v[52:55], v18 offset:4096
    s_add_u32 m0, s40, 131328
    s_add_u32 s74, s45, 172032
    buffer_load_dwordx4 v28, s[4:7], s74 offen lds
    v_lshlrev_b32 v40, 16, v81
    v_and_b32 v41, s58, v81
    v_add_f32 v34, v34, v40
    v_add_f32 v35, v35, v41
    v_mfma_f32_32x32x16_bf16 v[192:207], v[80:83], v[68:71], v[192:207]
    ds_read_b64_tr_b16 v[60:61], v26 offset:0
    ds_read_b64_tr_b16 v[62:63], v26 offset:512
    s_add_u32 m0, s40, 135424
    s_add_u32 s74, s45, 200704
    buffer_load_dwordx4 v28, s[4:7], s74 offen lds
    v_lshlrev_b32 v38, 16, v82
    v_and_b32 v39, s58, v82
    v_add_f32 v34, v34, v38
    v_add_f32 v35, v35, v39
    v_mfma_f32_32x32x16_bf16 v[208:223], v[80:83], v[72:75], v[208:223]
    s_add_u32 m0, s28, 106752
    s_nop 0
    buffer_load_dwordx4 v29, s[8:11], s46 offen lds
    v_lshlrev_b32 v40, 16, v83
    v_and_b32 v41, s58, v83
    v_add_f32 v34, v34, v40
    v_add_f32 v35, v35, v41
    s_waitcnt lgkmcnt(0)
    v_mfma_f32_32x32x16_bf16 v[160:175], v[56:59], v[48:51], v[160:175]
    ds_read_b128 v[68:71], v19 offset:0
    ds_read_b64_tr_b16 v[76:77], v23 offset:0
    s_add_u32 m0, s42, 106752
    s_nop 0
    buffer_load_dwordx4 v30, s[12:15], s47 offen lds
    v_mfma_f32_32x32x16_bf16 v[176:191], v[56:59], v[52:55], v[176:191]
    ds_read_b64_tr_b16 v[78:79], v23 offset:256
    ds_read_b128 v[72:75], v19 offset:4096
    s_add_u32 m0, s43, 106752
    s_nop 0
    buffer_load_dwordx4 v30, s[16:19], s47 offen lds
    v_add_f32 v32, v32, v33
    v_add_f32 v34, v34, v35
    v_mov_b32 v33, v32
    v_mov_b32 v35, v34
    s_nop 1
    v_permlane32_swap_b32 v32, v33
    v_permlane32_swap_b32 v34, v35
    v_mfma_f32_32x32x16_bf16 v[192:207], v[60:63], v[48:51], v[192:207]
    ds_read_b64_tr_b16 v[80:81], v27 offset:0
    ds_read_b64_tr_b16 v[82:83], v27 offset:512
    s_add_u32 m0, s42, 110848
    s_add_u32 s74, s47, 114688
    buffer_load_dwordx4 v30, s[12:15], s74 offen lds
    v_and_b32 v1, 31, v0
    v_lshlrev_b32 v1, 2, v1
    s_mul_i32 s49, s33, 640
    s_add_u32 s49, s49, 160128
    v_add_u32 v1, s49, v1
    v_add_f32 v32, v32, v33
    v_add_f32 v34, v34, v35
    ds_write_b32 v1, v32 offset:0
    ds_write_b32 v1, v34 offset:128
    v_mfma_f32_32x32x16_bf16 v[208:223], v[60:63], v[52:55], v[208:223]
    s_add_u32 m0, s43, 110848
    s_add_u32 s74, s47, 114688
    buffer_load_dwordx4 v30, s[16:19], s74 offen lds
    s_waitcnt lgkmcnt(0)
    s_waitcnt vmcnt(14)
    s_barrier
    v_mfma_f32_32x32x16_bf16 v[160:175], v[76:79], v[68:71], v[160:175]
    ds_read_b128 v[48:51], v16 offset:53376
    ds_read_b64_tr_b16 v[56:57], v20 offset:53376
    s_lshl_b32 s45, s44, 7
    s_mul_i32 s46, s44, 172032
    s_mul_i32 s47, s44, 229376
    s_add_u32 s45, s45, s37
    s_add_u32 s46, s46, s48
    s_add_u32 s47, s47, s39
    s_add_u32 s44, s44, 1
    s_cmp_eq_u32 s44, 7
    s_cselect_b32 s44, 0, s44
    s_add_u32 m0, s40, 0
    s_nop 0
    buffer_load_dwordx4 v28, s[4:7], s45 offen lds
    v_mfma_f32_32x32x16_bf16 v[176:191], v[76:79], v[72:75], v[176:191]
    ds_read_b64_tr_b16 v[58:59], v20 offset:53632
    ds_read_b128 v[52:55], v16 offset:57472
    s_add_u32 m0, s40, 4096
    s_add_u32 s74, s45, 28672
    buffer_load_dwordx4 v28, s[4:7], s74 offen lds
    v_mfma_f32_32x32x16_bf16 v[192:207], v[80:83], v[68:71], v[192:207]
    ds_read_b64_tr_b16 v[60:61], v24 offset:53376
    ds_read_b64_tr_b16 v[62:63], v24 offset:53888
    s_add_u32 m0, s40, 8192
    s_add_u32 s74, s45, 57344
    buffer_load_dwordx4 v28, s[4:7], s74 offen lds
    v_mfma_f32_32x32x16_bf16 v[208:223], v[80:83], v[72:75], v[208:223]
    s_add_u32 m0, s40, 12288
    s_add_u32 s74, s45, 86016
    buffer_load_dwordx4 v28, s[4:7], s74 offen lds
    s_waitcnt lgkmcnt(0)
    v_mfma_f32_32x32x16_bf16 v[160:175], v[56:59], v[48:51], v[160:175]
    ds_read_b128 v[68:71], v17 offset:53376
    ds_read_b64_tr_b16 v[76:77], v21 offset:53376
    s_add_u32 m0, s40, 16384
    s_add_u32 s74, s45, 114688
    buffer_load_dwordx4 v28, s[4:7], s74 offen lds
    v_mfma_f32_32x32x16_bf16 v[176:191], v[56:59], v[52:55], v[176:191]
    ds_read_b64_tr_b16 v[78:79], v21 offset:53632
    ds_read_b128 v[72:75], v17 offset:57472
    s_add_u32 m0, s40, 20480
    s_add_u32 s74, s45, 143360
    buffer_load_dwordx4 v28, s[4:7], s74 offen lds
    v_mfma_f32_32x32x16_bf16 v[192:207], v[60:63], v[48:51], v[192:207]
    ds_read_b64_tr_b16 v[80:81], v25 offset:53376
    ds_read_b64_tr_b16 v[82:83], v25 offset:53888
    s_add_u32 m0, s40, 24576
    s_add_u32 s74, s45, 172032
    buffer_load_dwordx4 v28, s[4:7], s74 offen lds
    v_mfma_f32_32x32x16_bf16 v[208:223], v[60:63], v[52:55], v[208:223]
    s_add_u32 m0, s40, 28672
    s_add_u32 s74, s45, 200704
    buffer_load_dwordx4 v28, s[4:7], s74 offen lds
    s_waitcnt lgkmcnt(0)
    v_mfma_f32_32x32x16_bf16 v[160:175], v[76:79], v[68:71], v[160:175]
    ds_read_b128 v[48:51], v18 offset:53376
    ds_read_b64_tr_b16 v[56:57], v22 offset:53376
    s_add_u32 m0, s28, 0
    s_nop 0
    buffer_load_dwordx4 v29, s[8:11], s46 offen lds
    v_mfma_f32_32x32x16_bf16 v[176:191], v[76:79], v[72:75], v[176:191]
    ds_read_b64_tr_b16 v[58:59], v22 offset:53632
    ds_read_b128 v[52:55], v18 offset:57472
    s_add_u32 m0, s42, 0
    s_nop 0
    buffer_load_dwordx4 v30, s[12:15], s47 offen lds
    v_mfma_f32_32x32x16_bf16 v[192:207], v[80:83], v[68:71], v[192:207]
    ds_read_b64_tr_b16 v[60:61], v26 offset:53376
    ds_read_b64_tr_b16 v[62:63], v26 offset:53888
    s_add_u32 m0, s43, 0
    s_nop 0
    buffer_load_dwordx4 v30, s[16:19], s47 offen lds
    v_mfma_f32_32x32x16_bf16 v[208:223], v[80:83], v[72:75], v[208:223]
    s_add_u32 m0, s42, 4096
    s_add_u32 s74, s47, 114688
    buffer_load_dwordx4 v30, s[12:15], s74 offen lds
    s_waitcnt lgkmcnt(0)
    v_mfma_f32_32x32x16_bf16 v[160:175], v[56:59], v[48:51], v[160:175]
    ds_read_b128 v[68:71], v19 offset:53376
    ds_read_b64_tr_b16 v[76:77], v23 offset:53376
    s_add_u32 m0, s43, 4096
    s_add_u32 s74, s47, 114688
    buffer_load_dwordx4 v30, s[16:19], s74 offen lds
    v_mfma_f32_32x32x16_bf16 v[176:191], v[56:59], v[52:55], v[176:191]
    ds_read_b64_tr_b16 v[78:79], v23 offset:53632
    ds_read_b128 v[72:75], v19 offset:57472
    v_mfma_f32_32x32x16_bf16 v[192:207], v[60:63], v[48:51], v[192:207]
    ds_read_b64_tr_b16 v[80:81], v27 offset:53376
    ds_read_b64_tr_b16 v[82:83], v27 offset:53888
    v_mfma_f32_32x32x16_bf16 v[208:223], v[60:63], v[52:55], v[208:223]
    s_waitcnt lgkmcnt(0)
    s_waitcnt vmcnt(13)
    s_barrier
    v_mfma_f32_32x32x16_bf16 v[160:175], v[76:79], v[68:71], v[160:175]
    ds_read_b128 v[48:51], v124 offset:0
    ds_read_b64_tr_b16 v[56:57], v128 offset:0
    s_lshl_b32 s45, s44, 7
    s_mul_i32 s46, s44, 172032
    s_mul_i32 s47, s44, 229376
    s_add_u32 s45, s45, s37
    s_add_u32 s46, s46, s48
    s_add_u32 s47, s47, s39
    s_add_u32 s44, s44, 1
    s_cmp_eq_u32 s44, 7
    s_cselect_b32 s44, 0, s44
    s_add_u32 m0, s40, 53376
    s_nop 0
    buffer_load_dwordx4 v28, s[4:7], s45 offen lds
    v_mfma_f32_32x32x16_bf16 v[176:191], v[76:79], v[72:75], v[176:191]
    ds_read_b64_tr_b16 v[58:59], v128 offset:256
    ds_read_b128 v[52:55], v124 offset:4096
    s_add_u32 m0, s40, 57472
    s_add_u32 s74, s45, 28672
    buffer_load_dwordx4 v28, s[4:7], s74 offen lds
    v_mfma_f32_32x32x16_bf16 v[192:207], v[80:83], v[68:71], v[192:207]
    ds_read_b64_tr_b16 v[60:61], v132 offset:0
    ds_read_b64_tr_b16 v[62:63], v132 offset:512
    s_add_u32 m0, s40, 61568
    s_add_u32 s74, s45, 57344
    buffer_load_dwordx4 v28, s[4:7], s74 offen lds
    v_mfma_f32_32x32x16_bf16 v[208:223], v[80:83], v[72:75], v[208:223]
    s_add_u32 m0, s40, 65664
    s_add_u32 s74, s45, 86016
    buffer_load_dwordx4 v28, s[4:7], s74 offen lds
    s_waitcnt lgkmcnt(0)
    v_mfma_f32_32x32x16_bf16 v[160:175], v[56:59], v[48:51], v[160:175]
    ds_read_b128 v[68:71], v125 offset:0
    ds_read_b64_tr_b16 v[76:77], v129 offset:0
    s_add_u32 m0, s40, 69760
    s_add_u32 s74, s45, 114688
    buffer_load_dwordx4 v28, s[4:7], s74 offen lds
    v_mfma_f32_32x32x16_bf16 v[176:191], v[56:59], v[52:55], v[176:191]
    ds_read_b64_tr_b16 v[78:79], v129 offset:256
    ds_read_b128 v[72:75], v125 offset:4096
    s_add_u32 m0, s40, 73856
    s_add_u32 s74, s45, 143360
    buffer_load_dwordx4 v28, s[4:7], s74 offen lds
    v_mfma_f32_32x32x16_bf16 v[192:207], v[60:63], v[48:51], v[192:207]
    ds_read_b64_tr_b16 v[80:81], v133 offset:0
    ds_read_b64_tr_b16 v[82:83], v133 offset:512
    s_add_u32 m0, s40, 77952
    s_add_u32 s74, s45, 172032
    buffer_load_dwordx4 v28, s[4:7], s74 offen lds
    v_mfma_f32_32x32x16_bf16 v[208:223], v[60:63], v[52:55], v[208:223]
    s_add_u32 m0, s40, 82048
    s_add_u32 s74, s45, 200704
    buffer_load_dwordx4 v28, s[4:7], s74 offen lds
    s_waitcnt lgkmcnt(0)
    v_mfma_f32_32x32x16_bf16 v[160:175], v[76:79], v[68:71], v[160:175]
    ds_read_b128 v[48:51], v126 offset:0
    ds_read_b64_tr_b16 v[56:57], v130 offset:0
    s_add_u32 m0, s28, 53376
    s_nop 0
    buffer_load_dwordx4 v29, s[8:11], s46 offen lds
    v_mfma_f32_32x32x16_bf16 v[176:191], v[76:79], v[72:75], v[176:191]
    ds_read_b64_tr_b16 v[58:59], v130 offset:256
    ds_read_b128 v[52:55], v126 offset:4096
    s_add_u32 m0, s42, 53376
    s_nop 0
    buffer_load_dwordx4 v30, s[12:15], s47 offen lds
    v_mfma_f32_32x32x16_bf16 v[192:207], v[80:83], v[68:71], v[192:207]
    ds_read_b64_tr_b16 v[60:61], v134 offset:0
    ds_read_b64_tr_b16 v[62:63], v134 offset:512
    s_add_u32 m0, s43, 53376
    s_nop 0
    buffer_load_dwordx4 v30, s[16:19], s47 offen lds
    v_mfma_f32_32x32x16_bf16 v[208:223], v[80:83], v[72:75], v[208:223]
    s_add_u32 m0, s42, 57472
    s_add_u32 s74, s47, 114688
    buffer_load_dwordx4 v30, s[12:15], s74 offen lds
    s_waitcnt lgkmcnt(0)
    v_mfma_f32_32x32x16_bf16 v[160:175], v[56:59], v[48:51], v[160:175]
    ds_read_b128 v[68:71], v127 offset:0
    ds_read_b64_tr_b16 v[76:77], v131 offset:0
    s_add_u32 m0, s43, 57472
    s_add_u32 s74, s47, 114688
    buffer_load_dwordx4 v30, s[16:19], s74 offen lds
    v_mfma_f32_32x32x16_bf16 v[176:191], v[56:59], v[52:55], v[176:191]
    ds_read_b64_tr_b16 v[78:79], v131 offset:256
    ds_read_b128 v[72:75], v127 offset:4096
    v_mfma_f32_32x32x16_bf16 v[192:207], v[60:63], v[48:51], v[192:207]
    ds_read_b64_tr_b16 v[80:81], v135 offset:0
    ds_read_b64_tr_b16 v[82:83], v135 offset:512
    v_mfma_f32_32x32x16_bf16 v[208:223], v[60:63], v[52:55], v[208:223]
    s_waitcnt lgkmcnt(0)
    s_waitcnt vmcnt(13)
    s_barrier
    v_mfma_f32_32x32x16_bf16 v[160:175], v[76:79], v[68:71], v[160:175]
    ds_read_b128 v[48:51], v16 offset:0
    ds_read_b64_tr_b16 v[56:57], v20 offset:0
    s_lshl_b32 s45, s44, 7
    s_mul_i32 s46, s44, 172032
    s_mul_i32 s47, s44, 229376
    s_add_u32 s45, s45, s37
    s_add_u32 s46, s46, s48
    s_add_u32 s47, s47, s39
    s_add_u32 s44, s44, 1
    s_cmp_eq_u32 s44, 7
    s_cselect_b32 s44, 0, s44
    s_add_u32 m0, s40, 106752
    s_nop 0
    buffer_load_dwordx4 v28, s[4:7], s45 offen lds
    v_mfma_f32_32x32x16_bf16 v[176:191], v[76:79], v[72:75], v[176:191]
    ds_read_b64_tr_b16 v[58:59], v20 offset:256
    ds_read_b128 v[52:55], v16 offset:4096
    s_add_u32 m0, s40, 110848
    s_add_u32 s74, s45, 28672
    buffer_load_dwordx4 v28, s[4:7], s74 offen lds
    v_mfma_f32_32x32x16_bf16 v[192:207], v[80:83], v[68:71], v[192:207]
    ds_read_b64_tr_b16 v[60:61], v24 offset:0
    ds_read_b64_tr_b16 v[62:63], v24 offset:512
    s_add_u32 m0, s40, 114944
    s_add_u32 s74, s45, 57344
    buffer_load_dwordx4 v28, s[4:7], s74 offen lds
    v_mfma_f32_32x32x16_bf16 v[208:223], v[80:83], v[72:75], v[208:223]
    s_add_u32 m0, s40, 119040
    s_add_u32 s74, s45, 86016
    buffer_load_dwordx4 v28, s[4:7], s74 offen lds
    s_waitcnt lgkmcnt(0)
    v_mfma_f32_32x32x16_bf16 v[160:175], v[56:59], v[48:51], v[160:175]
    ds_read_b128 v[68:71], v17 offset:0
    ds_read_b64_tr_b16 v[76:77], v21 offset:0
    s_add_u32 m0, s40, 123136
    s_add_u32 s74, s45, 114688
    buffer_load_dwordx4 v28, s[4:7], s74 offen lds
    v_mfma_f32_32x32x16_bf16 v[176:191], v[56:59], v[52:55], v[176:191]
    ds_read_b64_tr_b16 v[78:79], v21 offset:256
    ds_read_b128 v[72:75], v17 offset:4096
    s_add_u32 m0, s40, 127232
    s_add_u32 s74, s45, 143360
    buffer_load_dwordx4 v28, s[4:7], s74 offen lds
    v_mfma_f32_32x32x16_bf16 v[192:207], v[60:63], v[48:51], v[192:207]
    ds_read_b64_tr_b16 v[80:81], v25 offset:0
    ds_read_b64_tr_b16 v[82:83], v25 offset:512
    s_add_u32 m0, s40, 131328
    s_add_u32 s74, s45, 172032
    buffer_load_dwordx4 v28, s[4:7], s74 offen lds
    v_mfma_f32_32x32x16_bf16 v[208:223], v[60:63], v[52:55], v[208:223]
    s_add_u32 m0, s40, 135424
    s_add_u32 s74, s45, 200704
    buffer_load_dwordx4 v28, s[4:7], s74 offen lds
    s_waitcnt lgkmcnt(0)
    v_mfma_f32_32x32x16_bf16 v[160:175], v[76:79], v[68:71], v[160:175]
    ds_read_b128 v[48:51], v18 offset:0
    ds_read_b64_tr_b16 v[56:57], v22 offset:0
    s_add_u32 m0, s28, 106752
    s_nop 0
    buffer_load_dwordx4 v29, s[8:11], s46 offen lds
    v_mfma_f32_32x32x16_bf16 v[176:191], v[76:79], v[72:75], v[176:191]
    ds_read_b64_tr_b16 v[58:59], v22 offset:256
    ds_read_b128 v[52:55], v18 offset:4096
    s_add_u32 m0, s42, 106752
    s_nop 0
    buffer_load_dwordx4 v30, s[12:15], s47 offen lds
    v_mfma_f32_32x32x16_bf16 v[192:207], v[80:83], v[68:71], v[192:207]
    ds_read_b64_tr_b16 v[60:61], v26 offset:0
    ds_read_b64_tr_b16 v[62:63], v26 offset:512
    s_add_u32 m0, s43, 106752
    s_nop 0
    buffer_load_dwordx4 v30, s[16:19], s47 offen lds
    v_mfma_f32_32x32x16_bf16 v[208:223], v[80:83], v[72:75], v[208:223]
    s_add_u32 m0, s42, 110848
    s_add_u32 s74, s47, 114688
    buffer_load_dwordx4 v30, s[12:15], s74 offen lds
    s_waitcnt lgkmcnt(0)
    v_mfma_f32_32x32x16_bf16 v[160:175], v[56:59], v[48:51], v[160:175]
    ds_read_b128 v[68:71], v19 offset:0
    ds_read_b64_tr_b16 v[76:77], v23 offset:0
    s_add_u32 m0, s43, 110848
    s_add_u32 s74, s47, 114688
    buffer_load_dwordx4 v30, s[16:19], s74 offen lds
    v_mfma_f32_32x32x16_bf16 v[176:191], v[56:59], v[52:55], v[176:191]
    ds_read_b64_tr_b16 v[78:79], v23 offset:256
    ds_read_b128 v[72:75], v19 offset:4096
    v_mfma_f32_32x32x16_bf16 v[192:207], v[60:63], v[48:51], v[192:207]
    ds_read_b64_tr_b16 v[80:81], v27 offset:0
    ds_read_b64_tr_b16 v[82:83], v27 offset:512
    v_mfma_f32_32x32x16_bf16 v[208:223], v[60:63], v[52:55], v[208:223]
    s_waitcnt lgkmcnt(0)
    s_waitcnt vmcnt(13)
    s_barrier
    v_mfma_f32_32x32x16_bf16 v[160:175], v[76:79], v[68:71], v[160:175]
    ds_read_b128 v[48:51], v16 offset:53376
    ds_read_b64_tr_b16 v[56:57], v20 offset:53376
    s_lshl_b32 s45, s44, 7
    s_mul_i32 s46, s44, 172032
    s_mul_i32 s47, s44, 229376
    s_add_u32 s45, s45, s37
    s_add_u32 s46, s46, s48
    s_add_u32 s47, s47, s39
    s_add_u32 s44, s44, 1
    s_cmp_eq_u32 s44, 7
    s_cselect_b32 s44, 0, s44
    s_add_u32 m0, s40, 0
    s_nop 0
    buffer_load_dwordx4 v28, s[4:7], s45 offen lds
    s_lshl_b32 s49, s34, 12
    s_lshl_b32 s50, s32, 10
    s_add_u32 s49, s49, s50
    s_add_u32 s49, s49, 12648448
    buffer_load_dwordx4 v[96:99], v31, s[20:23], s49 offen sc1
    v_mfma_f32_32x32x16_bf16 v[176:191], v[76:79], v[72:75], v[176:191]
    ds_read_b64_tr_b16 v[58:59], v20 offset:53632
    ds_read_b128 v[52:55], v16 offset:57472
    s_add_u32 m0, s40, 4096
    s_add_u32 s74, s45, 28672
    buffer_load_dwordx4 v28, s[4:7], s74 offen lds
    s_mul_i32 s49, s36, 8960
    s_lshl_b32 s50, s32, 10
    s_add_u32 s49, s49, s50
    s_add_u32 s49, s49, 12718080
    buffer_load_dwordx4 v[100:103], v31, s[20:23], s49 offen sc1
    v_mfma_f32_32x32x16_bf16 v[192:207], v[80:83], v[68:71], v[192:207]
    ds_read_b64_tr_b16 v[60:61], v24 offset:53376
    ds_read_b64_tr_b16 v[62:63], v24 offset:53888
    s_add_u32 m0, s40, 8192
    s_add_u32 s74, s45, 57344
    buffer_load_dwordx4 v28, s[4:7], s74 offen lds
    v_mfma_f32_32x32x16_bf16 v[208:223], v[80:83], v[72:75], v[208:223]
    s_add_u32 m0, s40, 12288
    s_add_u32 s74, s45, 86016
    buffer_load_dwordx4 v28, s[4:7], s74 offen lds
    s_waitcnt lgkmcnt(0)
    v_mfma_f32_32x32x16_bf16 v[160:175], v[56:59], v[48:51], v[160:175]
    ds_read_b128 v[68:71], v17 offset:53376
    ds_read_b64_tr_b16 v[76:77], v21 offset:53376
    s_add_u32 m0, s40, 16384
    s_add_u32 s74, s45, 114688
    buffer_load_dwordx4 v28, s[4:7], s74 offen lds
    v_mfma_f32_32x32x16_bf16 v[176:191], v[56:59], v[52:55], v[176:191]
    ds_read_b64_tr_b16 v[78:79], v21 offset:53632
    ds_read_b128 v[72:75], v17 offset:57472
    s_add_u32 m0, s40, 20480
    s_add_u32 s74, s45, 143360
    buffer_load_dwordx4 v28, s[4:7], s74 offen lds
    v_mfma_f32_32x32x16_bf16 v[192:207], v[60:63], v[48:51], v[192:207]
    ds_read_b64_tr_b16 v[80:81], v25 offset:53376
    ds_read_b64_tr_b16 v[82:83], v25 offset:53888
    s_add_u32 m0, s40, 24576
    s_add_u32 s74, s45, 172032
    buffer_load_dwordx4 v28, s[4:7], s74 offen lds
    v_mfma_f32_32x32x16_bf16 v[208:223], v[60:63], v[52:55], v[208:223]
    s_add_u32 m0, s40, 28672
    s_add_u32 s74, s45, 200704
    buffer_load_dwordx4 v28, s[4:7], s74 offen lds
    s_waitcnt lgkmcnt(0)
    v_mfma_f32_32x32x16_bf16 v[160:175], v[76:79], v[68:71], v[160:175]
    ds_read_b128 v[48:51], v18 offset:53376
    ds_read_b64_tr_b16 v[56:57], v22 offset:53376
    s_add_u32 m0, s28, 0
    s_nop 0
    buffer_load_dwordx4 v29, s[8:11], s46 offen lds
    v_mfma_f32_32x32x16_bf16 v[176:191], v[76:79], v[72:75], v[176:191]
    ds_read_b64_tr_b16 v[58:59], v22 offset:53632
    ds_read_b128 v[52:55], v18 offset:57472
    s_add_u32 m0, s42, 0
    s_nop 0
    buffer_load_dwordx4 v30, s[12:15], s47 offen lds
    v_mfma_f32_32x32x16_bf16 v[192:207], v[80:83], v[68:71], v[192:207]
    ds_read_b64_tr_b16 v[60:61], v26 offset:53376
    ds_read_b64_tr_b16 v[62:63], v26 offset:53888
    s_add_u32 m0, s43, 0
    s_nop 0
    buffer_load_dwordx4 v30, s[16:19], s47 offen lds
    v_mfma_f32_32x32x16_bf16 v[208:223], v[80:83], v[72:75], v[208:223]
    s_add_u32 m0, s42, 4096
    s_add_u32 s74, s47, 114688
    buffer_load_dwordx4 v30, s[12:15], s74 offen lds
    s_waitcnt lgkmcnt(0)
    v_mfma_f32_32x32x16_bf16 v[160:175], v[56:59], v[48:51], v[160:175]
    ds_read_b128 v[68:71], v19 offset:53376
    ds_read_b64_tr_b16 v[76:77], v23 offset:53376
    s_add_u32 m0, s43, 4096
    s_add_u32 s74, s47, 114688
    buffer_load_dwordx4 v30, s[16:19], s74 offen lds
    v_mfma_f32_32x32x16_bf16 v[176:191], v[56:59], v[52:55], v[176:191]
    ds_read_b64_tr_b16 v[78:79], v23 offset:53632
    ds_read_b128 v[72:75], v19 offset:57472
    v_mfma_f32_32x32x16_bf16 v[192:207], v[60:63], v[48:51], v[192:207]
    ds_read_b64_tr_b16 v[80:81], v27 offset:53376
    ds_read_b64_tr_b16 v[82:83], v27 offset:53888
    v_mfma_f32_32x32x16_bf16 v[208:223], v[60:63], v[52:55], v[208:223]
    s_waitcnt lgkmcnt(0)
    s_waitcnt vmcnt(15)
    s_barrier
    v_mfma_f32_32x32x16_bf16 v[160:175], v[76:79], v[68:71], v[160:175]
    ds_read_b128 v[48:51], v124 offset:0
    ds_read_b64_tr_b16 v[56:57], v128 offset:0
    s_lshr_b32 s53, s2, 3
    s_lshl_b32 s53, s53, 3
    s_add_u32 s53, s53, s32
    v_lshlrev_b32 v32, 7, v0
    s_cmp_lt_u32 s53, 196
    s_cselect_b32 s64, s24, s80
    s_cselect_b32 s65, s25, s81
    s_mov_b32 s66, 401408
    s_cselect_b32 s66, 1605632, s66
    s_mov_b32 s67, 0x20000
    s_cselect_b32 s54, 0, 196
    s_sub_u32 s53, s53, s54
    s_lshl_b32 s53, s53, 13
    v_add_u32 v32, s53, v32
    v_mfma_f32_32x32x16_bf16 v[176:191], v[76:79], v[72:75], v[176:191]
    ds_read_b64_tr_b16 v[58:59], v128 offset:256
    ds_read_b128 v[52:55], v124 offset:4096
    s_mov_b32 exec_lo, 0xffffffff
    s_mov_b32 exec_hi, 0xffffffff
    buffer_load_dword v33, v32, s[64:67], 0 offen
    s_mov_b64 exec, -1
    v_mfma_f32_32x32x16_bf16 v[192:207], v[80:83], v[68:71], v[192:207]
    ds_read_b64_tr_b16 v[60:61], v132 offset:0
    ds_read_b64_tr_b16 v[62:63], v132 offset:512
    v_mfma_f32_32x32x16_bf16 v[208:223], v[80:83], v[72:75], v[208:223]
    s_waitcnt lgkmcnt(0)
    v_mfma_f32_32x32x16_bf16 v[160:175], v[56:59], v[48:51], v[160:175]
    ds_read_b128 v[68:71], v125 offset:0
    ds_read_b64_tr_b16 v[76:77], v129 offset:0
    s_mov_b64 s[70:71], -1
    s_mov_b32 s78, 0
    s_waitcnt vmcnt(12)
    v_mfma_f32_32x32x16_bf16 v[176:191], v[56:59], v[52:55], v[176:191]
    ds_read_b64_tr_b16 v[78:79], v129 offset:256
    ds_read_b128 v[72:75], v125 offset:4096
    v_xor_b32 v108, v96, v97
    v_xor_b32 v108, s59, v108
    v_mfma_f32_32x32x16_bf16 v[192:207], v[60:63], v[48:51], v[192:207]
    ds_read_b64_tr_b16 v[80:81], v133 offset:0
    ds_read_b64_tr_b16 v[82:83], v133 offset:512
    v_xor_b32 v108, v98, v108
    v_subrev_u32 v109, s55, v98
    v_mfma_f32_32x32x16_bf16 v[208:223], v[60:63], v[52:55], v[208:223]
    v_cmp_eq_u32 vcc, v108, v99
    v_cmp_gt_u32_e64 s[68:69], s79, v109
    s_waitcnt lgkmcnt(0)
    v_mfma_f32_32x32x16_bf16 v[160:175], v[76:79], v[68:71], v[160:175]
    ds_read_b128 v[48:51], v126 offset:0
    ds_read_b64_tr_b16 v[56:57], v130 offset:0
    s_nop 1
    s_and_b64 s[68:69], s[68:69], vcc
    v_mfma_f32_32x32x16_bf16 v[176:191], v[76:79], v[72:75], v[176:191]
    ds_read_b64_tr_b16 v[58:59], v130 offset:256
    ds_read_b128 v[52:55], v126 offset:4096
    v_xor_b32 v110, v100, v101
    v_xor_b32 v110, s59, v110
    v_mfma_f32_32x32x16_bf16 v[192:207], v[80:83], v[68:71], v[192:207]
    ds_read_b64_tr_b16 v[60:61], v134 offset:0
    ds_read_b64_tr_b16 v[62:63], v134 offset:512
    v_xor_b32 v110, v102, v110
    v_subrev_u32 v111, s55, v102
    v_mfma_f32_32x32x16_bf16 v[208:223], v[80:83], v[72:75], v[208:223]
    v_cmp_eq_u32 vcc, v110, v103
    v_cmp_gt_u32_e64 s[84:85], s79, v111
    s_waitcnt lgkmcnt(0)
    v_mfma_f32_32x32x16_bf16 v[160:175], v[56:59], v[48:51], v[160:175]
    ds_read_b128 v[68:71], v127 offset:0
    ds_read_b64_tr_b16 v[76:77], v131 offset:0
    s_nop 1
    s_and_b64 s[84:85], s[84:85], vcc
    v_mfma_f32_32x32x16_bf16 v[176:191], v[56:59], v[52:55], v[176:191]
    ds_read_b64_tr_b16 v[78:79], v131 offset:256
    ds_read_b128 v[72:75], v127 offset:4096
    s_orn2_b64 s[84:85], s[84:85], s[70:71]
    s_and_b64 s[68:69], s[68:69], s[84:85]
    s_cmp_eq_u64 s[68:69], -1
    s_cbranch_scc0 K1_B0_slow
K1_B0_ok:
    s_lshl_b32 s49, s32, 8
    s_add_u32 s49, s49, 53376
    v_lshlrev_b32 v1, 2, v0
    v_add_u32 v1, s49, v1
    ds_write_b32 v1, v96
    ds_write_b32 v1, v97 offset:1024
    v_mfma_f32_32x32x16_bf16 v[192:207], v[60:63], v[48:51], v[192:207]
    ds_read_b64_tr_b16 v[80:81], v135 offset:0
    ds_read_b64_tr_b16 v[82:83], v135 offset:512
    s_lshl_b32 s49, s32, 9
    s_add_u32 s49, s49, 57472
    v_lshlrev_b32 v1, 3, v0
    v_add_u32 v2, s49, v1
    v_add_u32 v1, 160128, v1
    v_cndmask_b32_e64 v1, v1, v2, s[70:71]
    ds_write_b64 v1, v[100:101]
    v_mfma_f32_32x32x16_bf16 v[208:223], v[60:63], v[52:55], v[208:223]
    s_waitcnt lgkmcnt(0)
    s_waitcnt vmcnt(1)
    s_setprio 0
    s_barrier
    v_mfma_f32_32x32x16_bf16 v[160:175], v[76:79], v[68:71], v[160:175]
    ds_read_b128 v[48:51], v16 offset:0
    ds_read_b64_tr_b16 v[56:57], v20 offset:0
    v_and_b32 v1, 31, v0
    v_lshlrev_b32 v1, 2, v1
    s_lshl_b32 s49, s33, 8
    s_add_u32 s49, s49, 53376
    v_add_u32 v2, s49, v1
    ds_read_b32 v157, v2
    ds_read_b32 v158, v2 offset:128
    v_add_u32 v3, 55424, v1
    ds_read_b32 v136, v3 offset:0
    v_mfma_f32_32x32x16_bf16 v[176:191], v[76:79], v[72:75], v[176:191]
    ds_read_b64_tr_b16 v[58:59], v20 offset:256
    ds_read_b128 v[52:55], v16 offset:4096
    ds_read_b32 v137, v3 offset:640
    ds_read_b32 v138, v3 offset:1280
    v_mfma_f32_32x32x16_bf16 v[192:207], v[80:83], v[68:71], v[192:207]
    ds_read_b64_tr_b16 v[60:61], v24 offset:0
    ds_read_b64_tr_b16 v[62:63], v24 offset:512
    ds_read_b32 v139, v3 offset:1920
    ds_read_b32 v140, v3 offset:2560
    v_mfma_f32_32x32x16_bf16 v[208:223], v[80:83], v[72:75], v[208:223]
    ds_read_b32 v141, v3 offset:3200
    ds_read_b32 v142, v3 offset:3840
    s_waitcnt lgkmcnt(0)
    v_mfma_f32_32x32x16_bf16 v[160:175], v[56:59], v[48:51], v[160:175]
    ds_read_b128 v[68:71], v17 offset:0
    ds_read_b64_tr_b16 v[76:77], v21 offset:0
    ds_read_b32 v143, v3 offset:128
    ds_read_b32 v144, v3 offset:768
    v_mfma_f32_32x32x16_bf16 v[176:191], v[56:59], v[52:55], v[176:191]
    ds_read_b64_tr_b16 v[78:79], v21 offset:256
    ds_read_b128 v[72:75], v17 offset:4096
    ds_read_b32 v145, v3 offset:1408
    ds_read_b32 v146, v3 offset:2048
    v_mfma_f32_32x32x16_bf16 v[192:207], v[60:63], v[48:51], v[192:207]
    ds_read_b64_tr_b16 v[80:81], v25 offset:0
    ds_read_b64_tr_b16 v[82:83], v25 offset:512
    ds_read_b32 v147, v3 offset:2688
    ds_read_b32 v148, v3 offset:3328
    v_mfma_f32_32x32x16_bf16 v[208:223], v[60:63], v[52:55], v[208:223]
    ds_read_b32 v149, v3 offset:3968
    ds_read_b32 v108, v2 offset:1024
    ds_read_b32 v109, v2 offset:1152
    s_waitcnt lgkmcnt(0)
    v_mfma_f32_32x32x16_bf16 v[160:175], v[76:79], v[68:71], v[160:175]
    ds_read_b128 v[48:51], v18 offset:0
    ds_read_b64_tr_b16 v[56:57], v22 offset:0
    v_sub_f32 v157, 0, v157
    v_cndmask_b32_e64 v157, 0, v157, s[62:63]
    v_sub_f32 v158, 0, v158
    v_cndmask_b32_e64 v158, 0, v158, s[62:63]
    v_mfma_f32_32x32x16_bf16 v[176:191], v[76:79], v[72:75], v[176:191]
    ds_read_b64_tr_b16 v[58:59], v22 offset:256
    ds_read_b128 v[52:55], v18 offset:4096
    v_cvt_pk_bf16_f32 v89, v157, 0
    v_cvt_pk_bf16_f32 v93, v158, 0
    v_lshlrev_b32 v1, 16, v89
    v_lshlrev_b32 v2, 16, v93
    v_mfma_f32_32x32x16_bf16 v[192:207], v[80:83], v[68:71], v[192:207]
    ds_read_b64_tr_b16 v[60:61], v26 offset:0
    ds_read_b64_tr_b16 v[62:63], v26 offset:512
    v_sub_f32 v1, v157, v1
    v_sub_f32 v2, v158, v2
    v_cvt_pk_bf16_f32 v88, v157, v1
    v_mfma_f32_32x32x16_bf16 v[208:223], v[80:83], v[72:75], v[208:223]
    v_mov_b32 v90, 0
    v_mov_b32 v91, 0
    v_cvt_pk_bf16_f32 v92, v158, v2
    v_mov_b32 v94, 0
    s_waitcnt lgkmcnt(0)
    v_mfma_f32_32x32x16_bf16 v[160:175], v[56:59], v[48:51], v[160:175]
    ds_read_b128 v[68:71], v19 offset:0
    ds_read_b64_tr_b16 v[76:77], v23 offset:0
    v_mov_b32 v95, 0
    v_add_f32 v136, v136, v137
    v_add_f32 v138, v138, v139
    v_mfma_f32_32x32x16_bf16 v[176:191], v[56:59], v[52:55], v[176:191]
    ds_read_b64_tr_b16 v[78:79], v23 offset:256
    ds_read_b128 v[72:75], v19 offset:4096
    v_add_f32 v140, v140, v141
    v_add_f32 v136, v136, v142
    v_add_f32 v138, v138, v140
    v_add_f32 v136, v136, v138
    v_mfma_f32_32x32x16_bf16 v[192:207], v[60:63], v[48:51], v[192:207]
    ds_read_b64_tr_b16 v[80:81], v27 offset:0
    ds_read_b64_tr_b16 v[82:83], v27 offset:512
    v_cvt_pk_bf16_f32 v96, v136, v136
    v_lshlrev_b32 v137, 16, v96
    v_sub_f32 v137, v136, v137
    v_cvt_pk_bf16_f32 v97, v137, 0
    v_mfma_f32_32x32x16_bf16 v[208:223], v[60:63], v[52:55], v[208:223]
    v_mov_b32 v98, 0
    v_mov_b32 v99, 0
    v_add_f32 v143, v143, v144
    s_waitcnt lgkmcnt(0)
    v_mfma_f32_32x32x16_bf16 v[160:175], v[76:79], v[68:71], v[160:175]
    v_add_f32 v145, v145, v146
    v_add_f32 v147, v147, v148
    v_add_f32 v143, v143, v149
    v_add_f32 v145, v145, v147
    v_mfma_f32_32x32x16_bf16 v[176:191], v[76:79], v[72:75], v[176:191]
    v_add_f32 v143, v143, v145
    v_cvt_pk_bf16_f32 v100, v143, v143
    v_lshlrev_b32 v144, 16, v100
    v_mfma_f32_32x32x16_bf16 v[192:207], v[80:83], v[68:71], v[192:207]
    v_sub_f32 v144, v143, v144
    v_cvt_pk_bf16_f32 v101, v144, 0
    v_mov_b32 v102, 0
    v_mov_b32 v103, 0
    v_mfma_f32_32x32x16_bf16 v[208:223], v[80:83], v[72:75], v[208:223]
    v_mov_b32 v12, 0x358637bd
    v_mov_b32 v13, 0x3fb8aa3b
    v_mov_b32 v14, 0xb5c1a2a0
    s_setprio 3
    v_mfma_f32_32x32x16_bf16 v[160:175], v[96:99], v[88:91], v[160:175]
    v_mfma_f32_32x32x16_bf16 v[176:191], v[96:99], v[92:95], v[176:191]
    v_mfma_f32_32x32x16_bf16 v[192:207], v[100:103], v[88:91], v[192:207]
    v_mfma_f32_32x32x16_bf16 v[208:223], v[100:103], v[92:95], v[208:223]
    s_lshl_b32 s49, s34, 3
    s_lshl_b32 s50, s33, 1
    s_add_u32 s49, s49, s50
    s_nop 7
    s_nop 7
    s_lshl_b32 s52, s35, 2
    s_add_u32 s52, s52, 48
    v_max_f32 v192, 0, v192
    v_max_f32 v193, 0, v193
    v_max_f32 v194, 0, v194
    v_max_f32 v195, 0, v195
    v_max_f32 v196, 0, v196
    v_max_f32 v197, 0, v197
    v_max_f32 v198, 0, v198
    v_max_f32 v199, 0, v199
    v_pk_mul_f32 v[192:193], v[192:193], v[200:201]
    v_pk_mul_f32 v[194:195], v[194:195], v[202:203]
    v_pk_mul_f32 v[196:197], v[196:197], v[204:205]
    v_pk_mul_f32 v[198:199], v[198:199], v[206:207]
    v_cvt_pk_bf16_f32 v112, v192, v193
    v_cvt_pk_bf16_f32 v113, v194, v195
    v_cvt_pk_bf16_f32 v114, v196, v197
    v_cvt_pk_bf16_f32 v115, v198, v199
    s_add_u32 s51, s49, 0
    s_mul_i32 s51, s51, 112
    s_add_u32 s51, s51, s52
    s_lshl_b32 s51, s51, 10
    buffer_store_dwordx4 v[112:115], v31, s[20:23], s51 offen sc1
    v_max_f32 v208, 0, v208
    v_max_f32 v209, 0, v209
    v_max_f32 v210, 0, v210
    v_max_f32 v211, 0, v211
    v_max_f32 v212, 0, v212
    v_max_f32 v213, 0, v213
    v_max_f32 v214, 0, v214
    v_max_f32 v215, 0, v215
    v_pk_mul_f32 v[208:209], v[208:209], v[216:217]
    v_pk_mul_f32 v[210:211], v[210:211], v[218:219]
    v_pk_mul_f32 v[212:213], v[212:213], v[220:221]
    v_pk_mul_f32 v[214:215], v[214:215], v[222:223]
    v_cvt_pk_bf16_f32 v116, v208, v209
    v_cvt_pk_bf16_f32 v117, v210, v211
    v_cvt_pk_bf16_f32 v118, v212, v213
    v_cvt_pk_bf16_f32 v119, v214, v215
    s_add_u32 s51, s49, 1
    s_mul_i32 s51, s51, 112
    s_add_u32 s51, s51, s52
    s_lshl_b32 s51, s51, 10
    buffer_store_dwordx4 v[116:119], v31, s[20:23], s51 offen sc1
    v_fma_f32 v48, v160, v108, v12
    v_fma_f32 v49, v161, v108, v12
    v_fma_f32 v50, v162, v108, v12
    v_fma_f32 v51, v163, v108, v12
    v_fma_f32 v52, v164, v108, v12
    v_fma_f32 v53, v165, v108, v12
    v_fma_f32 v54, v166, v108, v12
    v_fma_f32 v55, v167, v108, v12
    v_fma_f32 v56, v48, v13, v14
    v_fma_f32 v57, v49, v13, v14
    v_fma_f32 v58, v50, v13, v14
    v_fma_f32 v59, v51, v13, v14
    v_fma_f32 v60, v52, v13, v14
    v_fma_f32 v61, v53, v13, v14
    v_fma_f32 v62, v54, v13, v14
    v_fma_f32 v63, v55, v13, v14
    v_exp_f32_e64 v56, v56 clamp
    v_exp_f32_e64 v57, v57 clamp
    v_exp_f32_e64 v58, v58 clamp
    v_exp_f32_e64 v59, v59 clamp
    v_exp_f32_e64 v60, v60 clamp
    v_exp_f32_e64 v61, v61 clamp
    v_exp_f32_e64 v62, v62 clamp
    v_exp_f32_e64 v63, v63 clamp
    v_max_f32 v48, v12, v48
    v_max_f32 v49, v12, v49
    v_max_f32 v50, v12, v50
    v_max_f32 v51, v12, v51
    v_max_f32 v52, v12, v52
    v_max_f32 v53, v12, v53
    v_max_f32 v54, v12, v54
    v_max_f32 v55, v12, v55
    v_add_f32 v48, v48, v56
    v_add_f32 v49, v49, v57
    v_add_f32 v50, v50, v58
    v_add_f32 v51, v51, v59
    v_add_f32 v52, v52, v60
    v_add_f32 v53, v53, v61
    v_add_f32 v54, v54, v62
    v_add_f32 v55, v55, v63
    v_cvt_pk_bf16_f32 v120, v48, v49
    v_cvt_pk_bf16_f32 v121, v50, v51
    v_cvt_pk_bf16_f32 v122, v52, v53
    v_cvt_pk_bf16_f32 v123, v54, v55
    v_fma_f32 v48, v168, v108, v12
    v_fma_f32 v49, v169, v108, v12
    v_fma_f32 v50, v170, v108, v12
    v_fma_f32 v51, v171, v108, v12
    v_fma_f32 v52, v172, v108, v12
    v_fma_f32 v53, v173, v108, v12
    v_fma_f32 v54, v174, v108, v12
    v_fma_f32 v55, v175, v108, v12
    v_fma_f32 v56, v48, v13, v14
    v_fma_f32 v57, v49, v13, v14
    v_fma_f32 v58, v50, v13, v14
    v_fma_f32 v59, v51, v13, v14
    v_fma_f32 v60, v52, v13, v14
    v_fma_f32 v61, v53, v13, v14
    v_fma_f32 v62, v54, v13, v14
    v_fma_f32 v63, v55, v13, v14
    v_exp_f32_e64 v56, v56 clamp
    v_exp_f32_e64 v57, v57 clamp
    v_exp_f32_e64 v58, v58 clamp
    v_exp_f32_e64 v59, v59 clamp
    v_exp_f32_e64 v60, v60 clamp
    v_exp_f32_e64 v61, v61 clamp
    v_exp_f32_e64 v62, v62 clamp
    v_exp_f32_e64 v63, v63 clamp
    v_max_f32 v48, v12, v48
    v_max_f32 v49, v12, v49
    v_max_f32 v50, v12, v50
    v_max_f32 v51, v12, v51
    v_max_f32 v52, v12, v52
    v_max_f32 v53, v12, v53
    v_max_f32 v54, v12, v54
    v_max_f32 v55, v12, v55
    v_add_f32 v48, v48, v56
    v_add_f32 v49, v49, v57
    v_add_f32 v50, v50, v58
    v_add_f32 v51, v51, v59
    v_add_f32 v52, v52, v60
    v_add_f32 v53, v53, v61
    v_add_f32 v54, v54, v62
    v_add_f32 v55, v55, v63
    v_cndmask_b32_e64 v52, v52, 0, s[62:63]
    v_cndmask_b32_e64 v53, v53, 0, s[62:63]
    v_cndmask_b32_e64 v54, v54, 0, s[62:63]
    v_cndmask_b32_e64 v55, v55, 0, s[62:63]
    v_cvt_pk_bf16_f32 v124, v48, v49
    v_cvt_pk_bf16_f32 v125, v50, v51
    v_cvt_pk_bf16_f32 v126, v52, v53
    v_cvt_pk_bf16_f32 v127, v54, v55
    s_add_u32 s51, s49, 0
    s_lshl_b32 s51, s51, 4
    s_add_u32 s51, s51, s35
    s_lshl_b32 s51, s51, 11
    s_add_u32 s51, s51, 9437184
    buffer_store_dwordx4 v[120:123], v31, s[20:23], s51 offen sc1
    buffer_store_dwordx4 v[124:127], v31, s[20:23], s51 offen offset:1024 sc1
    v_fma_f32 v48, v176, v109, v12
    v_fma_f32 v49, v177, v109, v12
    v_fma_f32 v50, v178, v109, v12
    v_fma_f32 v51, v179, v109, v12
    v_fma_f32 v52, v180, v109, v12
    v_fma_f32 v53, v181, v109, v12
    v_fma_f32 v54, v182, v109, v12
    v_fma_f32 v55, v183, v109, v12
    v_fma_f32 v56, v48, v13, v14
    v_fma_f32 v57, v49, v13, v14
    v_fma_f32 v58, v50, v13, v14
    v_fma_f32 v59, v51, v13, v14
    v_fma_f32 v60, v52, v13, v14
    v_fma_f32 v61, v53, v13, v14
    v_fma_f32 v62, v54, v13, v14
    v_fma_f32 v63, v55, v13, v14
    v_exp_f32_e64 v56, v56 clamp
    v_exp_f32_e64 v57, v57 clamp
    v_exp_f32_e64 v58, v58 clamp
    v_exp_f32_e64 v59, v59 clamp
    v_exp_f32_e64 v60, v60 clamp
    v_exp_f32_e64 v61, v61 clamp
    v_exp_f32_e64 v62, v62 clamp
    v_exp_f32_e64 v63, v63 clamp
    v_max_f32 v48, v12, v48
    v_max_f32 v49, v12, v49
    v_max_f32 v50, v12, v50
    v_max_f32 v51, v12, v51
    v_max_f32 v52, v12, v52
    v_max_f32 v53, v12, v53
    v_max_f32 v54, v12, v54
    v_max_f32 v55, v12, v55
    v_add_f32 v48, v48, v56
    v_add_f32 v49, v49, v57
    v_add_f32 v50, v50, v58
    v_add_f32 v51, v51, v59
    v_add_f32 v52, v52, v60
    v_add_f32 v53, v53, v61
    v_add_f32 v54, v54, v62
    v_add_f32 v55, v55, v63
    v_cvt_pk_bf16_f32 v128, v48, v49
    v_cvt_pk_bf16_f32 v129, v50, v51
    v_cvt_pk_bf16_f32 v130, v52, v53
    v_cvt_pk_bf16_f32 v131, v54, v55
    v_fma_f32 v48, v184, v109, v12
    v_fma_f32 v49, v185, v109, v12
    v_fma_f32 v50, v186, v109, v12
    v_fma_f32 v51, v187, v109, v12
    v_fma_f32 v52, v188, v109, v12
    v_fma_f32 v53, v189, v109, v12
    v_fma_f32 v54, v190, v109, v12
    v_fma_f32 v55, v191, v109, v12
    v_fma_f32 v56, v48, v13, v14
    v_fma_f32 v57, v49, v13, v14
    v_fma_f32 v58, v50, v13, v14
    v_fma_f32 v59, v51, v13, v14
    v_fma_f32 v60, v52, v13, v14
    v_fma_f32 v61, v53, v13, v14
    v_fma_f32 v62, v54, v13, v14
    v_fma_f32 v63, v55, v13, v14
    v_exp_f32_e64 v56, v56 clamp
    v_exp_f32_e64 v57, v57 clamp
    v_exp_f32_e64 v58, v58 clamp
    v_exp_f32_e64 v59, v59 clamp
    v_exp_f32_e64 v60, v60 clamp
    v_exp_f32_e64 v61, v61 clamp
    v_exp_f32_e64 v62, v62 clamp
    v_exp_f32_e64 v63, v63 clamp
    v_max_f32 v48, v12, v48
    v_max_f32 v49, v12, v49
    v_max_f32 v50, v12, v50
    v_max_f32 v51, v12, v51
    v_max_f32 v52, v12, v52
    v_max_f32 v53, v12, v53
    v_max_f32 v54, v12, v54
    v_max_f32 v55, v12, v55
    v_add_f32 v48, v48, v56
    v_add_f32 v49, v49, v57
    v_add_f32 v50, v50, v58
    v_add_f32 v51, v51, v59
    v_add_f32 v52, v52, v60
    v_add_f32 v53, v53, v61
    v_add_f32 v54, v54, v62
    v_add_f32 v55, v55, v63
    v_cndmask_b32_e64 v52, v52, 0, s[62:63]
    v_cndmask_b32_e64 v53, v53, 0, s[62:63]
    v_cndmask_b32_e64 v54, v54, 0, s[62:63]
    v_cndmask_b32_e64 v55, v55, 0, s[62:63]
    v_cvt_pk_bf16_f32 v132, v48, v49
    v_cvt_pk_bf16_f32 v133, v50, v51
    v_cvt_pk_bf16_f32 v134, v52, v53
    v_cvt_pk_bf16_f32 v135, v54, v55
    s_add_u32 s51, s49, 1
    s_lshl_b32 s51, s51, 4
    s_add_u32 s51, s51, s35
    s_lshl_b32 s51, s51, 11
    s_add_u32 s51, s51, 9437184
    buffer_store_dwordx4 v[128:131], v31, s[20:23], s51 offen sc1
    buffer_store_dwordx4 v[132:135], v31, s[20:23], s51 offen offset:1024 sc1
    s_branch F_bridge
K1_B0_slow:
    s_add_u32 s78, s78, 1
    s_cmp_ge_u32 s78, 40
    s_cbranch_scc1 K1_fb_8
    s_sleep 2
    s_lshl_b32 s49, s34, 12
    s_lshl_b32 s50, s32, 10
    s_add_u32 s49, s49, s50
    s_add_u32 s49, s49, 12648448
    buffer_load_dwordx4 v[96:99], v31, s[20:23], s49 offen sc1
    s_mul_i32 s49, s36, 8960
    s_lshl_b32 s50, s32, 10
    s_add_u32 s49, s49, s50
    s_add_u32 s49, s49, 12718080
    buffer_load_dwordx4 v[100:103], v31, s[20:23], s49 offen sc1
    s_waitcnt vmcnt(0)
    v_xor_b32 v108, v96, v97
    v_xor_b32 v108, s59, v108
    v_xor_b32 v108, v98, v108
    v_subrev_u32 v109, s55, v98
    v_cmp_eq_u32 vcc, v108, v99
    v_cmp_gt_u32_e64 s[68:69], s79, v109
    s_nop 1
    s_and_b64 s[68:69], s[68:69], vcc
    v_xor_b32 v110, v100, v101
    v_xor_b32 v110, s59, v110
    v_xor_b32 v110, v102, v110
    v_subrev_u32 v111, s55, v102
    v_cmp_eq_u32 vcc, v110, v103
    v_cmp_gt_u32_e64 s[84:85], s79, v111
    s_nop 1
    s_and_b64 s[84:85], s[84:85], vcc
    s_orn2_b64 s[84:85], s[84:85], s[70:71]
    s_and_b64 s[68:69], s[68:69], s[84:85]
    s_cmp_eq_u64 s[68:69], -1
    s_cbranch_scc0 K1_B0_slow
    s_branch K1_B0_ok
K1_fb_8:
    s_lshl_b32 s49, s34, 8
    s_lshl_b32 s50, s32, 6
    s_add_u32 s49, s49, s50
    v_add_u32 v108, s49, v0
    v_mul_u32_u24 v108, 896, v108
    v_mov_b32 v96, 0
    v_mov_b32 v97, 0
    s_mov_b32 s51, 0
K1_fbr_9:
    buffer_load_dwordx4 v[112:115], v108, s[4:7], s51 offen
    s_waitcnt vmcnt(0)
    v_lshlrev_b32 v109, 16, v112
    v_and_b32 v110, s58, v112
    v_add_f32 v96, v96, v109
    v_fmac_f32 v97, v109, v109
    v_add_f32 v96, v96, v110
    v_fmac_f32 v97, v110, v110
    v_lshlrev_b32 v109, 16, v113
    v_and_b32 v110, s58, v113
    v_add_f32 v96, v96, v109
    v_fmac_f32 v97, v109, v109
    v_add_f32 v96, v96, v110
    v_fmac_f32 v97, v110, v110
    v_lshlrev_b32 v109, 16, v114
    v_and_b32 v110, s58, v114
    v_add_f32 v96, v96, v109
    v_fmac_f32 v97, v109, v109
    v_add_f32 v96, v96, v110
    v_fmac_f32 v97, v110, v110
    v_lshlrev_b32 v109, 16, v115
    v_and_b32 v110, s58, v115
    v_add_f32 v96, v96, v109
    v_fmac_f32 v97, v109, v109
    v_add_f32 v96, v96, v110
    v_fmac_f32 v97, v110, v110
    s_add_u32 s51, s51, 16
    s_cmp_lt_u32 s51, 896
    s_cbranch_scc1 K1_fbr_9
    v_mul_f32 v96, 0x3b124925, v96
    v_mul_f32 v97, 0x3b124925, v97
    v_fma_f32 v97, -v96, v96, v97
    v_max_f32 v97, 0, v97
    v_add_f32 v97, 0x3727c5ac, v97
    v_rsq_f32 v97, v97
    s_nop 0
    s_lshl_b32 s54, s32, 6
    s_add_u32 s54, s54, 256
    v_add_u32 v108, s54, v0
    v_mul_u32_u24 v109, 205, v108
    v_lshrrev_b32 v109, 14, v109
    v_mul_u32_u24 v110, 80, v109
    v_sub_u32 v110, v108, v110
    v_lshrrev_b32 v111, 4, v110
    v_and_b32 v112, 15, v110
    v_lshlrev_b32 v116, 1, v112
    v_subrev_u32 v117, 4, v116
    v_cmp_gt_u32 vcc, 24, v116
    s_nop 1
    v_cndmask_b32 v116, v117, v116, vcc
    s_mul_i32 s49, s35, 28
    v_add_u32 v116, s49, v116
    v_lshlrev_b32 v113, 1, v116
    v_mul_u32_u24 v117, 2688, v109
    v_lshlrev_b32 v117, 6, v117
    v_add_u32 v113, v113, v117
    v_mov_b32 v118, 1073741824
    v_cmp_gt_u32 vcc, 1, v111
    s_nop 1
    v_cndmask_b32 v113, v118, v113, vcc
    v_subrev_u32 v116, 1, v111
    v_lshlrev_b32 v116, 4, v116
    v_and_b32 v117, 7, v112
    v_lshl_add_u32 v116, v117, 1, v116
    s_lshl_b32 s49, s35, 6
    s_add_u32 s49, s49, 768
    v_add_u32 v116, s49, v116
    v_lshlrev_b32 v114, 1, v116
    v_mul_u32_u24 v117, 3584, v109
    v_lshlrev_b32 v117, 6, v117
    v_add_u32 v114, v114, v117
    v_cndmask_b32 v114, v114, v118, vcc
    v_cmp_gt_u32 vcc, 8, v112
    s_nop 1
    v_cndmask_b32 v115, v114, v118, vcc
    v_cndmask_b32 v114, v118, v114, vcc
    v_mov_b32 v100, 0
    v_mov_b32 v101, 0
    s_mov_b32 s51, 0
    s_mov_b32 s52, 0
    s_mov_b32 s53, 0
K1_fbc_10:
    buffer_load_dword v117, v113, s[8:11], s51 offen
    buffer_load_dword v118, v114, s[12:15], s52 offen
    buffer_load_dword v119, v115, s[16:19], s52 offen
    s_waitcnt vmcnt(0)
    v_or_b32 v117, v117, v118
    v_or_b32 v117, v117, v119
    v_lshlrev_b32 v118, 16, v117
    v_and_b32 v119, s58, v117
    v_add_f32 v100, v100, v118
    v_add_f32 v101, v101, v119
    s_add_u32 s51, s51, 2688
    s_add_u32 s52, s52, 3584
    s_add_u32 s53, s53, 1
    s_cmp_lt_u32 s53, 64
    s_cbranch_scc1 K1_fbc_10
    s_branch K1_B0_ok
K1_B1:
    s_setprio 1
    s_mov_b32 s58, 0xffff0000
    s_mov_b32 s62, -1
    s_mov_b32 s63, 0
    s_mov_b32 s30, 0x01000000
    s_mov_b32 s31, 0x01000000
    s_mov_b32 s79, 16777216
    s_mul_i32 s49, s36, 8960
    s_mul_i32 s50, s34, 1280
    s_add_u32 s49, s49, s50
    s_lshl_b32 s50, s33, 10
    s_add_u32 s49, s49, s50
    s_add_u32 s76, s49, 12713984
    v_mov_b32 v1, 0x40000000
    s_cmp_eq_u32 s33, 1
    s_cselect_b32 s68, 0xffff, 0
    s_mov_b32 s69, 0
    s_cmp_eq_u32 s33, 0
    s_cselect_b32 s68, -1, s68
    s_cselect_b32 s69, -1, 0
    s_cmp_lt_u32 s34, 7
    s_cselect_b32 s68, s68, 0
    s_cselect_b32 s69, s69, 0
    s_cselect_b32 s76, s76, 0
    v_cndmask_b32_e64 v43, v1, v31, s[68:69]
    v_and_b32 v1, 31, v0
    v_lshrrev_b32 v2, 5, v0
    v_lshrrev_b32 v3, 1, v1
    v_and_b32 v3, 7, v3
    s_lshl_b32 s49, s33, 13
    v_lshlrev_b32 v4, 7, v1
    v_add_u32 v4, s49, v4
    s_add_u32 s50, s33, 0
    s_and_b32 s50, s50, 3
    s_lshl_b32 s50, s50, 1
    v_add_u32 v5, s50, v2
    v_xor_b32 v5, v5, v3
    v_lshlrev_b32 v5, 4, v5
    v_add_u32 v16, v4, v5
    v_add_u32 v124, 106752, v16
    s_add_u32 s50, s33, 1
    s_and_b32 s50, s50, 3
    s_lshl_b32 s50, s50, 1
    v_add_u32 v5, s50, v2
    v_xor_b32 v5, v5, v3
    v_lshlrev_b32 v5, 4, v5
    v_add_u32 v17, v4, v5
    v_add_u32 v125, 106752, v17
    s_add_u32 s50, s33, 2
    s_and_b32 s50, s50, 3
    s_lshl_b32 s50, s50, 1
    v_add_u32 v5, s50, v2
    v_xor_b32 v5, v5, v3
    v_lshlrev_b32 v5, 4, v5
    v_add_u32 v18, v4, v5
    v_add_u32 v126, 106752, v18
    s_add_u32 s50, s33, 3
    s_and_b32 s50, s50, 3
    s_lshl_b32 s50, s50, 1
    v_add_u32 v5, s50, v2
    v_xor_b32 v5, v5, v3
    v_lshlrev_b32 v5, 4, v5
    v_add_u32 v19, v4, v5
    v_add_u32 v127, 106752, v19
    v_lshrrev_b32 v1, 2, v0
    v_and_b32 v1, 3, v1
    v_and_b32 v2, 3, v0
    v_lshrrev_b32 v3, 5, v0
    v_lshrrev_b32 v4, 4, v0
    v_and_b32 v4, 1, v4
    v_lshlrev_b32 v5, 3, v3
    v_add_u32 v5, v5, v1
    v_lshrrev_b32 v6, 1, v1
    v_lshlrev_b32 v7, 3, v2
    v_lshl_add_u32 v10, v5, 7, v7
    v_mul_u32_u24 v9, 8256, v4
    v_add_u32 v10, v10, v9
    v_add_u32 v10, 36864, v10
    v_lshlrev_b32 v11, 5, v6
    v_xor_b32 v12, 32, v11
    v_add_u32 v8, v10, v12
    v_add_u32 v9, v10, v11
    s_add_u32 s50, s33, 0
    s_and_b32 s50, s50, 3
    s_mul_i32 s51, s50, 2048
    v_add_u32 v20, s51, v8
    v_add_u32 v128, 106752, v20
    s_mul_i32 s51, s50, 2048
    v_add_u32 v24, s51, v9
    v_add_u32 v132, 106752, v24
    s_add_u32 s50, s33, 1
    s_and_b32 s50, s50, 3
    s_mul_i32 s51, s50, 2048
    v_add_u32 v21, s51, v8
    v_add_u32 v129, 106752, v21
    s_mul_i32 s51, s50, 2048
    v_add_u32 v25, s51, v9
    v_add_u32 v133, 106752, v25
    s_add_u32 s50, s33, 2
    s_and_b32 s50, s50, 3
    s_mul_i32 s51, s50, 2048
    v_add_u32 v22, s51, v8
    v_add_u32 v130, 106752, v22
    s_mul_i32 s51, s50, 2048
    v_add_u32 v26, s51, v9
    v_add_u32 v134, 106752, v26
    s_add_u32 s50, s33, 3
    s_and_b32 s50, s50, 3
    s_mul_i32 s51, s50, 2048
    v_add_u32 v23, s51, v8
    v_add_u32 v131, 106752, v23
    s_mul_i32 s51, s50, 2048
    v_add_u32 v27, s51, v9
    v_add_u32 v135, 106752, v27
    s_waitcnt lgkmcnt(0)
    s_sub_u32 s55, s60, 800
    s_xor_b32 s59, s61, 0x5bd1e995
    s_waitcnt vmcnt(7)
    v_lshlrev_b32 v92, 16, v88
    v_and_b32 v93, s58, v88
    v_lshlrev_b32 v94, 16, v89
    v_and_b32 v95, s58, v89
    v_lshlrev_b32 v96, 16, v90
    v_and_b32 v97, s58, v90
    v_lshlrev_b32 v98, 16, v91
    v_and_b32 v99, s58, v91
    v_add_f32 v100, v92, v93
    v_mul_f32 v101, v92, v92
    v_fmac_f32 v101, v93, v93
    v_add_f32 v100, v100, v94
    v_fmac_f32 v101, v94, v94
    v_add_f32 v100, v100, v95
    v_fmac_f32 v101, v95, v95
    v_add_f32 v100, v100, v96
    v_fmac_f32 v101, v96, v96
    v_add_f32 v100, v100, v97
    v_fmac_f32 v101, v97, v97
    v_add_f32 v100, v100, v98
    v_fmac_f32 v101, v98, v98
    v_add_f32 v100, v100, v99
    v_fmac_f32 v101, v99, v99
    s_nop 0
    v_add_f32_dpp v100, v100, v100 row_shr:1 row_mask:0xf bank_mask:0xf bound_ctrl:0
    v_add_f32_dpp v101, v101, v101 row_shr:1 row_mask:0xf bank_mask:0xf bound_ctrl:0
    s_nop 0
    v_add_f32_dpp v100, v100, v100 row_shr:2 row_mask:0xf bank_mask:0xf bound_ctrl:0
    v_add_f32_dpp v101, v101, v101 row_shr:2 row_mask:0xf bank_mask:0xf bound_ctrl:0
    s_nop 0
    v_add_f32_dpp v100, v100, v100 row_shr:4 row_mask:0xf bank_mask:0xf bound_ctrl:0
    v_add_f32_dpp v101, v101, v101 row_shr:4 row_mask:0xf bank_mask:0xf bound_ctrl:0
    s_nop 0
    v_add_f32_dpp v100, v100, v100 row_shr:8 row_mask:0xf bank_mask:0xf bound_ctrl:0
    v_add_f32_dpp v101, v101, v101 row_shr:8 row_mask:0xf bank_mask:0xf bound_ctrl:0
    s_nop 0
    v_add_f32_dpp v100, v100, v100 row_bcast:15 row_mask:0xa bank_mask:0xf
    v_add_f32_dpp v101, v101, v101 row_bcast:15 row_mask:0xa bank_mask:0xf
    s_nop 0
    v_add_f32_dpp v100, v100, v100 row_bcast:31 row_mask:0xc bank_mask:0xf
    v_add_f32_dpp v101, v101, v101 row_bcast:31 row_mask:0xc bank_mask:0xf
    v_mul_f32 v104, 0x3b124925, v100
    v_mul_f32 v101, 0x3b124925, v101
    v_fma_f32 v101, -v104, v104, v101
    v_max_f32 v101, 0, v101
    v_add_f32 v101, 0x3727c5ac, v101
    v_rsq_f32 v105, v101
    s_lshl_b32 s49, s73, 4
    s_add_u32 s49, s49, 12648448
    v_mov_b32 v1, 0
    v_mov_b32 v106, s60
    v_xor_b32 v107, v104, v105
    v_xor_b32 v107, s59, v107
    v_xor_b32 v107, s60, v107
    s_mov_b32 s72, s49
    s_lshl_b32 s74, s44, 7
    s_add_u32 s74, s74, s37
    s_add_u32 m0, s40, 53376
    s_mul_i32 s75, s44, 172032
    buffer_load_dwordx4 v28, s[4:7], s74 offen lds
    s_add_u32 m0, m0, 8192
    s_add_u32 s74, s74, 57344
    buffer_load_dwordx4 v28, s[4:7], s74 offen lds
    s_add_u32 m0, m0, 8192
    s_add_u32 s74, s74, 57344
    buffer_load_dwordx4 v28, s[4:7], s74 offen lds
    s_add_u32 m0, m0, 8192
    s_add_u32 s74, s74, 57344
    buffer_load_dwordx4 v28, s[4:7], s74 offen lds
    s_add_u32 m0, s41, 53376
    s_add_u32 s75, s75, s38
    s_mov_b64 exec, s[56:57]
    buffer_load_dwordx4 v29, s[8:11], s75 offen lds
    s_mov_b64 exec, -1
    s_mul_i32 s74, s44, 229376
    s_add_u32 m0, s42, 53376
    s_add_u32 s74, s74, s39
    buffer_load_dwordx4 v30, s[12:15], s74 offen lds
    s_add_u32 m0, s43, 53376
    s_nop 0
    buffer_load_dwordx4 v30, s[16:19], s74 offen lds
    s_add_u32 s44, s44, 1
    s_cmp_eq_u32 s44, 7
    s_cselect_b32 s44, 0, s44
    s_mov_b32 s68, 0
    s_mov_b32 s69, 0x80000000
    v_mov_b32 v1, 0
    s_mov_b64 exec, s[68:69]
    buffer_store_dwordx4 v[104:107], v1, s[20:23], s72 offen sc1
    s_mov_b64 exec, -1
    v_mov_b32 v2, 0x40000000
    s_and_b32 s50, s2, 63
    s_lshl_b32 s50, s50, 2
    v_mov_b32 v4, s50
    s_cmp_eq_u32 s33, 0
    s_cselect_b64 s[68:69], 1, 0
    s_not_b32 s49, s60
    v_mov_b32 v3, s49
    v_cndmask_b32_e64 v2, v2, v4, s[68:69]
    buffer_atomic_umax v3, v2, s[64:67], 0 offen sc1
    s_waitcnt vmcnt(9)
    s_barrier
    ds_read_b128 v[48:51], v16 offset:0
    ds_read_b64_tr_b16 v[56:57], v20 offset:0
    ds_read_b64_tr_b16 v[58:59], v20 offset:512
    ds_read_b128 v[52:55], v16 offset:4096
    ds_read_b64_tr_b16 v[60:61], v24 offset:64
    ds_read_b64_tr_b16 v[62:63], v24 offset:576
    ds_read_b64_tr_b16 v[64:65], v20 offset:64
    ds_read_b64_tr_b16 v[66:67], v20 offset:576
    s_waitcnt lgkmcnt(0)
    v_mfma_f32_32x32x16_bf16 v[160:175], v[56:59], v[48:51], 0
    ds_read_b128 v[68:71], v17 offset:0
    ds_read_b64_tr_b16 v[76:77], v21 offset:0
    v_lshlrev_b32 v38, 16, v56
    v_and_b32 v39, s58, v56
    v_add_f32 v32, 0, v38
    v_mfma_f32_32x32x16_bf16 v[176:191], v[56:59], v[52:55], 0
    ds_read_b64_tr_b16 v[78:79], v21 offset:512
    ds_read_b128 v[72:75], v17 offset:4096
    v_add_f32 v33, 0, v39
    v_lshlrev_b32 v40, 16, v57
    v_and_b32 v41, s58, v57
    v_mfma_f32_32x32x16_bf16 v[192:207], v[60:63], v[48:51], 0
    ds_read_b64_tr_b16 v[80:81], v25 offset:64
    ds_read_b64_tr_b16 v[82:83], v25 offset:576
    v_add_f32 v32, v32, v40
    v_add_f32 v33, v33, v41
    v_mfma_f32_32x32x16_bf16 v[208:223], v[60:63], v[52:55], 0
    ds_read_b64_tr_b16 v[84:85], v21 offset:64
    ds_read_b64_tr_b16 v[86:87], v21 offset:576
    v_lshlrev_b32 v38, 16, v58
    v_and_b32 v39, s58, v58
    v_add_f32 v32, v32, v38
    v_mfma_f32_32x32x16_bf16 v[224:239], v[64:67], v[48:51], 0
    v_add_f32 v33, v33, v39
    v_lshlrev_b32 v40, 16, v59
    v_and_b32 v41, s58, v59
    v_mfma_f32_32x32x16_bf16 v[240:255], v[64:67], v[52:55], 0
    v_add_f32 v32, v32, v40
    v_add_f32 v33, v33, v41
    s_waitcnt lgkmcnt(0)
    v_mfma_f32_32x32x16_bf16 v[160:175], v[76:79], v[68:71], v[160:175]
    ds_read_b128 v[48:51], v18 offset:0
    ds_read_b64_tr_b16 v[56:57], v22 offset:0
    v_lshlrev_b32 v38, 16, v80
    v_and_b32 v39, s58, v80
    v_add_f32 v34, 0, v38
    v_mfma_f32_32x32x16_bf16 v[176:191], v[76:79], v[72:75], v[176:191]
    ds_read_b64_tr_b16 v[58:59], v22 offset:512
    ds_read_b128 v[52:55], v18 offset:4096
    v_add_f32 v35, 0, v39
    v_lshlrev_b32 v40, 16, v81
    v_and_b32 v41, s58, v81
    v_mfma_f32_32x32x16_bf16 v[192:207], v[80:83], v[68:71], v[192:207]
    ds_read_b64_tr_b16 v[60:61], v26 offset:64
    ds_read_b64_tr_b16 v[62:63], v26 offset:576
    v_add_f32 v34, v34, v40
    v_add_f32 v35, v35, v41
    v_mfma_f32_32x32x16_bf16 v[208:223], v[80:83], v[72:75], v[208:223]
    ds_read_b64_tr_b16 v[64:65], v22 offset:64
    ds_read_b64_tr_b16 v[66:67], v22 offset:576
    v_lshlrev_b32 v38, 16, v82
    v_and_b32 v39, s58, v82
    v_add_f32 v34, v34, v38
    v_mfma_f32_32x32x16_bf16 v[224:239], v[84:87], v[68:71], v[224:239]
    v_add_f32 v35, v35, v39
    v_lshlrev_b32 v40, 16, v83
    v_and_b32 v41, s58, v83
    v_mfma_f32_32x32x16_bf16 v[240:255], v[84:87], v[72:75], v[240:255]
    v_add_f32 v34, v34, v40
    v_add_f32 v35, v35, v41
    s_waitcnt lgkmcnt(0)
    v_mfma_f32_32x32x16_bf16 v[160:175], v[56:59], v[48:51], v[160:175]
    ds_read_b128 v[68:71], v19 offset:0
    ds_read_b64_tr_b16 v[76:77], v23 offset:0
    ds_read_b64_tr_b16 v[78:79], v23 offset:512
    v_lshlrev_b32 v38, 16, v64
    v_and_b32 v39, s58, v64
    v_add_f32 v36, 0, v38
    v_add_f32 v37, 0, v39
    v_lshlrev_b32 v40, 16, v65
    v_and_b32 v41, s58, v65
    v_mfma_f32_32x32x16_bf16 v[176:191], v[56:59], v[52:55], v[176:191]
    ds_read_b128 v[72:75], v19 offset:4096
    ds_read_b64_tr_b16 v[80:81], v27 offset:64
    ds_read_b64_tr_b16 v[82:83], v27 offset:576
    v_add_f32 v36, v36, v40
    v_add_f32 v37, v37, v41
    v_lshlrev_b32 v38, 16, v66
    v_and_b32 v39, s58, v66
    v_add_f32 v36, v36, v38
    v_mfma_f32_32x32x16_bf16 v[192:207], v[60:63], v[48:51], v[192:207]
    ds_read_b64_tr_b16 v[84:85], v23 offset:64
    ds_read_b64_tr_b16 v[86:87], v23 offset:576
    v_add_f32 v37, v37, v39
    v_lshlrev_b32 v40, 16, v67
    v_and_b32 v41, s58, v67
    v_add_f32 v36, v36, v40
    v_add_f32 v37, v37, v41
    v_mfma_f32_32x32x16_bf16 v[208:223], v[60:63], v[52:55], v[208:223]
    v_add_f32 v32, v32, v33
    v_add_f32 v34, v34, v35
    v_add_f32 v36, v36, v37
    v_mov_b32 v33, v32
    v_mov_b32 v35, v34
    v_mov_b32 v37, v36
    s_nop 1
    v_permlane32_swap_b32 v32, v33
    v_permlane32_swap_b32 v34, v35
    v_permlane32_swap_b32 v36, v37
    v_mfma_f32_32x32x16_bf16 v[224:239], v[64:67], v[48:51], v[224:239]
    v_and_b32 v1, 31, v0
    v_lshlrev_b32 v1, 2, v1
    s_mul_i32 s49, s33, 640
    s_add_u32 s49, s49, 160384
    v_add_u32 v1, s49, v1
    v_add_f32 v32, v32, v33
    v_add_f32 v34, v34, v35
    v_add_f32 v36, v36, v37
    ds_write_b32 v1, v32 offset:0
    ds_write_b32 v1, v34 offset:128
    ds_write_b32 v1, v36 offset:256
    s_waitcnt lgkmcnt(0)
    s_waitcnt vmcnt(2)
    s_barrier
    v_mfma_f32_32x32x16_bf16 v[240:255], v[64:67], v[52:55], v[240:255]
    v_mfma_f32_32x32x16_bf16 v[160:175], v[76:79], v[68:71], v[160:175]
    ds_read_b128 v[48:51], v16 offset:53376
    ds_read_b64_tr_b16 v[56:57], v20 offset:53376
    v_mfma_f32_32x32x16_bf16 v[176:191], v[76:79], v[72:75], v[176:191]
    ds_read_b64_tr_b16 v[58:59], v20 offset:53888
    ds_read_b128 v[52:55], v16 offset:57472
    v_mfma_f32_32x32x16_bf16 v[192:207], v[80:83], v[68:71], v[192:207]
    ds_read_b64_tr_b16 v[60:61], v24 offset:53440
    ds_read_b64_tr_b16 v[62:63], v24 offset:53952
    v_mfma_f32_32x32x16_bf16 v[208:223], v[80:83], v[72:75], v[208:223]
    ds_read_b64_tr_b16 v[64:65], v20 offset:53440
    ds_read_b64_tr_b16 v[66:67], v20 offset:53952
    v_mfma_f32_32x32x16_bf16 v[224:239], v[84:87], v[68:71], v[224:239]
    v_mfma_f32_32x32x16_bf16 v[240:255], v[84:87], v[72:75], v[240:255]
    v_lshlrev_b32 v1, 3, v0
    s_and_b32 s49, s33, 1
    s_lshl_b32 s49, s49, 9
    s_add_u32 s49, s49, 160128
    v_add_u32 v1, s49, v1
    ds_read_b64 v[104:105], v1 offset:0
    ds_read_b64 v[106:107], v1 offset:640
    ds_read_b64 v[108:109], v1 offset:1280
    ds_read_b64 v[110:111], v1 offset:1920
    s_waitcnt lgkmcnt(0)
    v_mfma_f32_32x32x16_bf16 v[160:175], v[56:59], v[48:51], v[160:175]
    ds_read_b128 v[68:71], v17 offset:53376
    ds_read_b64_tr_b16 v[76:77], v21 offset:53376
    v_add_f32 v104, v104, v106
    v_add_f32 v108, v108, v110
    v_mfma_f32_32x32x16_bf16 v[176:191], v[56:59], v[52:55], v[176:191]
    ds_read_b64_tr_b16 v[78:79], v21 offset:53888
    ds_read_b128 v[72:75], v17 offset:57472
    v_add_f32 v105, v105, v107
    v_add_f32 v109, v109, v111
    v_mfma_f32_32x32x16_bf16 v[192:207], v[60:63], v[48:51], v[192:207]
    ds_read_b64_tr_b16 v[80:81], v25 offset:53440
    ds_read_b64_tr_b16 v[82:83], v25 offset:53952
    v_add_f32 v112, v104, v108
    v_add_f32 v113, v105, v109
    v_mfma_f32_32x32x16_bf16 v[208:223], v[60:63], v[52:55], v[208:223]
    ds_read_b64_tr_b16 v[84:85], v21 offset:53440
    ds_read_b64_tr_b16 v[86:87], v21 offset:53952
    v_mov_b32 v114, s60
    v_xor_b32 v115, v112, v113
    v_mfma_f32_32x32x16_bf16 v[224:239], v[64:67], v[48:51], v[224:239]
    v_xor_b32 v115, s59, v115
    v_xor_b32 v115, s60, v115
    v_mfma_f32_32x32x16_bf16 v[240:255], v[64:67], v[52:55], v[240:255]
    buffer_store_dwordx4 v[112:115], v43, s[20:23], s76 offen sc1
    s_waitcnt lgkmcnt(0)
    v_mfma_f32_32x32x16_bf16 v[160:175], v[76:79], v[68:71], v[160:175]
    ds_read_b128 v[48:51], v18 offset:53376
    ds_read_b64_tr_b16 v[56:57], v22 offset:53376
    v_mfma_f32_32x32x16_bf16 v[176:191], v[76:79], v[72:75], v[176:191]
    ds_read_b64_tr_b16 v[58:59], v22 offset:53888
    ds_read_b128 v[52:55], v18 offset:57472
    v_mfma_f32_32x32x16_bf16 v[192:207], v[80:83], v[68:71], v[192:207]
    ds_read_b64_tr_b16 v[60:61], v26 offset:53440
    ds_read_b64_tr_b16 v[62:63], v26 offset:53952
    v_mfma_f32_32x32x16_bf16 v[208:223], v[80:83], v[72:75], v[208:223]
    ds_read_b64_tr_b16 v[64:65], v22 offset:53440
    ds_read_b64_tr_b16 v[66:67], v22 offset:53952
    v_mfma_f32_32x32x16_bf16 v[224:239], v[84:87], v[68:71], v[224:239]
    v_mfma_f32_32x32x16_bf16 v[240:255], v[84:87], v[72:75], v[240:255]
    s_waitcnt lgkmcnt(0)
    v_mfma_f32_32x32x16_bf16 v[160:175], v[56:59], v[48:51], v[160:175]
    ds_read_b128 v[68:71], v19 offset:53376
    ds_read_b64_tr_b16 v[76:77], v23 offset:53376
    ds_read_b64_tr_b16 v[78:79], v23 offset:53888
    v_mfma_f32_32x32x16_bf16 v[176:191], v[56:59], v[52:55], v[176:191]
    ds_read_b128 v[72:75], v19 offset:57472
    ds_read_b64_tr_b16 v[80:81], v27 offset:53440
    ds_read_b64_tr_b16 v[82:83], v27 offset:53952
    v_mfma_f32_32x32x16_bf16 v[192:207], v[60:63], v[48:51], v[192:207]
    ds_read_b64_tr_b16 v[84:85], v23 offset:53440
    ds_read_b64_tr_b16 v[86:87], v23 offset:53952
    v_mfma_f32_32x32x16_bf16 v[208:223], v[60:63], v[52:55], v[208:223]
    v_mfma_f32_32x32x16_bf16 v[224:239], v[64:67], v[48:51], v[224:239]
    s_waitcnt lgkmcnt(0)
    s_barrier
    v_mfma_f32_32x32x16_bf16 v[240:255], v[64:67], v[52:55], v[240:255]
    v_mfma_f32_32x32x16_bf16 v[160:175], v[76:79], v[68:71], v[160:175]
    ds_read_b128 v[48:51], v124 offset:0
    ds_read_b64_tr_b16 v[56:57], v128 offset:0
    v_mfma_f32_32x32x16_bf16 v[176:191], v[76:79], v[72:75], v[176:191]
    ds_read_b64_tr_b16 v[58:59], v128 offset:512
    ds_read_b128 v[52:55], v124 offset:4096
    v_mfma_f32_32x32x16_bf16 v[192:207], v[80:83], v[68:71], v[192:207]
    ds_read_b64_tr_b16 v[60:61], v132 offset:64
    ds_read_b64_tr_b16 v[62:63], v132 offset:576
    v_mfma_f32_32x32x16_bf16 v[208:223], v[80:83], v[72:75], v[208:223]
    ds_read_b64_tr_b16 v[64:65], v128 offset:64
    ds_read_b64_tr_b16 v[66:67], v128 offset:576
    v_mfma_f32_32x32x16_bf16 v[224:239], v[84:87], v[68:71], v[224:239]
    v_mfma_f32_32x32x16_bf16 v[240:255], v[84:87], v[72:75], v[240:255]
    s_waitcnt lgkmcnt(0)
    v_mfma_f32_32x32x16_bf16 v[160:175], v[56:59], v[48:51], v[160:175]
    ds_read_b128 v[68:71], v125 offset:0
    ds_read_b64_tr_b16 v[76:77], v129 offset:0
    v_mfma_f32_32x32x16_bf16 v[176:191], v[56:59], v[52:55], v[176:191]
    ds_read_b64_tr_b16 v[78:79], v129 offset:512
    ds_read_b128 v[72:75], v125 offset:4096
    v_mfma_f32_32x32x16_bf16 v[192:207], v[60:63], v[48:51], v[192:207]
    ds_read_b64_tr_b16 v[80:81], v133 offset:64
    ds_read_b64_tr_b16 v[82:83], v133 offset:576
    v_mfma_f32_32x32x16_bf16 v[208:223], v[60:63], v[52:55], v[208:223]
    ds_read_b64_tr_b16 v[84:85], v129 offset:64
    ds_read_b64_tr_b16 v[86:87], v129 offset:576
    v_mfma_f32_32x32x16_bf16 v[224:239], v[64:67], v[48:51], v[224:239]
    v_mfma_f32_32x32x16_bf16 v[240:255], v[64:67], v[52:55], v[240:255]
    s_waitcnt lgkmcnt(0)
    v_mfma_f32_32x32x16_bf16 v[160:175], v[76:79], v[68:71], v[160:175]
    ds_read_b128 v[48:51], v126 offset:0
    ds_read_b64_tr_b16 v[56:57], v130 offset:0
    v_mfma_f32_32x32x16_bf16 v[176:191], v[76:79], v[72:75], v[176:191]
    ds_read_b64_tr_b16 v[58:59], v130 offset:512
    ds_read_b128 v[52:55], v126 offset:4096
    v_mfma_f32_32x32x16_bf16 v[192:207], v[80:83], v[68:71], v[192:207]
    ds_read_b64_tr_b16 v[60:61], v134 offset:64
    ds_read_b64_tr_b16 v[62:63], v134 offset:576
    v_mfma_f32_32x32x16_bf16 v[208:223], v[80:83], v[72:75], v[208:223]
    ds_read_b64_tr_b16 v[64:65], v130 offset:64
    ds_read_b64_tr_b16 v[66:67], v130 offset:576
    v_mfma_f32_32x32x16_bf16 v[224:239], v[84:87], v[68:71], v[224:239]
    v_mfma_f32_32x32x16_bf16 v[240:255], v[84:87], v[72:75], v[240:255]
    s_waitcnt lgkmcnt(0)
    v_mfma_f32_32x32x16_bf16 v[160:175], v[56:59], v[48:51], v[160:175]
    ds_read_b128 v[68:71], v127 offset:0
    ds_read_b64_tr_b16 v[76:77], v131 offset:0
    ds_read_b64_tr_b16 v[78:79], v131 offset:512
    v_mfma_f32_32x32x16_bf16 v[176:191], v[56:59], v[52:55], v[176:191]
    ds_read_b128 v[72:75], v127 offset:4096
    ds_read_b64_tr_b16 v[80:81], v135 offset:64
    ds_read_b64_tr_b16 v[82:83], v135 offset:576
    v_mfma_f32_32x32x16_bf16 v[192:207], v[60:63], v[48:51], v[192:207]
    ds_read_b64_tr_b16 v[84:85], v131 offset:64
    ds_read_b64_tr_b16 v[86:87], v131 offset:576
    v_mfma_f32_32x32x16_bf16 v[208:223], v[60:63], v[52:55], v[208:223]
    v_mfma_f32_32x32x16_bf16 v[224:239], v[64:67], v[48:51], v[224:239]
    s_waitcnt lgkmcnt(0)
    s_barrier
    v_mfma_f32_32x32x16_bf16 v[240:255], v[64:67], v[52:55], v[240:255]
    v_mfma_f32_32x32x16_bf16 v[160:175], v[76:79], v[68:71], v[160:175]
    ds_read_b128 v[48:51], v16 offset:0
    ds_read_b64_tr_b16 v[56:57], v20 offset:0
    v_mfma_f32_32x32x16_bf16 v[176:191], v[76:79], v[72:75], v[176:191]
    ds_read_b64_tr_b16 v[58:59], v20 offset:512
    ds_read_b128 v[52:55], v16 offset:4096
    v_mfma_f32_32x32x16_bf16 v[192:207], v[80:83], v[68:71], v[192:207]
    ds_read_b64_tr_b16 v[60:61], v24 offset:64
    ds_read_b64_tr_b16 v[62:63], v24 offset:576
    v_mfma_f32_32x32x16_bf16 v[208:223], v[80:83], v[72:75], v[208:223]
    ds_read_b64_tr_b16 v[64:65], v20 offset:64
    ds_read_b64_tr_b16 v[66:67], v20 offset:576
    v_mfma_f32_32x32x16_bf16 v[224:239], v[84:87], v[68:71], v[224:239]
    v_mfma_f32_32x32x16_bf16 v[240:255], v[84:87], v[72:75], v[240:255]
    s_waitcnt lgkmcnt(0)
    v_mfma_f32_32x32x16_bf16 v[160:175], v[56:59], v[48:51], v[160:175]
    ds_read_b128 v[68:71], v17 offset:0
    ds_read_b64_tr_b16 v[76:77], v21 offset:0
    v_mov_b32 v38, 0
    v_mov_b32 v39, 0
    v_mov_b32 v40, 0
    v_mov_b32 v41, 0
    v_mfma_f32_32x32x16_bf16 v[176:191], v[56:59], v[52:55], v[176:191]
    ds_read_b64_tr_b16 v[78:79], v21 offset:512
    ds_read_b128 v[72:75], v17 offset:4096
    s_lshl_b32 s53, s34, 5
    s_add_u32 s53, s53, s36
    s_lshl_b32 s53, s53, 2
    s_add_u32 s53, s53, s33
    s_lshl_b32 s53, s53, 11
    s_add_u32 s53, s53, 7340032
    buffer_store_dwordx4 v[38:41], v31, s[20:23], s53 offen sc1
    v_mfma_f32_32x32x16_bf16 v[192:207], v[60:63], v[48:51], v[192:207]
    ds_read_b64_tr_b16 v[80:81], v25 offset:64
    ds_read_b64_tr_b16 v[82:83], v25 offset:576
    buffer_store_dwordx4 v[38:41], v31, s[20:23], s53 offen offset:1024 sc1
    v_mfma_f32_32x32x16_bf16 v[208:223], v[60:63], v[52:55], v[208:223]
    ds_read_b64_tr_b16 v[84:85], v21 offset:64
    ds_read_b64_tr_b16 v[86:87], v21 offset:576
    v_mfma_f32_32x32x16_bf16 v[224:239], v[64:67], v[48:51], v[224:239]
    v_mfma_f32_32x32x16_bf16 v[240:255], v[64:67], v[52:55], v[240:255]
    s_waitcnt lgkmcnt(0)
    v_mfma_f32_32x32x16_bf16 v[160:175], v[76:79], v[68:71], v[160:175]
    ds_read_b128 v[48:51], v18 offset:0
    ds_read_b64_tr_b16 v[56:57], v22 offset:0
    v_mfma_f32_32x32x16_bf16 v[176:191], v[76:79], v[72:75], v[176:191]
    ds_read_b64_tr_b16 v[58:59], v22 offset:512
    ds_read_b128 v[52:55], v18 offset:4096
    v_mfma_f32_32x32x16_bf16 v[192:207], v[80:83], v[68:71], v[192:207]
    ds_read_b64_tr_b16 v[60:61], v26 offset:64
    ds_read_b64_tr_b16 v[62:63], v26 offset:576
    v_mfma_f32_32x32x16_bf16 v[208:223], v[80:83], v[72:75], v[208:223]
    ds_read_b64_tr_b16 v[64:65], v22 offset:64
    ds_read_b64_tr_b16 v[66:67], v22 offset:576
    v_mfma_f32_32x32x16_bf16 v[224:239], v[84:87], v[68:71], v[224:239]
    v_mfma_f32_32x32x16_bf16 v[240:255], v[84:87], v[72:75], v[240:255]
    s_waitcnt lgkmcnt(0)
    v_mfma_f32_32x32x16_bf16 v[160:175], v[56:59], v[48:51], v[160:175]
    ds_read_b128 v[68:71], v19 offset:0
    ds_read_b64_tr_b16 v[76:77], v23 offset:0
    ds_read_b64_tr_b16 v[78:79], v23 offset:512
    v_mfma_f32_32x32x16_bf16 v[176:191], v[56:59], v[52:55], v[176:191]
    ds_read_b128 v[72:75], v19 offset:4096
    ds_read_b64_tr_b16 v[80:81], v27 offset:64
    ds_read_b64_tr_b16 v[82:83], v27 offset:576
    v_mfma_f32_32x32x16_bf16 v[192:207], v[60:63], v[48:51], v[192:207]
    ds_read_b64_tr_b16 v[84:85], v23 offset:64
    ds_read_b64_tr_b16 v[86:87], v23 offset:576
    v_mfma_f32_32x32x16_bf16 v[208:223], v[60:63], v[52:55], v[208:223]
    v_mfma_f32_32x32x16_bf16 v[224:239], v[64:67], v[48:51], v[224:239]
    s_waitcnt lgkmcnt(0)
    s_barrier
    v_mfma_f32_32x32x16_bf16 v[240:255], v[64:67], v[52:55], v[240:255]
    v_mfma_f32_32x32x16_bf16 v[160:175], v[76:79], v[68:71], v[160:175]
    ds_read_b128 v[48:51], v16 offset:53376
    ds_read_b64_tr_b16 v[56:57], v20 offset:53376
    s_mul_i32 s49, s36, 8960
    s_lshl_b32 s50, s33, 10
    s_add_u32 s49, s49, s50
    s_add_u32 s49, s49, 12713984
    buffer_load_dwordx4 v[96:99], v31, s[20:23], s49 offen sc1
    v_mfma_f32_32x32x16_bf16 v[176:191], v[76:79], v[72:75], v[176:191]
    ds_read_b64_tr_b16 v[58:59], v20 offset:53888
    ds_read_b128 v[52:55], v16 offset:57472
    s_mul_i32 s49, s36, 8960
    s_lshl_b32 s50, s32, 10
    s_add_u32 s49, s49, s50
    s_add_u32 s49, s49, 12718080
    buffer_load_dwordx4 v[100:103], v31, s[20:23], s49 offen sc1
    v_mfma_f32_32x32x16_bf16 v[192:207], v[80:83], v[68:71], v[192:207]
    ds_read_b64_tr_b16 v[60:61], v24 offset:53440
    ds_read_b64_tr_b16 v[62:63], v24 offset:53952
    v_mfma_f32_32x32x16_bf16 v[208:223], v[80:83], v[72:75], v[208:223]
    ds_read_b64_tr_b16 v[64:65], v20 offset:53440
    ds_read_b64_tr_b16 v[66:67], v20 offset:53952
    v_mfma_f32_32x32x16_bf16 v[224:239], v[84:87], v[68:71], v[224:239]
    v_mfma_f32_32x32x16_bf16 v[240:255], v[84:87], v[72:75], v[240:255]
    s_waitcnt lgkmcnt(0)
    v_mfma_f32_32x32x16_bf16 v[160:175], v[56:59], v[48:51], v[160:175]
    ds_read_b128 v[68:71], v17 offset:53376
    ds_read_b64_tr_b16 v[76:77], v21 offset:53376
    v_mfma_f32_32x32x16_bf16 v[176:191], v[56:59], v[52:55], v[176:191]
    ds_read_b64_tr_b16 v[78:79], v21 offset:53888
    ds_read_b128 v[72:75], v17 offset:57472
    v_mfma_f32_32x32x16_bf16 v[192:207], v[60:63], v[48:51], v[192:207]
    ds_read_b64_tr_b16 v[80:81], v25 offset:53440
    ds_read_b64_tr_b16 v[82:83], v25 offset:53952
    v_mfma_f32_32x32x16_bf16 v[208:223], v[60:63], v[52:55], v[208:223]
    ds_read_b64_tr_b16 v[84:85], v21 offset:53440
    ds_read_b64_tr_b16 v[86:87], v21 offset:53952
    v_mfma_f32_32x32x16_bf16 v[224:239], v[64:67], v[48:51], v[224:239]
    v_mfma_f32_32x32x16_bf16 v[240:255], v[64:67], v[52:55], v[240:255]
    s_waitcnt lgkmcnt(0)
    v_mfma_f32_32x32x16_bf16 v[160:175], v[76:79], v[68:71], v[160:175]
    ds_read_b128 v[48:51], v18 offset:53376
    ds_read_b64_tr_b16 v[56:57], v22 offset:53376
    v_mfma_f32_32x32x16_bf16 v[176:191], v[76:79], v[72:75], v[176:191]
    ds_read_b64_tr_b16 v[58:59], v22 offset:53888
    ds_read_b128 v[52:55], v18 offset:57472
    v_mfma_f32_32x32x16_bf16 v[192:207], v[80:83], v[68:71], v[192:207]
    ds_read_b64_tr_b16 v[60:61], v26 offset:53440
    ds_read_b64_tr_b16 v[62:63], v26 offset:53952
    v_mfma_f32_32x32x16_bf16 v[208:223], v[80:83], v[72:75], v[208:223]
    ds_read_b64_tr_b16 v[64:65], v22 offset:53440
    ds_read_b64_tr_b16 v[66:67], v22 offset:53952
    v_mfma_f32_32x32x16_bf16 v[224:239], v[84:87], v[68:71], v[224:239]
    v_mfma_f32_32x32x16_bf16 v[240:255], v[84:87], v[72:75], v[240:255]
    s_waitcnt lgkmcnt(0)
    v_mfma_f32_32x32x16_bf16 v[160:175], v[56:59], v[48:51], v[160:175]
    ds_read_b128 v[68:71], v19 offset:53376
    ds_read_b64_tr_b16 v[76:77], v23 offset:53376
    ds_read_b64_tr_b16 v[78:79], v23 offset:53888
    v_mfma_f32_32x32x16_bf16 v[176:191], v[56:59], v[52:55], v[176:191]
    ds_read_b128 v[72:75], v19 offset:57472
    ds_read_b64_tr_b16 v[80:81], v27 offset:53440
    ds_read_b64_tr_b16 v[82:83], v27 offset:53952
    v_mfma_f32_32x32x16_bf16 v[192:207], v[60:63], v[48:51], v[192:207]
    ds_read_b64_tr_b16 v[84:85], v23 offset:53440
    ds_read_b64_tr_b16 v[86:87], v23 offset:53952
    v_mfma_f32_32x32x16_bf16 v[208:223], v[60:63], v[52:55], v[208:223]
    v_mfma_f32_32x32x16_bf16 v[224:239], v[64:67], v[48:51], v[224:239]
    s_waitcnt lgkmcnt(0)
    s_barrier
    v_mfma_f32_32x32x16_bf16 v[240:255], v[64:67], v[52:55], v[240:255]
    v_mfma_f32_32x32x16_bf16 v[160:175], v[76:79], v[68:71], v[160:175]
    ds_read_b128 v[48:51], v124 offset:0
    ds_read_b64_tr_b16 v[56:57], v128 offset:0
    s_lshr_b32 s53, s2, 3
    s_lshl_b32 s53, s53, 3
    s_add_u32 s53, s53, s32
    v_lshlrev_b32 v32, 7, v0
    s_cmp_lt_u32 s53, 196
    s_cselect_b32 s64, s24, s80
    s_cselect_b32 s65, s25, s81
    s_mov_b32 s66, 401408
    s_cselect_b32 s66, 1605632, s66
    s_mov_b32 s67, 0x20000
    s_cselect_b32 s54, 0, 196
    s_sub_u32 s53, s53, s54
    s_lshl_b32 s53, s53, 13
    v_add_u32 v32, s53, v32
    v_mfma_f32_32x32x16_bf16 v[176:191], v[76:79], v[72:75], v[176:191]
    ds_read_b64_tr_b16 v[58:59], v128 offset:512
    ds_read_b128 v[52:55], v124 offset:4096
    s_mov_b32 exec_lo, 0xffffffff
    s_mov_b32 exec_hi, 0xffffffff
    buffer_load_dword v33, v32, s[64:67], 0 offen
    s_mov_b64 exec, -1
    v_mfma_f32_32x32x16_bf16 v[192:207], v[80:83], v[68:71], v[192:207]
    ds_read_b64_tr_b16 v[60:61], v132 offset:64
    ds_read_b64_tr_b16 v[62:63], v132 offset:576
    v_mfma_f32_32x32x16_bf16 v[208:223], v[80:83], v[72:75], v[208:223]
    ds_read_b64_tr_b16 v[64:65], v128 offset:64
    ds_read_b64_tr_b16 v[66:67], v128 offset:576
    v_mfma_f32_32x32x16_bf16 v[224:239], v[84:87], v[68:71], v[224:239]
    v_mfma_f32_32x32x16_bf16 v[240:255], v[84:87], v[72:75], v[240:255]
    s_waitcnt lgkmcnt(0)
    v_mfma_f32_32x32x16_bf16 v[160:175], v[56:59], v[48:51], v[160:175]
    ds_read_b128 v[68:71], v125 offset:0
    ds_read_b64_tr_b16 v[76:77], v129 offset:0
    s_cmp_eq_u32 s32, 4
    s_cselect_b32 s70, -1, 0
    s_cselect_b32 s71, 0xffff, 0
    s_mov_b32 s78, 0
    s_waitcnt vmcnt(1)
    v_mfma_f32_32x32x16_bf16 v[176:191], v[56:59], v[52:55], v[176:191]
    ds_read_b64_tr_b16 v[78:79], v129 offset:512
    ds_read_b128 v[72:75], v125 offset:4096
    v_xor_b32 v108, v96, v97
    v_mfma_f32_32x32x16_bf16 v[192:207], v[60:63], v[48:51], v[192:207]
    ds_read_b64_tr_b16 v[80:81], v133 offset:64
    ds_read_b64_tr_b16 v[82:83], v133 offset:576
    v_xor_b32 v108, s59, v108
    v_mfma_f32_32x32x16_bf16 v[208:223], v[60:63], v[52:55], v[208:223]
    ds_read_b64_tr_b16 v[84:85], v129 offset:64
    ds_read_b64_tr_b16 v[86:87], v129 offset:576
    v_xor_b32 v108, v98, v108
    v_subrev_u32 v109, s55, v98
    v_mfma_f32_32x32x16_bf16 v[224:239], v[64:67], v[48:51], v[224:239]
    v_cmp_eq_u32 vcc, v108, v99
    v_mfma_f32_32x32x16_bf16 v[240:255], v[64:67], v[52:55], v[240:255]
    v_cmp_gt_u32_e64 s[68:69], s79, v109
    s_waitcnt lgkmcnt(0)
    v_mfma_f32_32x32x16_bf16 v[160:175], v[76:79], v[68:71], v[160:175]
    ds_read_b128 v[48:51], v126 offset:0
    ds_read_b64_tr_b16 v[56:57], v130 offset:0
    s_nop 1
    s_and_b64 s[68:69], s[68:69], vcc
    v_mfma_f32_32x32x16_bf16 v[176:191], v[76:79], v[72:75], v[176:191]
    ds_read_b64_tr_b16 v[58:59], v130 offset:512
    ds_read_b128 v[52:55], v126 offset:4096
    v_xor_b32 v110, v100, v101
    v_mfma_f32_32x32x16_bf16 v[192:207], v[80:83], v[68:71], v[192:207]
    ds_read_b64_tr_b16 v[60:61], v134 offset:64
    ds_read_b64_tr_b16 v[62:63], v134 offset:576
    v_xor_b32 v110, s59, v110
    v_mfma_f32_32x32x16_bf16 v[208:223], v[80:83], v[72:75], v[208:223]
    ds_read_b64_tr_b16 v[64:65], v130 offset:64
    ds_read_b64_tr_b16 v[66:67], v130 offset:576
    v_xor_b32 v110, v102, v110
    v_subrev_u32 v111, s55, v102
    v_mfma_f32_32x32x16_bf16 v[224:239], v[84:87], v[68:71], v[224:239]
    v_cmp_eq_u32 vcc, v110, v103
    v_mfma_f32_32x32x16_bf16 v[240:255], v[84:87], v[72:75], v[240:255]
    v_cmp_gt_u32_e64 s[84:85], s79, v111
    s_waitcnt lgkmcnt(0)
    v_mfma_f32_32x32x16_bf16 v[160:175], v[56:59], v[48:51], v[160:175]
    ds_read_b128 v[68:71], v127 offset:0
    ds_read_b64_tr_b16 v[76:77], v131 offset:0
    ds_read_b64_tr_b16 v[78:79], v131 offset:512
    s_nop 1
    s_and_b64 s[84:85], s[84:85], vcc
    v_mfma_f32_32x32x16_bf16 v[176:191], v[56:59], v[52:55], v[176:191]
    ds_read_b128 v[72:75], v127 offset:4096
    ds_read_b64_tr_b16 v[80:81], v135 offset:64
    ds_read_b64_tr_b16 v[82:83], v135 offset:576
    s_orn2_b64 s[84:85], s[84:85], s[70:71]
    s_and_b64 s[68:69], s[68:69], s[84:85]
    s_cmp_eq_u64 s[68:69], -1
    s_cbranch_scc0 K1_B1_slow
K1_B1_ok:
    v_mfma_f32_32x32x16_bf16 v[192:207], v[60:63], v[48:51], v[192:207]
    ds_read_b64_tr_b16 v[84:85], v131 offset:64
    ds_read_b64_tr_b16 v[86:87], v131 offset:576
    s_lshl_b32 s49, s33, 9
    s_add_u32 s49, s49, 55424
    v_lshlrev_b32 v1, 3, v0
    v_add_u32 v1, s49, v1
    ds_write_b64 v1, v[96:97]
    v_mfma_f32_32x32x16_bf16 v[208:223], v[60:63], v[52:55], v[208:223]
    s_lshl_b32 s49, s32, 9
    s_add_u32 s49, s49, 57472
    v_lshlrev_b32 v1, 3, v0
    v_add_u32 v2, s49, v1
    v_add_u32 v1, 160128, v1
    v_cndmask_b32_e64 v1, v1, v2, s[70:71]
    ds_write_b64 v1, v[100:101]
    v_mfma_f32_32x32x16_bf16 v[224:239], v[64:67], v[48:51], v[224:239]
    s_waitcnt lgkmcnt(0)
    s_setprio 3
    s_barrier
    v_mfma_f32_32x32x16_bf16 v[240:255], v[64:67], v[52:55], v[240:255]
    v_mfma_f32_32x32x16_bf16 v[160:175], v[76:79], v[68:71], v[160:175]
    ds_read_b128 v[48:51], v16 offset:0
    ds_read_b64_tr_b16 v[56:57], v20 offset:0
    s_lshr_b32 s53, s2, 3
    s_sub_u32 s53, s53, 4
    s_max_i32 s53, s53, 0
    s_mul_i32 s54, s53, 37
    s_lshr_b32 s54, s54, 8
    s_mul_i32 s54, s54, 7
    s_sub_u32 s53, s53, s54
    s_lshl_b32 s53, s53, 7
    s_mul_i32 s37, s32, 200704
    s_add_u32 s37, s37, s53
    s_add_u32 s37, s37, 0
    s_mul_i32 s39, s32, 50176
    s_add_u32 s39, s39, s53
    s_add_u32 s39, s39, 0
    s_mul_i32 s41, s32, 20480
    s_add_u32 s41, s41, 0
    v_lshrrev_b32 v5, 3, v0
    v_lshrrev_b32 v6, 4, v0
    v_and_b32 v6, 1, v6
    v_lshlrev_b32 v6, 2, v6
    v_and_b32 v7, 7, v0
    v_xor_b32 v7, v7, v6
    v_lshlrev_b32 v7, 4, v7
    v_mul_u32_u24 v28, 896, v5
    v_add_u32 v28, v28, v7
    v_and_b32 v6, 3, v5
    v_subrev_u32 v29, 896, v28
    v_cmp_gt_u32 vcc, 32, v0
    s_nop 1
    v_cndmask_b32 v29, v29, v28, vcc
    v_mov_b32 v7, 0x40000000
    v_cmp_eq_u32 vcc, 3, v6
    s_nop 1
    v_cndmask_b32 v29, v29, v7, vcc
    v_and_b32 v1, 31, v0
    v_lshlrev_b32 v1, 2, v1
    s_lshl_b32 s49, s33, 8
    s_add_u32 s49, s49, 53376
    v_add_u32 v2, s49, v1
    ds_read_b32 v157, v2
    ds_read_b32 v158, v2 offset:128
    v_add_u32 v3, 55680, v1
    ds_read_b32 v136, v3 offset:0
    v_mfma_f32_32x32x16_bf16 v[176:191], v[76:79], v[72:75], v[176:191]
    ds_read_b64_tr_b16 v[58:59], v20 offset:512
    ds_read_b128 v[52:55], v16 offset:4096
    s_add_u32 m0, s41, 0
    s_add_u32 s40, s37, 0
    buffer_load_dwordx4 v28, s[24:27], s40 offen lds
    ds_read_b32 v137, v3 offset:640
    ds_read_b32 v138, v3 offset:1280
    v_mfma_f32_32x32x16_bf16 v[192:207], v[80:83], v[68:71], v[192:207]
    ds_read_b64_tr_b16 v[60:61], v24 offset:64
    ds_read_b64_tr_b16 v[62:63], v24 offset:576
    s_add_u32 m0, s41, 1024
    s_add_u32 s40, s37, 7168
    buffer_load_dwordx4 v28, s[24:27], s40 offen lds
    ds_read_b32 v139, v3 offset:1920
    ds_read_b32 v140, v3 offset:2560
    v_mfma_f32_32x32x16_bf16 v[208:223], v[80:83], v[72:75], v[208:223]
    ds_read_b64_tr_b16 v[64:65], v20 offset:64
    ds_read_b64_tr_b16 v[66:67], v20 offset:576
    s_add_u32 m0, s41, 2048
    s_add_u32 s40, s37, 14336
    buffer_load_dwordx4 v28, s[24:27], s40 offen lds
    ds_read_b32 v141, v3 offset:3200
    ds_read_b32 v142, v3 offset:3840
    v_mfma_f32_32x32x16_bf16 v[224:239], v[84:87], v[68:71], v[224:239]
    s_add_u32 m0, s41, 3072
    s_add_u32 s40, s37, 21504
    buffer_load_dwordx4 v28, s[24:27], s40 offen lds
    ds_read_b32 v143, v3 offset:128
    ds_read_b32 v144, v3 offset:768
    v_mfma_f32_32x32x16_bf16 v[240:255], v[84:87], v[72:75], v[240:255]
    s_add_u32 m0, s41, 4096
    s_add_u32 s40, s37, 28672
    buffer_load_dwordx4 v28, s[24:27], s40 offen lds
    ds_read_b32 v145, v3 offset:1408
    s_waitcnt lgkmcnt(0)
    v_mfma_f32_32x32x16_bf16 v[160:175], v[56:59], v[48:51], v[160:175]
    ds_read_b128 v[68:71], v17 offset:0
    ds_read_b64_tr_b16 v[76:77], v21 offset:0
    s_add_u32 m0, s41, 5120
    s_add_u32 s40, s37, 35840
    buffer_load_dwordx4 v28, s[24:27], s40 offen lds
    ds_read_b32 v146, v3 offset:2048
    ds_read_b32 v147, v3 offset:2688
    v_mfma_f32_32x32x16_bf16 v[176:191], v[56:59], v[52:55], v[176:191]
    ds_read_b64_tr_b16 v[78:79], v21 offset:512
    ds_read_b128 v[72:75], v17 offset:4096
    s_add_u32 m0, s41, 6144
    s_add_u32 s40, s37, 43008
    buffer_load_dwordx4 v28, s[24:27], s40 offen lds
    ds_read_b32 v148, v3 offset:3328
    ds_read_b32 v149, v3 offset:3968
    v_mfma_f32_32x32x16_bf16 v[192:207], v[60:63], v[48:51], v[192:207]
    ds_read_b64_tr_b16 v[80:81], v25 offset:64
    ds_read_b64_tr_b16 v[82:83], v25 offset:576
    ds_read_b32 v150, v3 offset:256
    ds_read_b32 v151, v3 offset:896
    v_mfma_f32_32x32x16_bf16 v[208:223], v[60:63], v[52:55], v[208:223]
    ds_read_b64_tr_b16 v[84:85], v21 offset:64
    ds_read_b64_tr_b16 v[86:87], v21 offset:576
    s_add_u32 m0, s41, 7168
    s_add_u32 s40, s37, 50176
    buffer_load_dwordx4 v28, s[24:27], s40 offen lds
    ds_read_b32 v152, v3 offset:1536
    ds_read_b32 v153, v3 offset:2176
    v_mfma_f32_32x32x16_bf16 v[224:239], v[64:67], v[48:51], v[224:239]
    s_add_u32 m0, s41, 8192
    s_add_u32 s40, s37, 57344
    buffer_load_dwordx4 v28, s[24:27], s40 offen lds
    ds_read_b32 v154, v3 offset:2816
    ds_read_b32 v155, v3 offset:3456
    v_mfma_f32_32x32x16_bf16 v[240:255], v[64:67], v[52:55], v[240:255]
    s_add_u32 m0, s41, 9216
    s_add_u32 s40, s37, 64512
    buffer_load_dwordx4 v28, s[24:27], s40 offen lds
    ds_read_b32 v156, v3 offset:4096
    s_waitcnt lgkmcnt(0)
    v_mfma_f32_32x32x16_bf16 v[160:175], v[76:79], v[68:71], v[160:175]
    ds_read_b128 v[48:51], v18 offset:0
    ds_read_b64_tr_b16 v[56:57], v22 offset:0
    s_add_u32 m0, s41, 10240
    s_add_u32 s40, s37, 71680
    buffer_load_dwordx4 v28, s[24:27], s40 offen lds
    v_sub_f32 v157, 0, v157
    v_cndmask_b32_e64 v157, 0, v157, s[62:63]
    v_sub_f32 v158, 0, v158
    v_mfma_f32_32x32x16_bf16 v[176:191], v[76:79], v[72:75], v[176:191]
    ds_read_b64_tr_b16 v[58:59], v22 offset:512
    ds_read_b128 v[52:55], v18 offset:4096
    s_add_u32 m0, s41, 11264
    s_add_u32 s40, s37, 78848
    buffer_load_dwordx4 v28, s[24:27], s40 offen lds
    v_cndmask_b32_e64 v158, 0, v158, s[62:63]
    v_cvt_pk_bf16_f32 v89, v157, 0
    v_cvt_pk_bf16_f32 v93, v158, 0
    v_mfma_f32_32x32x16_bf16 v[192:207], v[80:83], v[68:71], v[192:207]
    ds_read_b64_tr_b16 v[60:61], v26 offset:64
    ds_read_b64_tr_b16 v[62:63], v26 offset:576
    s_add_u32 m0, s41, 12288
    s_add_u32 s40, s39, 0
    buffer_load_dwordx4 v28, s[80:83], s40 offen lds
    v_lshlrev_b32 v1, 16, v89
    v_lshlrev_b32 v2, 16, v93
    v_sub_f32 v1, v157, v1
    v_mfma_f32_32x32x16_bf16 v[208:223], v[80:83], v[72:75], v[208:223]
    ds_read_b64_tr_b16 v[64:65], v22 offset:64
    ds_read_b64_tr_b16 v[66:67], v22 offset:576
    s_add_u32 m0, s41, 13312
    s_add_u32 s40, s39, 7168
    buffer_load_dwordx4 v29, s[80:83], s40 offen lds
    v_sub_f32 v2, v158, v2
    v_cvt_pk_bf16_f32 v88, v157, v1
    v_mov_b32 v90, 0
    v_mfma_f32_32x32x16_bf16 v[224:239], v[84:87], v[68:71], v[224:239]
    v_mov_b32 v91, 0
    v_cvt_pk_bf16_f32 v92, v158, v2
    v_mov_b32 v94, 0
    v_mfma_f32_32x32x16_bf16 v[240:255], v[84:87], v[72:75], v[240:255]
    s_add_u32 m0, s41, 14336
    s_add_u32 s40, s39, 12544
    buffer_load_dwordx4 v28, s[80:83], s40 offen lds
    v_mov_b32 v95, 0
    v_add_f32 v136, v136, v137
    v_add_f32 v138, v138, v139
    s_waitcnt lgkmcnt(0)
    v_mfma_f32_32x32x16_bf16 v[160:175], v[56:59], v[48:51], v[160:175]
    ds_read_b128 v[68:71], v19 offset:0
    ds_read_b64_tr_b16 v[76:77], v23 offset:0
    s_add_u32 m0, s41, 15360
    s_add_u32 s40, s39, 19712
    buffer_load_dwordx4 v29, s[80:83], s40 offen lds
    v_add_f32 v140, v140, v141
    v_add_f32 v136, v136, v142
    v_add_f32 v138, v138, v140
    v_mfma_f32_32x32x16_bf16 v[176:191], v[56:59], v[52:55], v[176:191]
    ds_read_b64_tr_b16 v[78:79], v23 offset:512
    ds_read_b128 v[72:75], v19 offset:4096
    s_add_u32 m0, s41, 16384
    s_add_u32 s40, s39, 25088
    buffer_load_dwordx4 v28, s[80:83], s40 offen lds
    v_add_f32 v136, v136, v138
    v_cvt_pk_bf16_f32 v96, v136, v136
    v_lshlrev_b32 v137, 16, v96
    v_mfma_f32_32x32x16_bf16 v[192:207], v[60:63], v[48:51], v[192:207]
    ds_read_b64_tr_b16 v[80:81], v27 offset:64
    ds_read_b64_tr_b16 v[82:83], v27 offset:576
    s_add_u32 m0, s41, 17408
    s_add_u32 s40, s39, 32256
    buffer_load_dwordx4 v29, s[80:83], s40 offen lds
    v_sub_f32 v137, v136, v137
    v_cvt_pk_bf16_f32 v97, v137, 0
    v_mfma_f32_32x32x16_bf16 v[208:223], v[60:63], v[52:55], v[208:223]
    ds_read_b64_tr_b16 v[84:85], v23 offset:64
    ds_read_b64_tr_b16 v[86:87], v23 offset:576
    s_add_u32 m0, s41, 18432
    s_add_u32 s40, s39, 37632
    buffer_load_dwordx4 v28, s[80:83], s40 offen lds
    v_mov_b32 v98, 0
    v_mov_b32 v99, 0
    v_add_f32 v143, v143, v144
    v_mfma_f32_32x32x16_bf16 v[224:239], v[64:67], v[48:51], v[224:239]
    s_add_u32 m0, s41, 19456
    s_add_u32 s40, s39, 44800
    buffer_load_dwordx4 v29, s[80:83], s40 offen lds
    v_add_f32 v145, v145, v146
    v_add_f32 v147, v147, v148
    v_add_f32 v143, v143, v149
    v_mfma_f32_32x32x16_bf16 v[240:255], v[64:67], v[52:55], v[240:255]
    v_add_f32 v145, v145, v147
    v_add_f32 v143, v143, v145
    v_cvt_pk_bf16_f32 v100, v143, v143
    s_waitcnt lgkmcnt(0)
    v_mfma_f32_32x32x16_bf16 v[160:175], v[76:79], v[68:71], v[160:175]
    v_lshlrev_b32 v144, 16, v100
    v_sub_f32 v144, v143, v144
    v_cvt_pk_bf16_f32 v101, v144, 0
    v_mfma_f32_32x32x16_bf16 v[176:191], v[76:79], v[72:75], v[176:191]
    v_mov_b32 v102, 0
    v_mov_b32 v103, 0
    v_add_f32 v150, v150, v151
    v_mfma_f32_32x32x16_bf16 v[192:207], v[80:83], v[68:71], v[192:207]
    v_add_f32 v152, v152, v153
    v_add_f32 v154, v154, v155
    v_add_f32 v150, v150, v156
    v_mfma_f32_32x32x16_bf16 v[208:223], v[80:83], v[72:75], v[208:223]
    v_add_f32 v152, v152, v154
    v_add_f32 v150, v150, v152
    v_cvt_pk_bf16_f32 v104, v150, v150
    v_mfma_f32_32x32x16_bf16 v[224:239], v[84:87], v[68:71], v[224:239]
    v_lshlrev_b32 v151, 16, v104
    v_sub_f32 v151, v150, v151
    v_cvt_pk_bf16_f32 v105, v151, 0
    v_mfma_f32_32x32x16_bf16 v[240:255], v[84:87], v[72:75], v[240:255]
    v_mov_b32 v106, 0
    v_mov_b32 v107, 0
    v_mfma_f32_32x32x16_bf16 v[160:175], v[96:99], v[88:91], v[160:175]
    v_mfma_f32_32x32x16_bf16 v[176:191], v[96:99], v[92:95], v[176:191]
    v_mfma_f32_32x32x16_bf16 v[192:207], v[100:103], v[88:91], v[192:207]
    v_mfma_f32_32x32x16_bf16 v[208:223], v[100:103], v[92:95], v[208:223]
    v_mfma_f32_32x32x16_bf16 v[224:239], v[104:107], v[88:91], v[224:239]
    v_mfma_f32_32x32x16_bf16 v[240:255], v[104:107], v[92:95], v[240:255]
    s_lshl_b32 s49, s34, 3
    s_lshl_b32 s50, s33, 1
    s_add_u32 s49, s49, s50
    s_nop 7
    s_nop 3
    s_lshl_b32 s52, s35, 2
    s_add_u32 s52, s52, 49
    v_max_f32 v160, 0, v160
    v_max_f32 v161, 0, v161
    v_max_f32 v162, 0, v162
    v_max_f32 v163, 0, v163
    v_max_f32 v164, 0, v164
    v_max_f32 v165, 0, v165
    v_max_f32 v166, 0, v166
    v_max_f32 v167, 0, v167
    v_pk_mul_f32 v[160:161], v[160:161], v[168:169]
    v_pk_mul_f32 v[162:163], v[162:163], v[170:171]
    v_pk_mul_f32 v[164:165], v[164:165], v[172:173]
    v_pk_mul_f32 v[166:167], v[166:167], v[174:175]
    v_cvt_pk_bf16_f32 v48, v160, v161
    v_cvt_pk_bf16_f32 v49, v162, v163
    v_cvt_pk_bf16_f32 v50, v164, v165
    v_cvt_pk_bf16_f32 v51, v166, v167
    s_add_u32 s51, s49, 0
    s_mul_i32 s51, s51, 112
    s_add_u32 s51, s51, s52
    s_lshl_b32 s51, s51, 10
    buffer_store_dwordx4 v[48:51], v31, s[20:23], s51 offen sc1
    v_max_f32 v176, 0, v176
    v_max_f32 v177, 0, v177
    v_max_f32 v178, 0, v178
    v_max_f32 v179, 0, v179
    v_max_f32 v180, 0, v180
    v_max_f32 v181, 0, v181
    v_max_f32 v182, 0, v182
    v_max_f32 v183, 0, v183
    v_pk_mul_f32 v[176:177], v[176:177], v[184:185]
    v_pk_mul_f32 v[178:179], v[178:179], v[186:187]
    v_pk_mul_f32 v[180:181], v[180:181], v[188:189]
    v_pk_mul_f32 v[182:183], v[182:183], v[190:191]
    v_cvt_pk_bf16_f32 v52, v176, v177
    v_cvt_pk_bf16_f32 v53, v178, v179
    v_cvt_pk_bf16_f32 v54, v180, v181
    v_cvt_pk_bf16_f32 v55, v182, v183
    s_add_u32 s51, s49, 1
    s_mul_i32 s51, s51, 112
    s_add_u32 s51, s51, s52
    s_lshl_b32 s51, s51, 10
    buffer_store_dwordx4 v[52:55], v31, s[20:23], s51 offen sc1
    s_lshl_b32 s52, s35, 2
    s_add_u32 s52, s52, 50
    v_max_f32 v192, 0, v192
    v_max_f32 v193, 0, v193
    v_max_f32 v194, 0, v194
    v_max_f32 v195, 0, v195
    v_max_f32 v196, 0, v196
    v_max_f32 v197, 0, v197
    v_max_f32 v198, 0, v198
    v_max_f32 v199, 0, v199
    v_pk_mul_f32 v[192:193], v[192:193], v[200:201]
    v_pk_mul_f32 v[194:195], v[194:195], v[202:203]
    v_pk_mul_f32 v[196:197], v[196:197], v[204:205]
    v_pk_mul_f32 v[198:199], v[198:199], v[206:207]
    v_cvt_pk_bf16_f32 v56, v192, v193
    v_cvt_pk_bf16_f32 v57, v194, v195
    v_cvt_pk_bf16_f32 v58, v196, v197
    v_cvt_pk_bf16_f32 v59, v198, v199
    s_add_u32 s51, s49, 0
    s_mul_i32 s51, s51, 112
    s_add_u32 s51, s51, s52
    s_lshl_b32 s51, s51, 10
    buffer_store_dwordx4 v[56:59], v31, s[20:23], s51 offen sc1
    v_max_f32 v208, 0, v208
    v_max_f32 v209, 0, v209
    v_max_f32 v210, 0, v210
    v_max_f32 v211, 0, v211
    v_max_f32 v212, 0, v212
    v_max_f32 v213, 0, v213
    v_max_f32 v214, 0, v214
    v_max_f32 v215, 0, v215
    v_pk_mul_f32 v[208:209], v[208:209], v[216:217]
    v_pk_mul_f32 v[210:211], v[210:211], v[218:219]
    v_pk_mul_f32 v[212:213], v[212:213], v[220:221]
    v_pk_mul_f32 v[214:215], v[214:215], v[222:223]
    v_cvt_pk_bf16_f32 v60, v208, v209
    v_cvt_pk_bf16_f32 v61, v210, v211
    v_cvt_pk_bf16_f32 v62, v212, v213
    v_cvt_pk_bf16_f32 v63, v214, v215
    s_add_u32 s51, s49, 1
    s_mul_i32 s51, s51, 112
    s_add_u32 s51, s51, s52
    s_lshl_b32 s51, s51, 10
    buffer_store_dwordx4 v[60:63], v31, s[20:23], s51 offen sc1
    s_lshl_b32 s52, s35, 2
    s_add_u32 s52, s52, 51
    v_max_f32 v224, 0, v224
    v_max_f32 v225, 0, v225
    v_max_f32 v226, 0, v226
    v_max_f32 v227, 0, v227
    v_max_f32 v228, 0, v228
    v_max_f32 v229, 0, v229
    v_max_f32 v230, 0, v230
    v_max_f32 v231, 0, v231
    v_pk_mul_f32 v[224:225], v[224:225], v[232:233]
    v_pk_mul_f32 v[226:227], v[226:227], v[234:235]
    v_pk_mul_f32 v[228:229], v[228:229], v[236:237]
    v_pk_mul_f32 v[230:231], v[230:231], v[238:239]
    v_cvt_pk_bf16_f32 v64, v224, v225
    v_cvt_pk_bf16_f32 v65, v226, v227
    v_cvt_pk_bf16_f32 v66, v228, v229
    v_cvt_pk_bf16_f32 v67, v230, v231
    s_add_u32 s51, s49, 0
    s_mul_i32 s51, s51, 112
    s_add_u32 s51, s51, s52
    s_lshl_b32 s51, s51, 10
    buffer_store_dwordx4 v[64:67], v31, s[20:23], s51 offen sc1
    v_max_f32 v240, 0, v240
    v_max_f32 v241, 0, v241
    v_max_f32 v242, 0, v242
    v_max_f32 v243, 0, v243
    v_max_f32 v244, 0, v244
    v_max_f32 v245, 0, v245
    v_max_f32 v246, 0, v246
    v_max_f32 v247, 0, v247
    v_pk_mul_f32 v[240:241], v[240:241], v[248:249]
    v_pk_mul_f32 v[242:243], v[242:243], v[250:251]
    v_pk_mul_f32 v[244:245], v[244:245], v[252:253]
    v_pk_mul_f32 v[246:247], v[246:247], v[254:255]
    v_cvt_pk_bf16_f32 v68, v240, v241
    v_cvt_pk_bf16_f32 v69, v242, v243
    v_cvt_pk_bf16_f32 v70, v244, v245
    v_cvt_pk_bf16_f32 v71, v246, v247
    s_add_u32 s51, s49, 1
    s_mul_i32 s51, s51, 112
    s_add_u32 s51, s51, s52
    s_lshl_b32 s51, s51, 10
    buffer_store_dwordx4 v[68:71], v31, s[20:23], s51 offen sc1
    s_setprio 0
    s_branch F_bridge
K1_B1_slow:
    s_add_u32 s78, s78, 1
    s_cmp_ge_u32 s78, 40
    s_cbranch_scc1 K1_fb_11
    s_sleep 2
    s_mul_i32 s49, s36, 8960
    s_lshl_b32 s50, s33, 10
    s_add_u32 s49, s49, s50
    s_add_u32 s49, s49, 12713984
    buffer_load_dwordx4 v[96:99], v31, s[20:23], s49 offen sc1
    s_mul_i32 s49, s36, 8960
    s_lshl_b32 s50, s32, 10
    s_add_u32 s49, s49, s50
    s_add_u32 s49, s49, 12718080
    buffer_load_dwordx4 v[100:103], v31, s[20:23], s49 offen sc1
    s_waitcnt vmcnt(0)
    v_xor_b32 v108, v96, v97
    v_xor_b32 v108, s59, v108
    v_xor_b32 v108, v98, v108
    v_subrev_u32 v109, s55, v98
    v_cmp_eq_u32 vcc, v108, v99
    v_cmp_gt_u32_e64 s[68:69], s79, v109
    s_nop 1
    s_and_b64 s[68:69], s[68:69], vcc
    v_xor_b32 v110, v100, v101
    v_xor_b32 v110, s59, v110
    v_xor_b32 v110, v102, v110
    v_subrev_u32 v111, s55, v102
    v_cmp_eq_u32 vcc, v110, v103
    v_cmp_gt_u32_e64 s[84:85], s79, v111
    s_nop 1
    s_and_b64 s[84:85], s[84:85], vcc
    s_orn2_b64 s[84:85], s[84:85], s[70:71]
    s_and_b64 s[68:69], s[68:69], s[84:85]
    s_cmp_eq_u64 s[68:69], -1
    s_cbranch_scc0 K1_B1_slow
    s_branch K1_B1_ok
K1_fb_11:
    s_lshl_b32 s54, s33, 6
    v_add_u32 v108, s54, v0
    v_mul_u32_u24 v109, 205, v108
    v_lshrrev_b32 v109, 14, v109
    v_mul_u32_u24 v110, 80, v109
    v_sub_u32 v110, v108, v110
    v_lshrrev_b32 v111, 4, v110
    v_and_b32 v112, 15, v110
    v_lshlrev_b32 v116, 1, v112
    v_subrev_u32 v117, 4, v116
    v_cmp_gt_u32 vcc, 24, v116
    s_nop 1
    v_cndmask_b32 v116, v117, v116, vcc
    s_mul_i32 s49, s35, 28
    v_add_u32 v116, s49, v116
    v_lshlrev_b32 v113, 1, v116
    v_mul_u32_u24 v117, 2688, v109
    v_lshlrev_b32 v117, 6, v117
    v_add_u32 v113, v113, v117
    v_mov_b32 v118, 1073741824
    v_cmp_gt_u32 vcc, 1, v111
    s_nop 1
    v_cndmask_b32 v113, v118, v113, vcc
    v_subrev_u32 v116, 1, v111
    v_lshlrev_b32 v116, 4, v116
    v_and_b32 v117, 7, v112
    v_lshl_add_u32 v116, v117, 1, v116
    s_lshl_b32 s49, s35, 6
    s_add_u32 s49, s49, 768
    v_add_u32 v116, s49, v116
    v_lshlrev_b32 v114, 1, v116
    v_mul_u32_u24 v117, 3584, v109
    v_lshlrev_b32 v117, 6, v117
    v_add_u32 v114, v114, v117
    v_cndmask_b32 v114, v114, v118, vcc
    v_cmp_gt_u32 vcc, 8, v112
    s_nop 1
    v_cndmask_b32 v115, v114, v118, vcc
    v_cndmask_b32 v114, v118, v114, vcc
    v_mov_b32 v96, 0
    v_mov_b32 v97, 0
    s_mov_b32 s51, 0
    s_mov_b32 s52, 0
    s_mov_b32 s53, 0
K1_fbc_12:
    buffer_load_dword v117, v113, s[8:11], s51 offen
    buffer_load_dword v118, v114, s[12:15], s52 offen
    buffer_load_dword v119, v115, s[16:19], s52 offen
    s_waitcnt vmcnt(0)
    v_or_b32 v117, v117, v118
    v_or_b32 v117, v117, v119
    v_lshlrev_b32 v118, 16, v117
    v_and_b32 v119, s58, v117
    v_add_f32 v96, v96, v118
    v_add_f32 v97, v97, v119
    s_add_u32 s51, s51, 2688
    s_add_u32 s52, s52, 3584
    s_add_u32 s53, s53, 1
    s_cmp_lt_u32 s53, 64
    s_cbranch_scc1 K1_fbc_12
    s_lshl_b32 s54, s32, 6
    s_add_u32 s54, s54, 256
    v_add_u32 v108, s54, v0
    v_mul_u32_u24 v109, 205, v108
    v_lshrrev_b32 v109, 14, v109
    v_mul_u32_u24 v110, 80, v109
    v_sub_u32 v110, v108, v110
    v_lshrrev_b32 v111, 4, v110
    v_and_b32 v112, 15, v110
    v_lshlrev_b32 v116, 1, v112
    v_subrev_u32 v117, 4, v116
    v_cmp_gt_u32 vcc, 24, v116
    s_nop 1
    v_cndmask_b32 v116, v117, v116, vcc
    s_mul_i32 s49, s35, 28
    v_add_u32 v116, s49, v116
    v_lshlrev_b32 v113, 1, v116
    v_mul_u32_u24 v117, 2688, v109
    v_lshlrev_b32 v117, 6, v117
    v_add_u32 v113, v113, v117
    v_mov_b32 v118, 1073741824
    v_cmp_gt_u32 vcc, 1, v111
    s_nop 1
    v_cndmask_b32 v113, v118, v113, vcc
    v_subrev_u32 v116, 1, v111
    v_lshlrev_b32 v116, 4, v116
    v_and_b32 v117, 7, v112
    v_lshl_add_u32 v116, v117, 1, v116
    s_lshl_b32 s49, s35, 6
    s_add_u32 s49, s49, 768
    v_add_u32 v116, s49, v116
    v_lshlrev_b32 v114, 1, v116
    v_mul_u32_u24 v117, 3584, v109
    v_lshlrev_b32 v117, 6, v117
    v_add_u32 v114, v114, v117
    v_cndmask_b32 v114, v114, v118, vcc
    v_cmp_gt_u32 vcc, 8, v112
    s_nop 1
    v_cndmask_b32 v115, v114, v118, vcc
    v_cndmask_b32 v114, v118, v114, vcc
    v_mov_b32 v100, 0
    v_mov_b32 v101, 0
    s_mov_b32 s51, 0
    s_mov_b32 s52, 0
    s_mov_b32 s53, 0
K1_fbc_13:
    buffer_load_dword v117, v113, s[8:11], s51 offen
    buffer_load_dword v118, v114, s[12:15], s52 offen
    buffer_load_dword v119, v115, s[16:19], s52 offen
    s_waitcnt vmcnt(0)
    v_or_b32 v117, v117, v118
    v_or_b32 v117, v117, v119
    v_lshlrev_b32 v118, 16, v117
    v_and_b32 v119, s58, v117
    v_add_f32 v100, v100, v118
    v_add_f32 v101, v101, v119
    s_add_u32 s51, s51, 2688
    s_add_u32 s52, s52, 3584
    s_add_u32 s53, s53, 1
    s_cmp_lt_u32 s53, 64
    s_cbranch_scc1 K1_fbc_13
    s_branch K1_B1_ok
F_bridge:
    s_load_dwordx2 s[16:17], s[0:1], 56
    s_and_b32 s49, s2, 7
    s_lshr_b32 s50, s2, 3
    s_cmp_lt_u32 s50, 4
    s_cbranch_scc1 F_spare
    s_sub_u32 s50, s50, 4
    s_mul_i32 s51, s50, 37
    s_lshr_b32 s51, s51, 8
    s_mul_i32 s52, s51, 7
    s_sub_u32 s52, s50, s52
    s_and_b32 s53, s49, 1
    s_lshl_b32 s53, s53, 2
    s_lshr_b32 s49, s49, 1
    s_add_u32 s49, s49, s53
    s_mov_b32 s47, s49
    s_lshl_b32 s53, s49, 2
    s_add_u32 s53, s53, s51
    s_lshl_b32 s52, s52, 7
    s_mul_i32 s37, s32, 20480
    s_mul_i32 s38, s32, 200704
    s_add_u32 s38, s38, s52
    s_mul_i32 s39, s32, 50176
    s_add_u32 s39, s39, s52
    v_lshrrev_b32 v1, 3, v0
    v_lshrrev_b32 v2, 4, v0
    v_and_b32 v2, 1, v2
    v_lshlrev_b32 v2, 2, v2
    v_and_b32 v3, 7, v0
    v_xor_b32 v3, v3, v2
    v_lshlrev_b32 v3, 4, v3
    v_mul_u32_u24 v11, 896, v1
    v_add_u32 v11, v11, v3
    v_lshlrev_b32 v8, 4, v0
    v_and_b32 v2, 3, v1
    v_subrev_u32 v12, 896, v11
    v_cmp_gt_u32 vcc, 32, v0
    s_nop 1
    v_cndmask_b32 v12, v12, v11, vcc
    v_mov_b32 v3, 0x40000000
    v_cmp_eq_u32 vcc, 3, v2
    s_nop 1
    v_cndmask_b32 v12, v12, v3, vcc
    s_lshl_b32 s54, s32, 3
    v_lshrrev_b32 v1, 3, v0
    v_add_u32 v1, s54, v1
    v_and_b32 v2, 7, v0
    v_mul_u32_u24 v14, 896, v1
    v_lshl_add_u32 v14, v2, 4, v14
    s_mul_i32 s45, s53, 57344
    s_add_u32 s45, s45, s52
    buffer_load_dwordx4 v[112:115], v14, s[4:7], s45 offen
    v_lshlrev_b32 v7, 4, v1
    v_and_b32 v6, 31, v0
    v_lshlrev_b32 v6, 4, v6
    v_lshlrev_b32 v13, 2, v0
    v_add_u32 v15, s37, v8
    v_lshrrev_b32 v1, 2, v0
    v_and_b32 v1, 3, v1
    v_and_b32 v2, 3, v0
    v_lshrrev_b32 v3, 5, v0
    v_lshrrev_b32 v4, 4, v0
    v_and_b32 v4, 1, v4
    v_lshl_add_u32 v5, v3, 2, v1
    v_lshrrev_b32 v1, 1, v1
    v_lshrrev_b32 v3, 1, v2
    v_lshl_add_u32 v3, v4, 1, v3
    v_lshlrev_b32 v1, 2, v1
    v_xor_b32 v3, v3, v1
    v_lshlrev_b32 v3, 4, v3
    v_and_b32 v2, 1, v2
    v_lshl_add_u32 v3, v2, 3, v3
    v_lshl_add_u32 v3, v5, 7, v3
    v_add_u32 v9, s37, v3
    v_xor_b32 v10, 64, v9
    s_mul_i32 s40, s53, 229376
    s_mul_i32 s49, s32, 14336
    s_add_u32 s40, s40, s49
    s_add_u32 s41, s40, 114688
    s_lshl_b32 s49, s32, 12
    s_lshl_b32 s42, s53, 16
    s_add_u32 s42, s42, s49
    s_add_u32 s42, s42, 9437184
    s_add_u32 s43, s42, 32768
    s_lshl_b32 s44, s32, 13
    s_add_u32 s44, s44, 12582912
    s_lshl_b32 s42, s53, 16
    s_lshl_b32 s49, s32, 13
    s_add_u32 s42, s42, s49
    s_add_u32 s42, s42, 7340032
    s_add_u32 s43, s42, 4096
    s_lshl_b32 s46, s53, 10
    s_add_u32 s46, s46, 12648452
    s_mov_b32 s18, 1835008
    s_mov_b32 s19, 0x20000
    s_mov_b32 s54, 0x358637bd
    v_mov_b32 v123, 0x40000000
    v_cmp_eq_u32 vcc, 0, v0
    s_lshl_b32 s49, s34, 5
    s_add_u32 s49, s49, s36
    s_lshl_b32 s49, s49, 4
    s_add_u32 s49, s49, 13107200
    v_mov_b32 v124, s49
    v_cndmask_b32 v123, v123, v124, vcc
    v_mov_b32 v124, 1
    v_mov_b32 v125, 2
    v_mov_b32 v126, s60
    v_xor_b32 v127, v124, v125
    v_xor_b32 v127, s59, v127
    v_xor_b32 v127, s60, v127
    s_cmp_eq_u32 s32, 5
    s_cbranch_scc0 F_nfq
    s_setprio 3
F_nfq:
    s_cmp_lg_u32 s32, 4
    s_cbranch_scc1 F_nfp
    s_setprio 3
F_nfp:
    s_mov_b32 s78, 0
    s_lshl_b32 s49, s47, 9
    s_add_u32 s49, s49, 13107200
    v_mov_b32 v1, 0x40000000
    v_cmp_gt_u32 vcc, 32, v0
    s_nop 1
    v_cndmask_b32 v1, v1, v8, vcc
    s_waitcnt vmcnt(1)
    s_barrier
    s_cmp_lg_u32 s32, 5
    s_cbranch_scc1 F_nfl
    buffer_store_dwordx4 v[124:127], v123, s[20:23], 0 offen sc1
F_nfl:
    s_cmp_lg_u32 s32, 4
    s_cbranch_scc1 F_wait
    s_sleep 6
F_poll:
F_poll0:
    buffer_load_dwordx4 v[96:99], v1, s[20:23], s49 offen sc1
F_poll0w:
    s_waitcnt vmcnt(0)
    v_xor_b32 v2, v96, v97
    v_xor_b32 v2, s59, v2
    v_xor_b32 v2, v98, v2
    v_subrev_u32 v3, s55, v98
    v_cmp_eq_u32 vcc, v2, v99
    v_cmp_gt_u32_e64 s[68:69], s79, v3
    s_nop 1
    s_and_b64 s[68:69], s[68:69], vcc
    s_cmp_eq_u32 s68, -1
    s_cbranch_scc1 F_pdone
    s_add_u32 s78, s78, 1
    s_cmp_ge_u32 s78, 96
    s_cbranch_scc1 W_ref_14
W_ref_14_back:
    s_sleep 4
    s_cmp_lt_u32 s78, 200000
    s_cbranch_scc1 F_poll0
F_pdone:
    s_add_u32 s50, s38, 86016
    buffer_load_dwordx4 v[128:131], v11, s[24:27], s50 offen
    s_add_u32 s50, s38, 93184
    buffer_load_dwordx4 v[132:135], v11, s[24:27], s50 offen
    s_add_u32 s50, s38, 100352
    buffer_load_dwordx4 v[136:139], v11, s[24:27], s50 offen
    s_add_u32 s50, s38, 107520
    buffer_load_dwordx4 v[140:143], v11, s[24:27], s50 offen
    s_add_u32 s50, s38, 114688
    buffer_load_dwordx4 v[144:147], v11, s[24:27], s50 offen
    s_add_u32 s50, s38, 121856
    buffer_load_dwordx4 v[148:151], v11, s[24:27], s50 offen
    s_add_u32 s50, s38, 129024
    buffer_load_dwordx4 v[152:155], v11, s[24:27], s50 offen
    s_add_u32 s50, s38, 136192
    buffer_load_dwordx4 v[156:159], v11, s[24:27], s50 offen
    s_add_u32 s50, s38, 143360
    buffer_load_dwordx4 v[160:163], v11, s[24:27], s50 offen
    s_add_u32 s50, s38, 150528
    buffer_load_dwordx4 v[164:167], v11, s[24:27], s50 offen
    s_add_u32 s50, s38, 157696
    buffer_load_dwordx4 v[168:171], v11, s[24:27], s50 offen
    s_add_u32 s50, s38, 164864
    buffer_load_dwordx4 v[172:175], v11, s[24:27], s50 offen
    s_branch F_wait2
F_wait:
    s_cmp_ge_u32 s32, 4
    s_cbranch_scc1 F_wraw_15
    s_add_u32 m0, s37, 0
    s_add_u32 s50, s38, 0
    buffer_load_dwordx4 v11, s[24:27], s50 offen lds
    s_add_u32 m0, s37, 1024
    s_add_u32 s50, s38, 7168
    buffer_load_dwordx4 v11, s[24:27], s50 offen lds
    s_add_u32 m0, s37, 2048
    s_add_u32 s50, s38, 14336
    buffer_load_dwordx4 v11, s[24:27], s50 offen lds
    s_add_u32 m0, s37, 3072
    s_add_u32 s50, s38, 21504
    buffer_load_dwordx4 v11, s[24:27], s50 offen lds
    s_add_u32 m0, s37, 4096
    s_add_u32 s50, s38, 28672
    buffer_load_dwordx4 v11, s[24:27], s50 offen lds
    s_add_u32 m0, s37, 5120
    s_add_u32 s50, s38, 35840
    buffer_load_dwordx4 v11, s[24:27], s50 offen lds
    s_add_u32 m0, s37, 6144
    s_add_u32 s50, s38, 43008
    buffer_load_dwordx4 v11, s[24:27], s50 offen lds
    s_add_u32 m0, s37, 7168
    s_add_u32 s50, s38, 50176
    buffer_load_dwordx4 v11, s[24:27], s50 offen lds
    s_add_u32 m0, s37, 8192
    s_add_u32 s50, s38, 57344
    buffer_load_dwordx4 v11, s[24:27], s50 offen lds
    s_add_u32 m0, s37, 9216
    s_add_u32 s50, s38, 64512
    buffer_load_dwordx4 v11, s[24:27], s50 offen lds
    s_add_u32 m0, s37, 10240
    s_add_u32 s50, s38, 71680
    buffer_load_dwordx4 v11, s[24:27], s50 offen lds
    s_add_u32 m0, s37, 11264
    s_add_u32 s50, s38, 78848
    buffer_load_dwordx4 v11, s[24:27], s50 offen lds
    s_add_u32 m0, s37, 12288
    s_add_u32 s50, s39, 0
    buffer_load_dwordx4 v11, s[80:83], s50 offen lds
    s_add_u32 m0, s37, 13312
    s_add_u32 s50, s39, 7168
    buffer_load_dwordx4 v12, s[80:83], s50 offen lds
    s_add_u32 m0, s37, 14336
    s_add_u32 s50, s39, 12544
    buffer_load_dwordx4 v11, s[80:83], s50 offen lds
    s_add_u32 m0, s37, 15360
    s_add_u32 s50, s39, 19712
    buffer_load_dwordx4 v12, s[80:83], s50 offen lds
    s_add_u32 m0, s37, 16384
    s_add_u32 s50, s39, 25088
    buffer_load_dwordx4 v11, s[80:83], s50 offen lds
    s_add_u32 m0, s37, 17408
    s_add_u32 s50, s39, 32256
    buffer_load_dwordx4 v12, s[80:83], s50 offen lds
    s_add_u32 m0, s37, 18432
    s_add_u32 s50, s39, 37632
    buffer_load_dwordx4 v11, s[80:83], s50 offen lds
    s_add_u32 m0, s37, 19456
    s_add_u32 s50, s39, 44800
    buffer_load_dwordx4 v12, s[80:83], s50 offen lds
F_wraw_15:
    s_add_u32 s50, s38, 86016
    buffer_load_dwordx4 v[128:131], v11, s[24:27], s50 offen
    s_add_u32 s50, s38, 93184
    buffer_load_dwordx4 v[132:135], v11, s[24:27], s50 offen
    s_add_u32 s50, s38, 100352
    buffer_load_dwordx4 v[136:139], v11, s[24:27], s50 offen
    s_add_u32 s50, s38, 107520
    buffer_load_dwordx4 v[140:143], v11, s[24:27], s50 offen
    s_add_u32 s50, s38, 114688
    buffer_load_dwordx4 v[144:147], v11, s[24:27], s50 offen
    s_add_u32 s50, s38, 121856
    buffer_load_dwordx4 v[148:151], v11, s[24:27], s50 offen
    s_add_u32 s50, s38, 129024
    buffer_load_dwordx4 v[152:155], v11, s[24:27], s50 offen
    s_add_u32 s50, s38, 136192
    buffer_load_dwordx4 v[156:159], v11, s[24:27], s50 offen
    s_add_u32 s50, s38, 143360
    buffer_load_dwordx4 v[160:163], v11, s[24:27], s50 offen
    s_add_u32 s50, s38, 150528
    buffer_load_dwordx4 v[164:167], v11, s[24:27], s50 offen
    s_add_u32 s50, s38, 157696
    buffer_load_dwordx4 v[168:171], v11, s[24:27], s50 offen
    s_add_u32 s50, s38, 164864
    buffer_load_dwordx4 v[172:175], v11, s[24:27], s50 offen
F_wait2:
    s_setprio 0
    s_barrier
    v_mov_b32 v120, 0x40000000
    v_mov_b32 v1, 8188
    v_cmp_eq_u32 vcc, 0, v0
    s_nop 1
    v_cndmask_b32 v120, v120, v1, vcc
    s_setprio 3
    buffer_load_dwordx4 v[16:19], v8, s[20:23], s40 offen offset:0
    buffer_load_dwordx4 v[20:23], v8, s[20:23], s41 offen offset:0
    buffer_load_dword v118, v7, s[20:23], s46 offen sc1
    buffer_load_dwordx4 v[24:27], v8, s[20:23], s40 offen offset:1024
    buffer_load_dwordx4 v[28:31], v8, s[20:23], s41 offen offset:1024
    s_setprio 2
    buffer_load_dwordx4 v[32:35], v8, s[20:23], s40 offen offset:2048
    buffer_load_dwordx4 v[36:39], v8, s[20:23], s41 offen offset:2048
    buffer_load_dwordx4 v[40:43], v8, s[20:23], s40 offen offset:3072
    buffer_load_dwordx4 v[44:47], v8, s[20:23], s41 offen offset:3072
    s_setprio 1
    s_add_u32 s40, s40, 4096
    s_add_u32 s41, s41, 4096
    buffer_load_dwordx4 v[48:51], v8, s[20:23], s40 offen offset:0
    buffer_load_dwordx4 v[52:55], v8, s[20:23], s41 offen offset:0
    s_setprio 0
    s_waitcnt vmcnt(9)
    ds_read_b64_tr_b16 v[96:97], v9 offset:0
    ds_read_b64_tr_b16 v[98:99], v9 offset:1024
    ds_read_b64_tr_b16 v[100:101], v10 offset:0
    ds_read_b64_tr_b16 v[102:103], v10 offset:1024
    s_waitcnt lgkmcnt(0)
    s_waitcnt vmcnt(9)
    v_mfma_f32_32x32x16_bf16 v[192:207], v[96:99], v[16:19], 0
    ds_read_b64_tr_b16 v[104:105], v9 offset:2048
    ds_read_b64_tr_b16 v[106:107], v9 offset:3072
    v_mfma_f32_32x32x16_bf16 v[208:223], v[96:99], v[20:23], 0
    ds_read_b64_tr_b16 v[108:109], v10 offset:2048
    ds_read_b64_tr_b16 v[110:111], v10 offset:3072
    v_mfma_f32_32x32x16_bf16 v[224:239], v[100:103], v[16:19], 0
    v_mfma_f32_32x32x16_bf16 v[240:255], v[100:103], v[20:23], 0
    buffer_load_dwordx4 v[56:59], v8, s[20:23], s40 offen offset:1024
    buffer_load_dwordx4 v[60:63], v8, s[20:23], s41 offen offset:1024
    s_waitcnt lgkmcnt(0)
    s_waitcnt vmcnt(8)
    v_mfma_f32_32x32x16_bf16 v[192:207], v[104:107], v[24:27], v[192:207]
    ds_read_b64_tr_b16 v[96:97], v9 offset:4096
    ds_read_b64_tr_b16 v[98:99], v9 offset:5120
    v_mfma_f32_32x32x16_bf16 v[208:223], v[104:107], v[28:31], v[208:223]
    ds_read_b64_tr_b16 v[100:101], v10 offset:4096
    ds_read_b64_tr_b16 v[102:103], v10 offset:5120
    v_mfma_f32_32x32x16_bf16 v[224:239], v[108:111], v[24:27], v[224:239]
    v_mul_f32 v118, v118, v118
    v_mfma_f32_32x32x16_bf16 v[240:255], v[108:111], v[28:31], v[240:255]
    buffer_load_dwordx4 v[64:67], v8, s[20:23], s40 offen offset:2048
    buffer_load_dwordx4 v[68:71], v8, s[20:23], s41 offen offset:2048
    s_waitcnt lgkmcnt(0)
    s_waitcnt vmcnt(8)
    v_mfma_f32_32x32x16_bf16 v[192:207], v[96:99], v[32:35], v[192:207]
    ds_read_b64_tr_b16 v[104:105], v9 offset:6144
    ds_read_b64_tr_b16 v[106:107], v9 offset:7168
    v_mfma_f32_32x32x16_bf16 v[208:223], v[96:99], v[36:39], v[208:223]
    ds_read_b64_tr_b16 v[108:109], v10 offset:6144
    ds_read_b64_tr_b16 v[110:111], v10 offset:7168
    v_mfma_f32_32x32x16_bf16 v[224:239], v[100:103], v[32:35], v[224:239]
    v_mfma_f32_32x32x16_bf16 v[240:255], v[100:103], v[36:39], v[240:255]
    buffer_load_dwordx4 v[72:75], v8, s[20:23], s40 offen offset:3072
    buffer_load_dwordx4 v[76:79], v8, s[20:23], s41 offen offset:3072
    s_waitcnt lgkmcnt(0)
    s_waitcnt vmcnt(8)
    v_mfma_f32_32x32x16_bf16 v[192:207], v[104:107], v[40:43], v[192:207]
    ds_read_b64_tr_b16 v[96:97], v9 offset:8192
    ds_read_b64_tr_b16 v[98:99], v9 offset:9216
    v_mfma_f32_32x32x16_bf16 v[208:223], v[104:107], v[44:47], v[208:223]
    ds_read_b64_tr_b16 v[100:101], v10 offset:8192
    ds_read_b64_tr_b16 v[102:103], v10 offset:9216
    v_mfma_f32_32x32x16_bf16 v[224:239], v[108:111], v[40:43], v[224:239]
    v_mfma_f32_32x32x16_bf16 v[240:255], v[108:111], v[44:47], v[240:255]
    s_add_u32 s40, s40, 4096
    s_add_u32 s41, s41, 4096
    buffer_load_dwordx4 v[80:83], v8, s[20:23], s40 offen offset:0
    buffer_load_dwordx4 v[84:87], v8, s[20:23], s41 offen offset:0
    s_waitcnt lgkmcnt(0)
    s_waitcnt vmcnt(8)
    v_mfma_f32_32x32x16_bf16 v[192:207], v[96:99], v[48:51], v[192:207]
    ds_read_b64_tr_b16 v[104:105], v9 offset:10240
    ds_read_b64_tr_b16 v[106:107], v9 offset:11264
    v_mfma_f32_32x32x16_bf16 v[208:223], v[96:99], v[52:55], v[208:223]
    ds_read_b64_tr_b16 v[108:109], v10 offset:10240
    ds_read_b64_tr_b16 v[110:111], v10 offset:11264
    v_mfma_f32_32x32x16_bf16 v[224:239], v[100:103], v[48:51], v[224:239]
    ds_write_b128 v15, v[128:131] offset:0
    v_mfma_f32_32x32x16_bf16 v[240:255], v[100:103], v[52:55], v[240:255]
    ds_write_b128 v15, v[132:135] offset:1024
    buffer_load_dwordx4 v[88:91], v8, s[20:23], s40 offen offset:1024
    buffer_load_dwordx4 v[92:95], v8, s[20:23], s41 offen offset:1024
    s_waitcnt lgkmcnt(2)
    s_waitcnt vmcnt(8)
    v_mfma_f32_32x32x16_bf16 v[192:207], v[104:107], v[56:59], v[192:207]
    ds_read_b64_tr_b16 v[96:97], v9 offset:0
    ds_read_b64_tr_b16 v[98:99], v9 offset:1024
    v_mfma_f32_32x32x16_bf16 v[208:223], v[104:107], v[60:63], v[208:223]
    ds_read_b64_tr_b16 v[100:101], v10 offset:0
    ds_read_b64_tr_b16 v[102:103], v10 offset:1024
    v_mfma_f32_32x32x16_bf16 v[224:239], v[108:111], v[56:59], v[224:239]
    ds_write_b128 v15, v[136:139] offset:2048
    v_mfma_f32_32x32x16_bf16 v[240:255], v[108:111], v[60:63], v[240:255]
    ds_write_b128 v15, v[140:143] offset:3072
    s_add_u32 s50, s38, 172032
    buffer_load_dwordx4 v[176:179], v11, s[24:27], s50 offen
    s_add_u32 s50, s38, 179200
    buffer_load_dwordx4 v[180:183], v11, s[24:27], s50 offen
    buffer_load_dwordx4 v[16:19], v8, s[20:23], s40 offen offset:2048
    buffer_load_dwordx4 v[20:23], v8, s[20:23], s41 offen offset:2048
    s_waitcnt lgkmcnt(2)
    s_waitcnt vmcnt(10)
    v_mfma_f32_32x32x16_bf16 v[192:207], v[96:99], v[64:67], v[192:207]
    ds_read_b64_tr_b16 v[104:105], v9 offset:2048
    ds_read_b64_tr_b16 v[106:107], v9 offset:3072
    v_mfma_f32_32x32x16_bf16 v[208:223], v[96:99], v[68:71], v[208:223]
    ds_read_b64_tr_b16 v[108:109], v10 offset:2048
    ds_read_b64_tr_b16 v[110:111], v10 offset:3072
    v_mfma_f32_32x32x16_bf16 v[224:239], v[100:103], v[64:67], v[224:239]
    ds_write_b128 v15, v[144:147] offset:4096
    v_mfma_f32_32x32x16_bf16 v[240:255], v[100:103], v[68:71], v[240:255]
    ds_write_b128 v15, v[148:151] offset:5120
    s_add_u32 s50, s38, 186368
    buffer_load_dwordx4 v[184:187], v11, s[24:27], s50 offen
    s_add_u32 s50, s38, 193536
    buffer_load_dwordx4 v[188:191], v11, s[24:27], s50 offen
    buffer_load_dwordx4 v[24:27], v8, s[20:23], s40 offen offset:3072
    buffer_load_dwordx4 v[28:31], v8, s[20:23], s41 offen offset:3072
    s_waitcnt lgkmcnt(2)
    s_waitcnt vmcnt(12)
    v_mfma_f32_32x32x16_bf16 v[192:207], v[104:107], v[72:75], v[192:207]
    ds_read_b64_tr_b16 v[96:97], v9 offset:4096
    ds_read_b64_tr_b16 v[98:99], v9 offset:5120
    v_mfma_f32_32x32x16_bf16 v[208:223], v[104:107], v[76:79], v[208:223]
    ds_read_b64_tr_b16 v[100:101], v10 offset:4096
    ds_read_b64_tr_b16 v[102:103], v10 offset:5120
    v_mfma_f32_32x32x16_bf16 v[224:239], v[108:111], v[72:75], v[224:239]
    ds_write_b128 v15, v[152:155] offset:6144
    v_mfma_f32_32x32x16_bf16 v[240:255], v[108:111], v[76:79], v[240:255]
    ds_write_b128 v15, v[156:159] offset:7168
    s_add_u32 s40, s40, 4096
    s_add_u32 s41, s41, 4096
    buffer_load_dwordx4 v[32:35], v8, s[20:23], s40 offen offset:0
    buffer_load_dwordx4 v[36:39], v8, s[20:23], s41 offen offset:0
    s_waitcnt lgkmcnt(2)
    s_waitcnt vmcnt(12)
    v_mfma_f32_32x32x16_bf16 v[192:207], v[96:99], v[80:83], v[192:207]
    ds_read_b64_tr_b16 v[104:105], v9 offset:6144
    ds_read_b64_tr_b16 v[106:107], v9 offset:7168
    v_mfma_f32_32x32x16_bf16 v[208:223], v[96:99], v[84:87], v[208:223]
    ds_read_b64_tr_b16 v[108:109], v10 offset:6144
    ds_read_b64_tr_b16 v[110:111], v10 offset:7168
    v_mfma_f32_32x32x16_bf16 v[224:239], v[100:103], v[80:83], v[224:239]
    ds_write_b128 v15, v[160:163] offset:8192
    v_mfma_f32_32x32x16_bf16 v[240:255], v[100:103], v[84:87], v[240:255]
    ds_write_b128 v15, v[164:167] offset:9216
    buffer_load_dwordx4 v[40:43], v8, s[20:23], s40 offen offset:1024
    buffer_load_dwordx4 v[44:47], v8, s[20:23], s41 offen offset:1024
    s_waitcnt lgkmcnt(2)
    s_waitcnt vmcnt(12)
    v_mfma_f32_32x32x16_bf16 v[192:207], v[104:107], v[88:91], v[192:207]
    ds_read_b64_tr_b16 v[96:97], v9 offset:8192
    ds_read_b64_tr_b16 v[98:99], v9 offset:9216
    v_mfma_f32_32x32x16_bf16 v[208:223], v[104:107], v[92:95], v[208:223]
    ds_read_b64_tr_b16 v[100:101], v10 offset:8192
    ds_read_b64_tr_b16 v[102:103], v10 offset:9216
    v_mfma_f32_32x32x16_bf16 v[224:239], v[108:111], v[88:91], v[224:239]
    ds_write_b128 v15, v[168:171] offset:10240
    ds_write_b128 v15, v[172:175] offset:11264
    v_mfma_f32_32x32x16_bf16 v[240:255], v[108:111], v[92:95], v[240:255]
    buffer_load_dword v121, v120, s[20:23], s42 offen sc1
    s_waitcnt lgkmcnt(2)
    s_waitcnt vmcnt(9)
    v_mfma_f32_32x32x16_bf16 v[192:207], v[96:99], v[16:19], v[192:207]
    ds_read_b64_tr_b16 v[104:105], v9 offset:10240
    ds_read_b64_tr_b16 v[106:107], v9 offset:11264
    v_mfma_f32_32x32x16_bf16 v[208:223], v[96:99], v[20:23], v[208:223]
    ds_read_b64_tr_b16 v[108:109], v10 offset:10240
    ds_read_b64_tr_b16 v[110:111], v10 offset:11264
    v_mfma_f32_32x32x16_bf16 v[224:239], v[100:103], v[16:19], v[224:239]
    ds_write_b128 v15, v[176:179] offset:0
    ds_write_b128 v15, v[180:183] offset:1024
    ds_read_b64_tr_b16 v[48:49], v9 offset:12288
    v_mfma_f32_32x32x16_bf16 v[240:255], v[100:103], v[20:23], v[240:255]
    ds_read_b64_tr_b16 v[50:51], v9 offset:13312
    ds_read_b64_tr_b16 v[52:53], v10 offset:12288
    ds_read_b64_tr_b16 v[54:55], v10 offset:13312
    s_waitcnt vmcnt(0)
    v_readfirstlane_b32 s49, v121
    s_lshr_b32 s49, s49, 16
    s_cmp_eq_u32 s49, 0x3f80
    s_cbranch_scc0 F_olate
    buffer_load_dwordx4 v[128:131], v8, s[20:23], s42 offen offset:0 sc1
    buffer_load_dwordx4 v[132:135], v8, s[20:23], s42 offen offset:1024 sc1
    buffer_load_dwordx4 v[136:139], v8, s[20:23], s42 offen offset:2048 sc1
    buffer_load_dwordx4 v[140:143], v8, s[20:23], s42 offen offset:3072 sc1
    buffer_load_dwordx4 v[144:147], v8, s[20:23], s43 offen offset:0 sc1
    buffer_load_dwordx4 v[148:151], v8, s[20:23], s43 offen offset:1024 sc1
    buffer_load_dwordx4 v[152:155], v8, s[20:23], s43 offen offset:2048 sc1
    buffer_load_dwordx4 v[156:159], v8, s[20:23], s43 offen offset:3072 sc1
    s_waitcnt lgkmcnt(6)
    s_waitcnt vmcnt(13)
    v_mfma_f32_32x32x16_bf16 v[192:207], v[104:107], v[24:27], v[192:207]
    ds_read_b64_tr_b16 v[96:97], v9 offset:0
    ds_read_b64_tr_b16 v[98:99], v9 offset:1024
    v_mfma_f32_32x32x16_bf16 v[208:223], v[104:107], v[28:31], v[208:223]
    ds_read_b64_tr_b16 v[100:101], v10 offset:0
    ds_read_b64_tr_b16 v[102:103], v10 offset:1024
    v_mfma_f32_32x32x16_bf16 v[224:239], v[108:111], v[24:27], v[224:239]
    ds_write_b128 v15, v[184:187] offset:2048
    ds_write_b128 v15, v[188:191] offset:3072
    ds_read_b64_tr_b16 v[56:57], v9 offset:14336
    v_mfma_f32_32x32x16_bf16 v[240:255], v[108:111], v[28:31], v[240:255]
    ds_read_b64_tr_b16 v[58:59], v9 offset:15360
    ds_read_b64_tr_b16 v[60:61], v10 offset:14336
    ds_read_b64_tr_b16 v[62:63], v10 offset:15360
    s_waitcnt lgkmcnt(6)
    s_waitcnt vmcnt(11)
    v_mfma_f32_32x32x16_bf16 v[192:207], v[96:99], v[32:35], v[192:207]
    ds_read_b64_tr_b16 v[104:105], v9 offset:2048
    ds_read_b64_tr_b16 v[106:107], v9 offset:3072
    v_mfma_f32_32x32x16_bf16 v[208:223], v[96:99], v[36:39], v[208:223]
    ds_read_b64_tr_b16 v[108:109], v10 offset:2048
    ds_read_b64_tr_b16 v[110:111], v10 offset:3072
    v_mfma_f32_32x32x16_bf16 v[224:239], v[100:103], v[32:35], v[224:239]
    ds_read_b64_tr_b16 v[64:65], v9 offset:16384
    ds_read_b64_tr_b16 v[66:67], v9 offset:17408
    v_mfma_f32_32x32x16_bf16 v[240:255], v[100:103], v[36:39], v[240:255]
    ds_read_b64_tr_b16 v[68:69], v10 offset:16384
    ds_read_b64_tr_b16 v[70:71], v10 offset:17408
    s_waitcnt lgkmcnt(4)
    s_waitcnt vmcnt(9)
    v_mfma_f32_32x32x16_bf16 v[192:207], v[104:107], v[40:43], v[192:207]
    v_mfma_f32_32x32x16_bf16 v[208:223], v[104:107], v[44:47], v[208:223]
    v_mfma_f32_32x32x16_bf16 v[224:239], v[108:111], v[40:43], v[224:239]
    ds_read_b64_tr_b16 v[72:73], v9 offset:18432
    ds_read_b64_tr_b16 v[74:75], v9 offset:19456
    v_mfma_f32_32x32x16_bf16 v[240:255], v[108:111], v[44:47], v[240:255]
    ds_read_b64_tr_b16 v[76:77], v10 offset:18432
    ds_read_b64_tr_b16 v[78:79], v10 offset:19456
    s_mov_b32 s78, 0
    s_waitcnt vmcnt(0)
F_ocheck:
    v_and_b32 v122, v131, v135
    v_and_b32 v122, v122, v139
    v_and_b32 v122, v122, v143
    v_and_b32 v122, v122, v147
    v_and_b32 v122, v122, v151
    v_and_b32 v122, v122, v155
    v_and_b32 v122, v122, v159
    v_lshrrev_b32 v122, 16, v122
    v_cmp_eq_u32 vcc, 0x3f80, v122
    s_waitcnt lgkmcnt(0)
    s_nop 0
    s_cmp_eq_u64 vcc, -1
    s_cbranch_scc0 F_oretry
F_ook:
    v_mfma_f32_32x32x16_bf16 v[192:207], v[48:51], v[128:131], v[192:207]
    v_mfma_f32_32x32x16_bf16 v[208:223], v[48:51], v[132:135], v[208:223]
    v_and_b32 v4, 31, v0
    v_mul_u32_u24 v4, 272, v4
    v_lshrrev_b32 v5, 5, v0
    v_lshl_add_u32 v4, v5, 4, v4
    v_add_u32 v4, s37, v4
    s_lshl_b32 s49, s32, 3
    v_lshrrev_b32 v5, 3, v0
    v_add_u32 v5, s49, v5
    v_mul_u32_u24 v5, 272, v5
    v_and_b32 v6, 7, v0
    v_lshl_add_u32 v5, v6, 5, v5
    v_add_u32 v6, 61440, v5
    v_add_u32 v7, 122880, v5
    v_mfma_f32_32x32x16_bf16 v[192:207], v[56:59], v[136:139], v[192:207]
    v_mfma_f32_32x32x16_bf16 v[208:223], v[56:59], v[140:143], v[208:223]
    v_mfma_f32_32x32x16_bf16 v[192:207], v[64:67], v[144:147], v[192:207]
    v_mfma_f32_32x32x16_bf16 v[208:223], v[64:67], v[148:151], v[208:223]
    v_mfma_f32_32x32x16_bf16 v[192:207], v[72:75], v[152:155], v[192:207]
    v_mfma_f32_32x32x16_bf16 v[208:223], v[72:75], v[156:159], v[208:223]
    v_mfma_f32_32x32x16_bf16 v[224:239], v[52:55], v[128:131], v[224:239]
    v_mfma_f32_32x32x16_bf16 v[240:255], v[52:55], v[132:135], v[240:255]
    v_mfma_f32_32x32x16_bf16 v[224:239], v[60:63], v[136:139], v[224:239]
    v_mfma_f32_32x32x16_bf16 v[240:255], v[60:63], v[140:143], v[240:255]
    s_nop 6
    ds_write_b128 v4, v[192:195] offset:0
    ds_write_b128 v4, v[196:199] offset:32
    ds_write_b128 v4, v[200:203] offset:64
    ds_write_b128 v4, v[204:207] offset:96
    v_mfma_f32_32x32x16_bf16 v[224:239], v[68:71], v[144:147], v[224:239]
    v_mfma_f32_32x32x16_bf16 v[240:255], v[68:71], v[148:151], v[240:255]
    ds_write_b128 v4, v[208:211] offset:8704
    ds_write_b128 v4, v[212:215] offset:8736
    ds_write_b128 v4, v[216:219] offset:8768
    ds_write_b128 v4, v[220:223] offset:8800
    v_mfma_f32_32x32x16_bf16 v[224:239], v[76:79], v[152:155], v[224:239]
    v_mfma_f32_32x32x16_bf16 v[240:255], v[76:79], v[156:159], v[240:255]
    v_lshlrev_b32 v96, 16, v112
    v_and_b32 v97, s58, v112
    v_lshlrev_b32 v98, 16, v113
    v_and_b32 v99, s58, v113
    v_lshlrev_b32 v100, 16, v114
    v_and_b32 v101, s58, v114
    v_lshlrev_b32 v102, 16, v115
    v_and_b32 v103, s58, v115
    s_nop 3
    ds_write_b128 v4, v[224:227] offset:128
    ds_write_b128 v4, v[228:231] offset:160
    ds_write_b128 v4, v[232:235] offset:192
    ds_write_b128 v4, v[236:239] offset:224
    ds_write_b128 v4, v[240:243] offset:8832
    ds_write_b128 v4, v[244:247] offset:8864
    ds_write_b128 v4, v[248:251] offset:8896
    ds_write_b128 v4, v[252:255] offset:8928
    s_waitcnt lgkmcnt(0)
    s_barrier
    ds_read_b128 v[16:19], v5 offset:0
    ds_read_b128 v[20:23], v5 offset:16
    ds_read_b128 v[24:27], v5 offset:20480
    ds_read_b128 v[28:31], v5 offset:20496
    ds_read_b128 v[32:35], v5 offset:40960
    ds_read_b128 v[36:39], v5 offset:40976
    ds_read_b128 v[40:43], v6 offset:0
    ds_read_b128 v[44:47], v6 offset:16
    ds_read_b128 v[48:51], v6 offset:20480
    ds_read_b128 v[52:55], v6 offset:20496
    ds_read_b128 v[56:59], v6 offset:40960
    ds_read_b128 v[60:63], v6 offset:40976
    ds_read_b128 v[64:67], v7 offset:0
    ds_read_b128 v[68:71], v7 offset:16
    ds_read_b128 v[72:75], v7 offset:20480
    ds_read_b128 v[76:79], v7 offset:20496
    s_waitcnt lgkmcnt(12)
    v_add_f32 v16, v16, v24
    v_add_f32 v17, v17, v25
    v_add_f32 v18, v18, v26
    v_add_f32 v19, v19, v27
    v_add_f32 v20, v20, v28
    v_add_f32 v21, v21, v29
    v_add_f32 v22, v22, v30
    v_add_f32 v23, v23, v31
    s_waitcnt lgkmcnt(8)
    v_add_f32 v32, v32, v40
    v_add_f32 v33, v33, v41
    v_add_f32 v34, v34, v42
    v_add_f32 v35, v35, v43
    v_add_f32 v36, v36, v44
    v_add_f32 v37, v37, v45
    v_add_f32 v38, v38, v46
    v_add_f32 v39, v39, v47
    s_waitcnt lgkmcnt(4)
    v_add_f32 v48, v48, v56
    v_add_f32 v49, v49, v57
    v_add_f32 v50, v50, v58
    v_add_f32 v51, v51, v59
    v_add_f32 v52, v52, v60
    v_add_f32 v53, v53, v61
    v_add_f32 v54, v54, v62
    v_add_f32 v55, v55, v63
    s_waitcnt lgkmcnt(0)
    v_add_f32 v64, v64, v72
    v_add_f32 v65, v65, v73
    v_add_f32 v66, v66, v74
    v_add_f32 v67, v67, v75
    v_add_f32 v68, v68, v76
    v_add_f32 v69, v69, v77
    v_add_f32 v70, v70, v78
    v_add_f32 v71, v71, v79
    v_add_f32 v16, v16, v32
    v_add_f32 v48, v48, v64
    v_add_f32 v17, v17, v33
    v_add_f32 v49, v49, v65
    v_add_f32 v18, v18, v34
    v_add_f32 v50, v50, v66
    v_add_f32 v19, v19, v35
    v_add_f32 v51, v51, v67
    v_add_f32 v20, v20, v36
    v_add_f32 v52, v52, v68
    v_add_f32 v21, v21, v37
    v_add_f32 v53, v53, v69
    v_add_f32 v22, v22, v38
    v_add_f32 v54, v54, v70
    v_add_f32 v23, v23, v39
    v_add_f32 v55, v55, v71
    v_add_f32 v16, v16, v48
    v_add_f32 v17, v17, v49
    v_add_f32 v18, v18, v50
    v_add_f32 v19, v19, v51
    v_add_f32 v20, v20, v52
    v_add_f32 v21, v21, v53
    v_add_f32 v22, v22, v54
    v_add_f32 v23, v23, v55
    v_fma_f32 v16, v16, v118, v96
    v_fma_f32 v17, v17, v118, v97
    v_fma_f32 v18, v18, v118, v98
    v_fma_f32 v19, v19, v118, v99
    v_fma_f32 v20, v20, v118, v100
    v_fma_f32 v21, v21, v118, v101
    v_fma_f32 v22, v22, v118, v102
    v_fma_f32 v23, v23, v118, v103
    v_cvt_pk_bf16_f32 v104, v16, v17
    v_cvt_pk_bf16_f32 v105, v18, v19
    v_cvt_pk_bf16_f32 v106, v20, v21
    v_cvt_pk_bf16_f32 v107, v22, v23
    s_waitcnt lgkmcnt(0)
    buffer_store_dwordx4 v[104:107], v14, s[16:19], s45 offen sc0 sc1
    s_endpgm
F_olate:
    s_waitcnt lgkmcnt(6)
    s_waitcnt vmcnt(5)
    v_mfma_f32_32x32x16_bf16 v[192:207], v[104:107], v[24:27], v[192:207]
    ds_read_b64_tr_b16 v[96:97], v9 offset:0
    ds_read_b64_tr_b16 v[98:99], v9 offset:1024
    v_mfma_f32_32x32x16_bf16 v[208:223], v[104:107], v[28:31], v[208:223]
    ds_read_b64_tr_b16 v[100:101], v10 offset:0
    ds_read_b64_tr_b16 v[102:103], v10 offset:1024
    v_mfma_f32_32x32x16_bf16 v[224:239], v[108:111], v[24:27], v[224:239]
    ds_write_b128 v15, v[184:187] offset:2048
    ds_write_b128 v15, v[188:191] offset:3072
    ds_read_b64_tr_b16 v[56:57], v9 offset:14336
    v_mfma_f32_32x32x16_bf16 v[240:255], v[108:111], v[28:31], v[240:255]
    ds_read_b64_tr_b16 v[58:59], v9 offset:15360
    ds_read_b64_tr_b16 v[60:61], v10 offset:14336
    ds_read_b64_tr_b16 v[62:63], v10 offset:15360
    s_waitcnt lgkmcnt(6)
    s_waitcnt vmcnt(3)
    v_mfma_f32_32x32x16_bf16 v[192:207], v[96:99], v[32:35], v[192:207]
    ds_read_b64_tr_b16 v[104:105], v9 offset:2048
    ds_read_b64_tr_b16 v[106:107], v9 offset:3072
    v_mfma_f32_32x32x16_bf16 v[208:223], v[96:99], v[36:39], v[208:223]
    ds_read_b64_tr_b16 v[108:109], v10 offset:2048
    ds_read_b64_tr_b16 v[110:111], v10 offset:3072
    v_mfma_f32_32x32x16_bf16 v[224:239], v[100:103], v[32:35], v[224:239]
    ds_read_b64_tr_b16 v[64:65], v9 offset:16384
    ds_read_b64_tr_b16 v[66:67], v9 offset:17408
    v_mfma_f32_32x32x16_bf16 v[240:255], v[100:103], v[36:39], v[240:255]
    ds_read_b64_tr_b16 v[68:69], v10 offset:16384
    ds_read_b64_tr_b16 v[70:71], v10 offset:17408
    s_waitcnt lgkmcnt(4)
    s_waitcnt vmcnt(1)
    v_mfma_f32_32x32x16_bf16 v[192:207], v[104:107], v[40:43], v[192:207]
    v_mfma_f32_32x32x16_bf16 v[208:223], v[104:107], v[44:47], v[208:223]
    v_mfma_f32_32x32x16_bf16 v[224:239], v[108:111], v[40:43], v[224:239]
    ds_read_b64_tr_b16 v[72:73], v9 offset:18432
    ds_read_b64_tr_b16 v[74:75], v9 offset:19456
    v_mfma_f32_32x32x16_bf16 v[240:255], v[108:111], v[44:47], v[240:255]
    ds_read_b64_tr_b16 v[76:77], v10 offset:18432
    ds_read_b64_tr_b16 v[78:79], v10 offset:19456
    s_mov_b32 s78, 0
F_opoll:
    buffer_load_dword v121, v120, s[20:23], s42 offen sc1
    s_waitcnt vmcnt(0)
    v_readfirstlane_b32 s49, v121
    s_lshr_b32 s49, s49, 16
    s_cmp_eq_u32 s49, 0x3f80
    s_cbranch_scc1 F_oretry1
    s_add_u32 s78, s78, 1
    s_sleep 2
    s_cmp_lt_u32 s78, 200000
    s_cbranch_scc1 F_opoll
    s_branch F_oretry1
F_oretry:
    s_add_u32 s78, s78, 1
    s_cmp_ge_u32 s78, 200000
    s_cbranch_scc1 F_ook
    s_sleep 2
F_oretry1:
    buffer_load_dwordx4 v[128:131], v8, s[20:23], s42 offen offset:0 sc1
    buffer_load_dwordx4 v[132:135], v8, s[20:23], s42 offen offset:1024 sc1
    buffer_load_dwordx4 v[136:139], v8, s[20:23], s42 offen offset:2048 sc1
    buffer_load_dwordx4 v[140:143], v8, s[20:23], s42 offen offset:3072 sc1
    buffer_load_dwordx4 v[144:147], v8, s[20:23], s43 offen offset:0 sc1
    buffer_load_dwordx4 v[148:151], v8, s[20:23], s43 offen offset:1024 sc1
    buffer_load_dwordx4 v[152:155], v8, s[20:23], s43 offen offset:2048 sc1
    buffer_load_dwordx4 v[156:159], v8, s[20:23], s43 offen offset:3072 sc1
    s_waitcnt vmcnt(0)
    s_branch F_ocheck
F_spare:
    s_and_b32 s53, s49, 1
    s_lshl_b32 s53, s53, 2
    s_lshr_b32 s49, s49, 1
    s_add_u32 s49, s49, s53
    s_mov_b32 s47, s49
    s_lshl_b32 s53, s49, 2
    s_add_u32 s53, s53, s50
    v_lshlrev_b32 v8, 4, v0
    v_and_b32 v6, 31, v0
    v_mov_b32 v7, v6
    v_cmp_lt_u32 vcc, 11, v6
    s_nop 1
    v_cndmask_b32 v9, 0, 1, vcc
    v_sub_u32 v7, v7, v9
    v_cmp_lt_u32 vcc, 15, v6
    s_nop 1
    v_cndmask_b32 v9, 0, 1, vcc
    v_sub_u32 v7, v7, v9
    v_cmp_lt_u32 vcc, 27, v6
    s_nop 1
    v_cndmask_b32 v9, 0, 1, vcc
    v_sub_u32 v7, v7, v9
    v_cmp_le_u32 vcc, 24, v7
    s_nop 1
    v_cndmask_b32 v9, 0, 4, vcc
    v_add_u32 v7, v7, v9
    v_and_b32 v9, 11, v6
    v_cmp_eq_u32 vcc, 11, v9
    v_mov_b32 v9, 24
    s_nop 0
    v_cndmask_b32 v7, v7, v9, vcc
    v_and_b32 v9, 32, v0
    v_add_u32 v7, v7, v9
    v_lshlrev_b32 v7, 4, v7
    v_lshlrev_b32 v6, 4, v6
    s_lshl_b32 s49, s32, 12
    s_lshl_b32 s42, s53, 16
    s_lshl_b32 s40, s32, 13
    s_add_u32 s40, s40, s42
    s_add_u32 s40, s40, 7340032
    s_add_u32 s41, s40, 4096
    s_add_u32 s42, s42, s49
    s_add_u32 s42, s42, 9437184
    s_add_u32 s43, s42, 32768
    s_lshl_b32 s44, s32, 13
    s_add_u32 s44, s44, 12582912
    s_add_u32 s38, s44, 4096
    s_lshl_b32 s46, s53, 10
    s_add_u32 s46, s46, 12648452
    s_mov_b32 s54, 0x358637bd
    v_mov_b32 v123, 0x40000000
    v_cmp_eq_u32 vcc, 0, v0
    s_lshl_b32 s49, s34, 5
    s_add_u32 s49, s49, s36
    s_lshl_b32 s49, s49, 4
    s_add_u32 s49, s49, 13107200
    v_mov_b32 v124, s49
    v_cndmask_b32 v123, v123, v124, vcc
    v_mov_b32 v124, 1
    v_mov_b32 v125, 2
    v_mov_b32 v126, s60
    v_xor_b32 v127, v124, v125
    v_xor_b32 v127, s59, v127
    v_xor_b32 v127, s60, v127
    s_waitcnt vmcnt(0) lgkmcnt(0)
    s_barrier
    s_cmp_lg_u32 s32, 4
    s_cbranch_scc1 S_wait
    buffer_store_dwordx4 v[124:127], v123, s[20:23], 0 offen sc1
    s_setprio 3
    s_mov_b32 s78, 0
S_poll:
    s_lshl_b32 s49, s47, 9
    s_add_u32 s49, s49, 13107200
    v_mov_b32 v1, 0x40000000
    v_cmp_gt_u32 vcc, 32, v0
    s_nop 1
    v_cndmask_b32 v1, v1, v8, vcc
S_poll0:
    buffer_load_dwordx4 v[96:99], v1, s[20:23], s49 offen sc1
    s_waitcnt vmcnt(0)
    v_xor_b32 v2, v96, v97
    v_xor_b32 v2, s59, v2
    v_xor_b32 v2, v98, v2
    v_subrev_u32 v3, s55, v98
    v_cmp_eq_u32 vcc, v2, v99
    v_cmp_gt_u32_e64 s[68:69], s79, v3
    s_nop 1
    s_and_b64 s[68:69], s[68:69], vcc
    s_lshr_b32 s68, s68, 16
    s_cmp_eq_u32 s68, 0xffff
    s_cbranch_scc1 S_poll1
    s_add_u32 s78, s78, 1
    s_cmp_ge_u32 s78, 96
    s_cbranch_scc1 W_ref_16
W_ref_16_back:
    s_sleep 4
    s_cmp_lt_u32 s78, 200000
    s_cbranch_scc1 S_poll0
S_poll1:
    s_barrier
S_poll2:
    s_mov_b32 s49, 13107200
    buffer_load_dwordx4 v[96:99], v8, s[20:23], s49 offen offset:0 sc1
    buffer_load_dwordx4 v[100:103], v8, s[20:23], s49 offen offset:1024 sc1
    buffer_load_dwordx4 v[104:107], v8, s[20:23], s49 offen offset:2048 sc1
    buffer_load_dwordx4 v[108:111], v8, s[20:23], s49 offen offset:3072 sc1
    s_mov_b64 s[84:85], -1
    s_waitcnt vmcnt(3)
    v_xor_b32 v2, v96, v97
    v_xor_b32 v2, s59, v2
    v_xor_b32 v2, v98, v2
    v_subrev_u32 v3, s55, v98
    v_cmp_eq_u32 vcc, v2, v99
    v_cmp_gt_u32_e64 s[68:69], s79, v3
    s_nop 1
    s_and_b64 s[68:69], s[68:69], vcc
    s_and_b64 s[84:85], s[84:85], s[68:69]
    s_waitcnt vmcnt(2)
    v_xor_b32 v2, v100, v101
    v_xor_b32 v2, s59, v2
    v_xor_b32 v2, v102, v2
    v_subrev_u32 v3, s55, v102
    v_cmp_eq_u32 vcc, v2, v103
    v_cmp_gt_u32_e64 s[68:69], s79, v3
    s_nop 1
    s_and_b64 s[68:69], s[68:69], vcc
    s_and_b64 s[84:85], s[84:85], s[68:69]
    s_waitcnt vmcnt(1)
    v_xor_b32 v2, v104, v105
    v_xor_b32 v2, s59, v2
    v_xor_b32 v2, v106, v2
    v_subrev_u32 v3, s55, v106
    v_cmp_eq_u32 vcc, v2, v107
    v_cmp_gt_u32_e64 s[68:69], s79, v3
    s_nop 1
    s_and_b64 s[68:69], s[68:69], vcc
    s_and_b64 s[84:85], s[84:85], s[68:69]
    s_waitcnt vmcnt(0)
    v_xor_b32 v2, v108, v109
    v_xor_b32 v2, s59, v2
    v_xor_b32 v2, v110, v2
    v_subrev_u32 v3, s55, v110
    v_cmp_eq_u32 vcc, v2, v111
    v_cmp_gt_u32_e64 s[68:69], s79, v3
    s_nop 1
    s_and_b64 s[68:69], s[68:69], vcc
    s_and_b64 s[84:85], s[84:85], s[68:69]
    s_cmp_eq_u64 s[84:85], -1
    s_cbranch_scc1 S_wait3
    s_add_u32 s78, s78, 1
    s_cmp_ge_u32 s78, 96
    s_cbranch_scc1 W_ref_17
W_ref_17_back:
    s_sleep 4
    s_cmp_lt_u32 s78, 200000
    s_cbranch_scc1 S_poll2
S_wait3:
    s_barrier
    buffer_load_dwordx4 v[16:19], v7, s[20:23], s44 offen offset:0
    buffer_load_dwordx4 v[20:23], v7, s[20:23], s44 offen offset:1024
    buffer_load_dwordx4 v[24:27], v7, s[20:23], s44 offen offset:2048
    buffer_load_dwordx4 v[28:31], v7, s[20:23], s44 offen offset:3072
    buffer_load_dwordx4 v[32:35], v7, s[20:23], s38 offen offset:0
    buffer_load_dwordx4 v[36:39], v7, s[20:23], s38 offen offset:1024
    buffer_load_dwordx4 v[40:43], v7, s[20:23], s38 offen offset:2048
    buffer_load_dwordx4 v[44:47], v7, s[20:23], s38 offen offset:3072
    buffer_load_dwordx4 v[48:51], v8, s[20:23], s42 offen offset:0
    buffer_load_dwordx4 v[52:55], v8, s[20:23], s43 offen offset:0
    buffer_load_dwordx4 v[56:59], v8, s[20:23], s42 offen offset:1024
    buffer_load_dwordx4 v[60:63], v8, s[20:23], s43 offen offset:1024
    buffer_load_dwordx4 v[64:67], v8, s[20:23], s42 offen offset:2048
    buffer_load_dwordx4 v[68:71], v8, s[20:23], s43 offen offset:2048
    buffer_load_dwordx4 v[72:75], v8, s[20:23], s42 offen offset:3072
    buffer_load_dwordx4 v[76:79], v8, s[20:23], s43 offen offset:3072
    buffer_load_dword v116, v6, s[20:23], s46 offen sc1
    buffer_load_dword v117, v6, s[20:23], s46 offen offset:512 sc1
    s_waitcnt vmcnt(0)
    s_branch S_go
S_wait:
    s_barrier
    buffer_load_dwordx4 v[48:51], v8, s[20:23], s42 offen offset:0
    buffer_load_dwordx4 v[52:55], v8, s[20:23], s43 offen offset:0
    buffer_load_dwordx4 v[56:59], v8, s[20:23], s42 offen offset:1024
    buffer_load_dwordx4 v[60:63], v8, s[20:23], s43 offen offset:1024
    buffer_load_dwordx4 v[64:67], v8, s[20:23], s42 offen offset:2048
    buffer_load_dwordx4 v[68:71], v8, s[20:23], s43 offen offset:2048
    buffer_load_dwordx4 v[72:75], v8, s[20:23], s42 offen offset:3072
    buffer_load_dwordx4 v[76:79], v8, s[20:23], s43 offen offset:3072
S_wait2:
    s_barrier
    buffer_load_dwordx4 v[16:19], v7, s[20:23], s44 offen offset:0
    buffer_load_dwordx4 v[20:23], v7, s[20:23], s44 offen offset:1024
    buffer_load_dwordx4 v[24:27], v7, s[20:23], s44 offen offset:2048
    buffer_load_dwordx4 v[28:31], v7, s[20:23], s44 offen offset:3072
    buffer_load_dwordx4 v[32:35], v7, s[20:23], s38 offen offset:0
    buffer_load_dwordx4 v[36:39], v7, s[20:23], s38 offen offset:1024
    buffer_load_dwordx4 v[40:43], v7, s[20:23], s38 offen offset:2048
    buffer_load_dwordx4 v[44:47], v7, s[20:23], s38 offen offset:3072
    buffer_load_dword v116, v6, s[20:23], s46 offen sc1
    buffer_load_dword v117, v6, s[20:23], s46 offen offset:512 sc1
S_go:
    s_waitcnt vmcnt(6)
    v_cvt_pk_bf16_f32 v16, v16, v17
    v_cvt_pk_bf16_f32 v17, v18, v19
    v_cvt_pk_bf16_f32 v18, v20, v21
    v_cvt_pk_bf16_f32 v19, v22, v23
    v_cvt_pk_bf16_f32 v20, v24, v25
    v_cvt_pk_bf16_f32 v21, v26, v27
    v_cvt_pk_bf16_f32 v22, v28, v29
    v_cvt_pk_bf16_f32 v23, v30, v31
    s_waitcnt vmcnt(14)
    s_nop 0
    v_mfma_f32_32x32x16_bf16 v[128:143], v[16:19], v[48:51], 0
    v_mfma_f32_32x32x16_bf16 v[128:143], v[20:23], v[56:59], v[128:143]
    v_mfma_f32_32x32x16_bf16 v[144:159], v[16:19], v[52:55], 0
    v_mfma_f32_32x32x16_bf16 v[144:159], v[20:23], v[60:63], v[144:159]
    s_waitcnt vmcnt(2)
    v_cvt_pk_bf16_f32 v32, v32, v33
    v_cvt_pk_bf16_f32 v33, v34, v35
    v_cvt_pk_bf16_f32 v34, v36, v37
    v_cvt_pk_bf16_f32 v35, v38, v39
    v_cvt_pk_bf16_f32 v36, v40, v41
    v_cvt_pk_bf16_f32 v37, v42, v43
    v_cvt_pk_bf16_f32 v38, v44, v45
    v_cvt_pk_bf16_f32 v39, v46, v47
    s_waitcnt vmcnt(10)
    s_nop 0
    v_mfma_f32_32x32x16_bf16 v[160:175], v[32:35], v[64:67], 0
    v_mfma_f32_32x32x16_bf16 v[160:175], v[36:39], v[72:75], v[160:175]
    v_mfma_f32_32x32x16_bf16 v[176:191], v[32:35], v[68:71], 0
    v_mfma_f32_32x32x16_bf16 v[176:191], v[36:39], v[76:79], v[176:191]
    s_waitcnt vmcnt(0)
    v_mul_f32 v116, v116, v116
    v_mul_f32 v117, v117, v117
    v_rcp_f32 v116, v116
    v_rcp_f32 v117, v117
    s_nop 3
    v_mov_b32 v120, v135
    v_mov_b32 v121, v135
    v_mov_b32 v122, v151
    v_mov_b32 v123, v151
    s_nop 1
    v_permlane32_swap_b32 v120, v121
    v_permlane32_swap_b32 v122, v123
    s_nop 0
    v_add_f32 v120, s54, v120
    v_add_f32 v122, s54, v122
    v_rcp_f32 v120, v120
    v_rcp_f32 v122, v122
    s_nop 0
    v_mul_f32 v120, v120, v116
    v_mul_f32 v122, v122, v117
    v_mul_f32 v128, v128, v120
    v_mul_f32 v129, v129, v120
    v_cvt_pk_bf16_f32 v128, v128, v129
    v_mul_f32 v130, v130, v120
    v_mul_f32 v131, v131, v120
    v_cvt_pk_bf16_f32 v129, v130, v131
    v_mul_f32 v132, v132, v120
    v_mul_f32 v133, v133, v120
    v_cvt_pk_bf16_f32 v130, v132, v133
    v_mul_f32 v134, v134, v120
    v_cvt_pk_bf16_f32 v131, v134, 1.0
    v_mul_f32 v136, v136, v120
    v_mul_f32 v137, v137, v120
    v_cvt_pk_bf16_f32 v132, v136, v137
    v_mul_f32 v138, v138, v120
    v_mul_f32 v139, v139, v120
    v_cvt_pk_bf16_f32 v133, v138, v139
    v_mul_f32 v140, v140, v120
    v_mul_f32 v141, v141, v120
    v_cvt_pk_bf16_f32 v134, v140, v141
    v_mul_f32 v142, v142, v120
    v_cvt_pk_bf16_f32 v135, v142, 1.0
    v_mul_f32 v144, v144, v122
    v_mul_f32 v145, v145, v122
    v_cvt_pk_bf16_f32 v144, v144, v145
    v_mul_f32 v146, v146, v122
    v_mul_f32 v147, v147, v122
    v_cvt_pk_bf16_f32 v145, v146, v147
    v_mul_f32 v148, v148, v122
    v_mul_f32 v149, v149, v122
    v_cvt_pk_bf16_f32 v146, v148, v149
    v_mul_f32 v150, v150, v122
    v_cvt_pk_bf16_f32 v147, v150, 1.0
    v_mul_f32 v152, v152, v122
    v_mul_f32 v153, v153, v122
    v_cvt_pk_bf16_f32 v148, v152, v153
    v_mul_f32 v154, v154, v122
    v_mul_f32 v155, v155, v122
    v_cvt_pk_bf16_f32 v149, v154, v155
    v_mul_f32 v156, v156, v122
    v_mul_f32 v157, v157, v122
    v_cvt_pk_bf16_f32 v150, v156, v157
    v_mul_f32 v158, v158, v122
    v_cvt_pk_bf16_f32 v151, v158, 1.0
    buffer_store_dwordx4 v[128:131], v8, s[20:23], s40 offen offset:0 sc1
    buffer_store_dwordx4 v[144:147], v8, s[20:23], s40 offen offset:1024 sc1
    buffer_store_dwordx4 v[132:135], v8, s[20:23], s40 offen offset:2048 sc1
    buffer_store_dwordx4 v[148:151], v8, s[20:23], s40 offen offset:3072 sc1
    s_nop 3
    v_mov_b32 v120, v167
    v_mov_b32 v121, v167
    v_mov_b32 v122, v183
    v_mov_b32 v123, v183
    s_nop 1
    v_permlane32_swap_b32 v120, v121
    v_permlane32_swap_b32 v122, v123
    s_nop 0
    v_add_f32 v120, s54, v120
    v_add_f32 v122, s54, v122
    v_rcp_f32 v120, v120
    v_rcp_f32 v122, v122
    s_nop 0
    v_mul_f32 v120, v120, v116
    v_mul_f32 v122, v122, v117
    v_mul_f32 v160, v160, v120
    v_mul_f32 v161, v161, v120
    v_cvt_pk_bf16_f32 v160, v160, v161
    v_mul_f32 v162, v162, v120
    v_mul_f32 v163, v163, v120
    v_cvt_pk_bf16_f32 v161, v162, v163
    v_mul_f32 v164, v164, v120
    v_mul_f32 v165, v165, v120
    v_cvt_pk_bf16_f32 v162, v164, v165
    v_mul_f32 v166, v166, v120
    v_cvt_pk_bf16_f32 v163, v166, 1.0
    v_mul_f32 v168, v168, v120
    v_mul_f32 v169, v169, v120
    v_cvt_pk_bf16_f32 v164, v168, v169
    v_mul_f32 v170, v170, v120
    v_mul_f32 v171, v171, v120
    v_cvt_pk_bf16_f32 v165, v170, v171
    v_mul_f32 v172, v172, v120
    v_mul_f32 v173, v173, v120
    v_cvt_pk_bf16_f32 v166, v172, v173
    v_mul_f32 v174, v174, v120
    v_cvt_pk_bf16_f32 v167, v174, 1.0
    v_mul_f32 v176, v176, v122
    v_mul_f32 v177, v177, v122
    v_cvt_pk_bf16_f32 v176, v176, v177
    v_mul_f32 v178, v178, v122
    v_mul_f32 v179, v179, v122
    v_cvt_pk_bf16_f32 v177, v178, v179
    v_mul_f32 v180, v180, v122
    v_mul_f32 v181, v181, v122
    v_cvt_pk_bf16_f32 v178, v180, v181
    v_mul_f32 v182, v182, v122
    v_cvt_pk_bf16_f32 v179, v182, 1.0
    v_mul_f32 v184, v184, v122
    v_mul_f32 v185, v185, v122
    v_cvt_pk_bf16_f32 v180, v184, v185
    v_mul_f32 v186, v186, v122
    v_mul_f32 v187, v187, v122
    v_cvt_pk_bf16_f32 v181, v186, v187
    v_mul_f32 v188, v188, v122
    v_mul_f32 v189, v189, v122
    v_cvt_pk_bf16_f32 v182, v188, v189
    v_mul_f32 v190, v190, v122
    v_cvt_pk_bf16_f32 v183, v190, 1.0
    buffer_store_dwordx4 v[160:163], v8, s[20:23], s41 offen offset:0 sc1
    buffer_store_dwordx4 v[176:179], v8, s[20:23], s41 offen offset:1024 sc1
    buffer_store_dwordx4 v[164:167], v8, s[20:23], s41 offen offset:2048 sc1
    buffer_store_dwordx4 v[180:183], v8, s[20:23], s41 offen offset:3072 sc1
    s_endpgm
W_ref_1:
    s_load_dwordx2 s[64:65], s[0:1], 64
    s_mov_b32 s66, 256
    s_mov_b32 s67, 0x20000
    v_lshlrev_b32 v2, 2, v0
    s_waitcnt lgkmcnt(0)
    buffer_load_dword v3, v2, s[64:67], 0 offen sc1
    s_waitcnt vmcnt(0)
    v_max_u32_dpp v3, v3, v3 row_shr:1 row_mask:0xf bank_mask:0xf bound_ctrl:0
    s_nop 1
    v_max_u32_dpp v3, v3, v3 row_shr:2 row_mask:0xf bank_mask:0xf bound_ctrl:0
    s_nop 1
    v_max_u32_dpp v3, v3, v3 row_shr:4 row_mask:0xf bank_mask:0xf bound_ctrl:0
    s_nop 1
    v_max_u32_dpp v3, v3, v3 row_shr:8 row_mask:0xf bank_mask:0xf bound_ctrl:0
    s_nop 1
    v_max_u32_dpp v3, v3, v3 row_bcast:15 row_mask:0xa bank_mask:0xf
    s_nop 1
    v_max_u32_dpp v3, v3, v3 row_bcast:31 row_mask:0xc bank_mask:0xf
    s_nop 1
    v_readlane_b32 s68, v3, 63
    s_nop 1
    s_cmp_eq_u32 s68, 0
    s_cbranch_scc1 W_ref_1_back
    s_not_b32 s68, s68
    s_sub_u32 s68, s68, 800
    s_sub_u32 s69, s55, s68
    s_cmp_lt_u32 s69, 0x80000000
    s_cselect_b32 s55, s68, s55
    s_branch W_ref_1_back
W_ref_14:
    s_load_dwordx2 s[64:65], s[0:1], 64
    s_mov_b32 s66, 256
    s_mov_b32 s67, 0x20000
    v_lshlrev_b32 v2, 2, v0
    s_waitcnt lgkmcnt(0)
    buffer_load_dword v3, v2, s[64:67], 0 offen sc1
    s_waitcnt vmcnt(0)
    v_max_u32_dpp v3, v3, v3 row_shr:1 row_mask:0xf bank_mask:0xf bound_ctrl:0
    s_nop 1
    v_max_u32_dpp v3, v3, v3 row_shr:2 row_mask:0xf bank_mask:0xf bound_ctrl:0
    s_nop 1
    v_max_u32_dpp v3, v3, v3 row_shr:4 row_mask:0xf bank_mask:0xf bound_ctrl:0
    s_nop 1
    v_max_u32_dpp v3, v3, v3 row_shr:8 row_mask:0xf bank_mask:0xf bound_ctrl:0
    s_nop 1
    v_max_u32_dpp v3, v3, v3 row_bcast:15 row_mask:0xa bank_mask:0xf
    s_nop 1
    v_max_u32_dpp v3, v3, v3 row_bcast:31 row_mask:0xc bank_mask:0xf
    s_nop 1
    v_readlane_b32 s68, v3, 63
    s_nop 1
    s_cmp_eq_u32 s68, 0
    s_cbranch_scc1 W_ref_14_back
    s_not_b32 s68, s68
    s_sub_u32 s68, s68, 800
    s_sub_u32 s69, s55, s68
    s_cmp_lt_u32 s69, 0x80000000
    s_cselect_b32 s55, s68, s55
    s_branch W_ref_14_back
W_ref_16:
    s_load_dwordx2 s[64:65], s[0:1], 64
    s_mov_b32 s66, 256
    s_mov_b32 s67, 0x20000
    v_lshlrev_b32 v2, 2, v0
    s_waitcnt lgkmcnt(0)
    buffer_load_dword v3, v2, s[64:67], 0 offen sc1
    s_waitcnt vmcnt(0)
    v_max_u32_dpp v3, v3, v3 row_shr:1 row_mask:0xf bank_mask:0xf bound_ctrl:0
    s_nop 1
    v_max_u32_dpp v3, v3, v3 row_shr:2 row_mask:0xf bank_mask:0xf bound_ctrl:0
    s_nop 1
    v_max_u32_dpp v3, v3, v3 row_shr:4 row_mask:0xf bank_mask:0xf bound_ctrl:0
    s_nop 1
    v_max_u32_dpp v3, v3, v3 row_shr:8 row_mask:0xf bank_mask:0xf bound_ctrl:0
    s_nop 1
    v_max_u32_dpp v3, v3, v3 row_bcast:15 row_mask:0xa bank_mask:0xf
    s_nop 1
    v_max_u32_dpp v3, v3, v3 row_bcast:31 row_mask:0xc bank_mask:0xf
    s_nop 1
    v_readlane_b32 s68, v3, 63
    s_nop 1
    s_cmp_eq_u32 s68, 0
    s_cbranch_scc1 W_ref_16_back
    s_not_b32 s68, s68
    s_sub_u32 s68, s68, 800
    s_sub_u32 s69, s55, s68
    s_cmp_lt_u32 s69, 0x80000000
    s_cselect_b32 s55, s68, s55
    s_branch W_ref_16_back
W_ref_17:
    s_load_dwordx2 s[64:65], s[0:1], 64
    s_mov_b32 s66, 256
    s_mov_b32 s67, 0x20000
    v_lshlrev_b32 v2, 2, v0
    s_waitcnt lgkmcnt(0)
    buffer_load_dword v3, v2, s[64:67], 0 offen sc1
    s_waitcnt vmcnt(0)
    v_max_u32_dpp v3, v3, v3 row_shr:1 row_mask:0xf bank_mask:0xf bound_ctrl:0
    s_nop 1
    v_max_u32_dpp v3, v3, v3 row_shr:2 row_mask:0xf bank_mask:0xf bound_ctrl:0
    s_nop 1
    v_max_u32_dpp v3, v3, v3 row_shr:4 row_mask:0xf bank_mask:0xf bound_ctrl:0
    s_nop 1
    v_max_u32_dpp v3, v3, v3 row_shr:8 row_mask:0xf bank_mask:0xf bound_ctrl:0
    s_nop 1
    v_max_u32_dpp v3, v3, v3 row_bcast:15 row_mask:0xa bank_mask:0xf
    s_nop 1
    v_max_u32_dpp v3, v3, v3 row_bcast:31 row_mask:0xc bank_mask:0xf
    s_nop 1
    v_readlane_b32 s68, v3, 63
    s_nop 1
    s_cmp_eq_u32 s68, 0
    s_cbranch_scc1 W_ref_17_back
    s_not_b32 s68, s68
    s_sub_u32 s68, s68, 800
    s_sub_u32 s69, s55, s68
    s_cmp_lt_u32 s69, 0x80000000
    s_cselect_b32 s55, s68, s55
    s_branch W_ref_17_back
K1_end:
    s_endpgm
K1_codeend:
.section .rodata,"a"
.p2align 6
.amdhsa_kernel parallel_sum__linear_attn_block__glu_gated_reglu__prompt_kernel
  .amdhsa_next_free_vgpr 256
  .amdhsa_next_free_sgpr 102
  .amdhsa_accum_offset 256
  .amdhsa_group_segment_fixed_size 0
  .amdhsa_kernarg_size 80
  .amdhsa_user_sgpr_count 2
  .amdhsa_user_sgpr_kernarg_segment_ptr 1
  .amdhsa_system_sgpr_workgroup_id_x 1
.end_amdhsa_kernel
```
